```python
import torch

def _softmax(x, axis=-1):
    return torch.softmax(x, dim=axis)
def _gelu(x):
    return torch.nn.functional.gelu(x, approximate="tanh")
def _silu(x):
    return torch.nn.functional.silu(x)
def _sigmoid(x):
    return torch.sigmoid(x)
def _layernorm(x, axis=-1, eps=1e-5):
    m = x.mean(dim=axis, keepdim=True)
    v = x.var(dim=axis, keepdim=True, unbiased=False)
    return (x - m) / torch.sqrt(v + eps)
def _scatter_add(tgt, idx, src, axis=0):
    return tgt.clone().index_add_(axis, idx, src)
def _segment_sum(src, seg, n):
    out = torch.zeros((n,) + src.shape[1:], dtype=src.dtype)
    return out.index_add_(0, seg, src)
def _pad(x, pw):
    flat = tuple(v for pair in reversed(pw) for v in pair)
    return torch.nn.functional.pad(x, flat)

kernel_name = 'parallel_sum__sliding_block__dense_activation_relu__prompt'

def setup_inputs():

    _w = (lambda a: (lambda t: t.to(torch.bfloat16) if t.is_floating_point() else t)(torch.as_tensor(a)))
    def _A_setup():
        B, S, D = 1, 2048, 1024
        return {
            "x": _w((lambda *s: torch.randn(*s, dtype=torch.bfloat16) * 0.05)(B, S, D)),
            "wqkv": _w((lambda *s: torch.randn(*s, dtype=torch.bfloat16) * 0.05)(D, 3 * D)),
            "wo": _w((lambda *s: torch.randn(*s, dtype=torch.bfloat16) * 0.05)(D, D)),
        }
    _A_in = _A_setup()

    def _B_setup():
        B, S, D, Dff = 1, 2048, 1024, 3584
        return {
            "x": _w((lambda *s: torch.randn(*s, dtype=torch.bfloat16) * 0.05)(B, S, D)),
            "w1": _w((lambda *s: torch.randn(*s, dtype=torch.bfloat16) * 0.05)(D, Dff)),
            "w2": _w((lambda *s: torch.randn(*s, dtype=torch.bfloat16) * 0.05)(Dff, D)),
        }
    _B_in = _B_setup()

    return {
        "A_x": _A_in["x"],
        "A_wqkv": _A_in["wqkv"],
        "A_wo": _A_in["wo"],
        "B_x": _B_in["x"],
        "B_w1": _B_in["w1"],
        "B_w2": _B_in["w2"],
    }

def reference(A_x, A_wqkv, A_wo, B_x, B_w1, B_w2):
    def _A_ref(x, wqkv, wo):
        B, S, D = x.shape
        H = 32; Dh = D // H; W = 256
        qkv = (lambda x, *d: x.permute(*d))((x @ wqkv).reshape(B, S, 3, H, Dh), 2, 0, 3, 1, 4)
        q, k, v = qkv[0], qkv[1], qkv[2]
        scores = torch.einsum("bhqd,bhkd->bhqk", q, k) * (Dh ** -0.5)
        idx = torch.arange(S)
        mask = (idx[:, None] - idx[None, :] >= 0) & (idx[:, None] - idx[None, :] < W)
        scores = torch.where(mask[None, None], scores, -1e9)
        p = _softmax(scores, axis=-1)
        o = torch.einsum("bhqk,bhkd->bhqd", p, v)
        return (lambda x, *d: x.permute(*d))(o, 0, 2, 1, 3).reshape(B, S, D) @ wo

    def _B_ref(x, w1, w2):
        h = torch.einsum("bsd,df->bsf", x, w1)
        zero = torch.zeros_like(h)
        h = torch.maximum(h, zero)
        return torch.einsum("bsf,fd->bsd", h, w2)

    x = A_x
    xn = _layernorm(x, axis=-1)
    return x + _A_ref(xn, A_wqkv, A_wo) + _B_ref(xn, B_w1, B_w2)
```

```asm
; @launch grid=(256,1,1) block=(256,1,1) lds=163840
.amdgcn_target "amdgcn-amd-amdhsa--gfx950"
.text
.globl parallel_sum__sliding_block__dense_activation_relu__prompt_kernel
.p2align 8
.type parallel_sum__sliding_block__dense_activation_relu__prompt_kernel,@function
parallel_sum__sliding_block__dense_activation_relu__prompt_kernel:
    s_cmp_ge_u32 s2, 256
    s_cbranch_scc1 F_end
    s_load_dwordx2 s[4:5], s[0:1], 8
    s_load_dwordx2 s[6:7], s[0:1], 32
    s_load_dwordx2 s[8:9], s[0:1], 64
    s_load_dwordx2 s[10:11], s[0:1], 0
    s_load_dwordx2 s[12:13], s[0:1], 40
    s_load_dwordx2 s[14:15], s[0:1], 16
    s_load_dwordx2 s[16:17], s[0:1], 48
    s_getpc_b64 s[32:33]
F_pc_1:
    s_and_b32 s33, s33, 0xffff
    s_mov_b32 s34, CODE_END - F_pc_1
    s_mov_b32 s35, 0x00020000
    s_lshr_b32 s53, s2, 3
    s_lshl_b32 s53, s53, 7
    v_lshlrev_b32 v70, 12, v0
    buffer_load_dword v76, v70, s[32:35], s53 offen
    s_load_dwordx2 s[100:101], s[0:1], 56
    v_and_b32 v224, 63, v0
    v_lshrrev_b32 v233, 6, v0
    v_lshlrev_b32 v208, 4, v224
    v_readfirstlane_b32 s40, v233
    s_and_b32 s41, s2, 1
    s_lshl_b32 s41, s41, 2
    s_bfe_u32 s53, s2, 0x20003
    s_add_u32 s41, s41, s53
    s_bfe_u32 s44, s2, 0x20001
    s_lshr_b32 s45, s2, 5
    s_lshl_b32 s42, s44, 3
    s_add_u32 s42, s42, s45
    s_and_b32 s43, s45, 1
    v_and_b32 v3, 7, v224
    v_lshrrev_b32 v4, 3, v224
    v_lshlrev_b32 v5, 11, v3
    v_lshl_add_u32 v5, v233, 9, v5
    v_lshl_add_u32 v5, v4, 4, v5
    s_lshl_b32 s56, s41, 5
    s_add_u32 s56, s56, s42
    s_lshl_b32 s70, s56, 14
    s_waitcnt lgkmcnt(0)
    s_mov_b32 s28, s10
    s_and_b32 s29, s11, 0xffff
    s_mov_b32 s30, 0x400000
    s_mov_b32 s31, 0x00020000
    buffer_load_dwordx4 v[8:11], v5, s[28:31], s70 offen offset:0
    buffer_load_dwordx4 v[12:15], v5, s[28:31], s70 offen offset:128
    buffer_load_dwordx4 v[16:19], v5, s[28:31], s70 offen offset:256
    buffer_load_dwordx4 v[20:23], v5, s[28:31], s70 offen offset:384
    s_mov_b32 s36, s8
    s_and_b32 s37, s9, 0xffff
    s_mov_b32 s38, 0x2f28000
    s_mov_b32 s39, 0x00020000
    s_lshl_b32 s83, s41, 12
    s_add_u32 s82, s83, 0x2f20000
    v_and_b32 v80, 31, v224
    v_lshlrev_b32 v80, 2, v80
    v_add_u32 v80, s82, v80
    buffer_load_dword v81, v80, s[36:39], 0 offen sc1
    v_lshrrev_b32 v234, 2, v224
    v_and_b32 v236, 3, v224
    v_lshlrev_b32 v236, 4, v236
    v_mul_u32_u24 v237, 98304, v233
    v_lshl_add_u32 v237, v234, 11, v237
    v_add_u32 v209, v237, v236
    v_and_b32 v235, 32, v224
    v_xor_b32 v240, v209, v235
    v_add_u32 v240, 32768, v240
    v_xor_b32 v241, 32, v209
    v_add_u32 v241, 65536, v241
    v_mul_u32_u24 v237, 114688, v233
    v_add_u32 v237, v237, v236
    v_mul_u32_u24 v236, 43, v234
    v_lshrrev_b32 v236, 7, v236
    v_mul_u32_u24 v236, 6976, v236
    v_lshl_add_u32 v236, v234, 6, v236
    v_add_u32 v210, v236, v237
    v_add_u32 v234, 16, v234
    v_mul_u32_u24 v236, 43, v234
    v_lshrrev_b32 v236, 7, v236
    v_mul_u32_u24 v236, 6976, v236
    v_lshl_add_u32 v236, v234, 6, v236
    v_add_u32 v242, v236, v237
    v_xor_b32 v242, v242, v235
    v_add_u32 v234, 16, v234
    v_mul_u32_u24 v236, 43, v234
    v_lshrrev_b32 v236, 7, v236
    v_mul_u32_u24 v236, 6976, v236
    v_lshl_add_u32 v236, v234, 6, v236
    v_add_u32 v243, v236, v237
    v_xor_b32 v243, 32, v243
    v_bfe_u32 v234, v224, 3, 1
    v_lshlrev_b32 v234, 3, v234
    v_bfe_u32 v235, v224, 4, 1
    v_lshl_add_u32 v234, v235, 2, v234
    v_bfe_u32 v235, v224, 1, 2
    v_add_u32 v234, v234, v235
    v_lshl_add_u32 v234, v233, 4, v234
    v_mul_u32_u24 v211, 7168, v234
    v_and_b32 v235, 1, v224
    v_lshl_add_u32 v211, v235, 4, v211
    v_lshrrev_b32 v235, 5, v224
    v_lshl_add_u32 v211, v235, 30, v211
    s_lshl_b32 s46, s42, 6
    s_mul_i32 s49, s42, 224
    s_lshl_b32 s53, s43, 5
    s_add_u32 s48, s49, s53
    s_xor_b32 s53, s43, 1
    s_mul_i32 s53, s53, 192
    s_add_u32 s49, s49, s53
    s_mul_i32 s50, s40, 7168
    s_lshl_b32 s51, s41, 2
    s_add_u32 s51, s51, s40
    s_lshl_b32 s51, s51, 17
    s_add_u32 s51, s51, 0x100000
    s_add_u32 s54, s41, s45
    s_and_b32 s54, s54, 3
    s_cmp_eq_u32 s54, 3
    s_cselect_b32 s58, -3, 1
    s_cmp_eq_u32 s54, 2
    s_cselect_b32 s59, -3, 1
    s_cmp_eq_u32 s54, 1
    s_cselect_b32 s60, -3, 1
    s_cmp_eq_u32 s54, 0
    s_cselect_b32 s61, 1, 5
    s_mul_i32 s53, s54, 393216
    s_add_u32 s46, s46, s53
    s_mul_i32 s53, s54, 458752
    s_add_u32 s48, s48, s53
    s_add_u32 s49, s49, s53
    s_lshl_b32 s53, s54, 13
    s_add_u32 s51, s51, s53
    s_lshl_b32 s62, s58, 13
    s_sub_u32 s62, s62, 4096
    s_lshl_b32 s63, s59, 13
    s_sub_u32 s63, s63, 4096
    s_lshl_b32 s64, s60, 13
    s_sub_u32 s64, s64, 4096
    s_lshl_b32 s65, s61, 13
    s_sub_u32 s65, s65, 4096
    s_mov_b32 s20, s4
    s_and_b32 s21, s5, 0xffff
    s_mov_b32 s22, 0x600000
    s_mov_b32 s23, 0x00020000
    s_mov_b32 s24, s6
    s_and_b32 s25, s7, 0xffff
    s_mov_b32 s26, 0x700000
    s_mov_b32 s27, 0x00020000
    s_add_u32 m0, s50, 0
    s_nop 0
    buffer_load_dwordx4 v209, s[20:23], s46 offen offset:0 lds
    s_mul_i32 s55, s58, 393216
    s_add_u32 m0, s50, 1024
    s_nop 0
    buffer_load_dwordx4 v240, s[20:23], s46 offen offset:0 lds
    s_lshl_b32 s53, s2, 9
    s_add_u32 s53, s53, 0x2f00000
    v_lshlrev_b32 v70, 2, v0
    v_lshrrev_b32 v71, 7, v0
    v_lshl_add_u32 v70, v71, 30, v70
    v_mov_b32 v71, 0
    buffer_store_dword v71, v70, s[36:39], s53 offen sc1
    s_lshr_b32 s53, s56, 3
    s_lshl_b32 s53, s53, 17
    s_bfe_u32 s54, s56, 0x20001
    s_lshl_b32 s54, s54, 10
    s_add_u32 s53, s53, s54
    s_and_b32 s54, s56, 1
    s_lshl_b32 s54, s54, 7
    s_add_u32 s53, s53, s54
    s_add_u32 s56, s53, 0x100000
    v_lshrrev_b32 v6, 2, v4
    v_lshl_add_u32 v6, v233, 3, v6
    v_lshlrev_b32 v6, 12, v6
    v_and_b32 v7, 3, v4
    v_lshl_add_u32 v6, v7, 8, v6
    v_lshl_add_u32 v6, v3, 4, v6
    v_lshl_add_u32 v7, v233, 3, v3
    v_lshlrev_b32 v7, 3, v7
    v_add_u32 v7, 143360, v7
    v_lshlrev_b32 v60, 3, v3
    v_add_u32 v60, 143360, v60
    s_waitcnt vmcnt(7)
    v_lshlrev_b32 v24, 16, v8
    v_and_b32 v25, 0xffff0000, v8
    v_lshlrev_b32 v26, 16, v9
    v_and_b32 v27, 0xffff0000, v9
    v_pk_add_f32 v[56:57], v[24:25], v[26:27]
    v_lshlrev_b32 v28, 16, v10
    v_and_b32 v29, 0xffff0000, v10
    v_lshlrev_b32 v30, 16, v11
    v_and_b32 v31, 0xffff0000, v11
    v_pk_add_f32 v[58:59], v[28:29], v[30:31]
    s_waitcnt vmcnt(6)
    v_lshlrev_b32 v32, 16, v12
    v_and_b32 v33, 0xffff0000, v12
    v_pk_add_f32 v[56:57], v[56:57], v[32:33]
    v_lshlrev_b32 v34, 16, v13
    v_and_b32 v35, 0xffff0000, v13
    v_pk_add_f32 v[58:59], v[58:59], v[34:35]
    v_lshlrev_b32 v36, 16, v14
    v_and_b32 v37, 0xffff0000, v14
    s_add_u32 m0, s50, 2048
    s_nop 0
    buffer_load_dwordx4 v241, s[20:23], s46 offen offset:0 lds
    s_add_u32 s46, s46, s55
    v_pk_add_f32 v[56:57], v[56:57], v[36:37]
    v_lshlrev_b32 v38, 16, v15
    v_and_b32 v39, 0xffff0000, v15
    v_pk_add_f32 v[58:59], v[58:59], v[38:39]
    s_waitcnt vmcnt(6)
    v_lshlrev_b32 v40, 16, v16
    v_and_b32 v41, 0xffff0000, v16
    v_pk_add_f32 v[56:57], v[56:57], v[40:41]
    v_lshlrev_b32 v42, 16, v17
    v_and_b32 v43, 0xffff0000, v17
    v_pk_add_f32 v[58:59], v[58:59], v[42:43]
    v_lshlrev_b32 v44, 16, v18
    v_and_b32 v45, 0xffff0000, v18
    v_pk_add_f32 v[56:57], v[56:57], v[44:45]
    v_lshlrev_b32 v46, 16, v19
    v_and_b32 v47, 0xffff0000, v19
    v_pk_add_f32 v[58:59], v[58:59], v[46:47]
    s_waitcnt vmcnt(5)
    v_lshlrev_b32 v48, 16, v20
    v_and_b32 v49, 0xffff0000, v20
    s_add_u32 m0, s50, 3072
    s_nop 0
    buffer_load_dwordx4 v210, s[24:27], s48 offen offset:0 lds
    s_mul_i32 s55, s58, 458752
    v_pk_add_f32 v[56:57], v[56:57], v[48:49]
    v_lshlrev_b32 v50, 16, v21
    v_and_b32 v51, 0xffff0000, v21
    v_pk_add_f32 v[58:59], v[58:59], v[50:51]
    v_lshlrev_b32 v52, 16, v22
    v_and_b32 v53, 0xffff0000, v22
    v_pk_add_f32 v[56:57], v[56:57], v[52:53]
    v_lshlrev_b32 v54, 16, v23
    v_and_b32 v55, 0xffff0000, v23
    v_pk_add_f32 v[58:59], v[58:59], v[54:55]
    v_pk_add_f32 v[56:57], v[56:57], v[58:59]
    v_add_f32 v56, v56, v57
    s_nop 1
    v_add_f32_dpp v56, v56, v56 row_ror:8 row_mask:0xf bank_mask:0xf
    v_mov_b32 v57, v56
    s_nop 1
    v_permlane16_swap_b32 v56, v57
    v_add_f32 v56, v56, v57
    v_mov_b32 v57, v56
    s_nop 1
    s_add_u32 m0, s50, 4096
    s_nop 0
    buffer_load_dwordx4 v242, s[24:27], s48 offen offset:0 lds
    v_permlane32_swap_b32 v56, v57
    v_add_f32 v56, v56, v57
    v_mul_f32 v56, 0x3b800000, v56
    v_pk_add_f32 v[62:63], v[24:25], v[56:57] op_sel_hi:[1,0] neg_lo:[0,1] neg_hi:[0,1]
    v_pk_mul_f32 v[66:67], v[62:63], v[62:63]
    v_pk_add_f32 v[64:65], v[26:27], v[56:57] op_sel_hi:[1,0] neg_lo:[0,1] neg_hi:[0,1]
    v_pk_mul_f32 v[68:69], v[64:65], v[64:65]
    v_pk_add_f32 v[62:63], v[28:29], v[56:57] op_sel_hi:[1,0] neg_lo:[0,1] neg_hi:[0,1]
    v_pk_fma_f32 v[66:67], v[62:63], v[62:63], v[66:67]
    v_pk_add_f32 v[64:65], v[30:31], v[56:57] op_sel_hi:[1,0] neg_lo:[0,1] neg_hi:[0,1]
    v_pk_fma_f32 v[68:69], v[64:65], v[64:65], v[68:69]
    v_pk_add_f32 v[62:63], v[32:33], v[56:57] op_sel_hi:[1,0] neg_lo:[0,1] neg_hi:[0,1]
    v_pk_fma_f32 v[66:67], v[62:63], v[62:63], v[66:67]
    v_pk_add_f32 v[64:65], v[34:35], v[56:57] op_sel_hi:[1,0] neg_lo:[0,1] neg_hi:[0,1]
    v_pk_fma_f32 v[68:69], v[64:65], v[64:65], v[68:69]
    v_pk_add_f32 v[62:63], v[36:37], v[56:57] op_sel_hi:[1,0] neg_lo:[0,1] neg_hi:[0,1]
    v_pk_fma_f32 v[66:67], v[62:63], v[62:63], v[66:67]
    v_pk_add_f32 v[64:65], v[38:39], v[56:57] op_sel_hi:[1,0] neg_lo:[0,1] neg_hi:[0,1]
    v_pk_fma_f32 v[68:69], v[64:65], v[64:65], v[68:69]
    v_pk_add_f32 v[62:63], v[40:41], v[56:57] op_sel_hi:[1,0] neg_lo:[0,1] neg_hi:[0,1]
    s_add_u32 m0, s50, 5120
    s_nop 0
    buffer_load_dwordx4 v243, s[24:27], s48 offen offset:0 lds
    s_add_u32 s48, s48, s55
    v_pk_fma_f32 v[66:67], v[62:63], v[62:63], v[66:67]
    v_pk_add_f32 v[64:65], v[42:43], v[56:57] op_sel_hi:[1,0] neg_lo:[0,1] neg_hi:[0,1]
    v_pk_fma_f32 v[68:69], v[64:65], v[64:65], v[68:69]
    v_pk_add_f32 v[62:63], v[44:45], v[56:57] op_sel_hi:[1,0] neg_lo:[0,1] neg_hi:[0,1]
    v_pk_fma_f32 v[66:67], v[62:63], v[62:63], v[66:67]
    v_pk_add_f32 v[64:65], v[46:47], v[56:57] op_sel_hi:[1,0] neg_lo:[0,1] neg_hi:[0,1]
    v_pk_fma_f32 v[68:69], v[64:65], v[64:65], v[68:69]
    v_pk_add_f32 v[62:63], v[48:49], v[56:57] op_sel_hi:[1,0] neg_lo:[0,1] neg_hi:[0,1]
    v_pk_fma_f32 v[66:67], v[62:63], v[62:63], v[66:67]
    v_pk_add_f32 v[64:65], v[50:51], v[56:57] op_sel_hi:[1,0] neg_lo:[0,1] neg_hi:[0,1]
    v_pk_fma_f32 v[68:69], v[64:65], v[64:65], v[68:69]
    v_pk_add_f32 v[62:63], v[52:53], v[56:57] op_sel_hi:[1,0] neg_lo:[0,1] neg_hi:[0,1]
    v_pk_fma_f32 v[66:67], v[62:63], v[62:63], v[66:67]
    v_pk_add_f32 v[64:65], v[54:55], v[56:57] op_sel_hi:[1,0] neg_lo:[0,1] neg_hi:[0,1]
    v_pk_fma_f32 v[68:69], v[64:65], v[64:65], v[68:69]
    v_pk_add_f32 v[66:67], v[66:67], v[68:69]
    v_add_f32 v57, v66, v67
    s_nop 1
    v_add_f32_dpp v57, v57, v57 row_ror:8 row_mask:0xf bank_mask:0xf
    v_mov_b32 v58, v57
    s_add_u32 m0, s50, 6144
    s_nop 0
    buffer_load_dwordx4 v211, s[24:27], s49 offen offset:0 lds
    s_add_u32 s49, s49, s55
    s_nop 1
    v_permlane16_swap_b32 v57, v58
    v_add_f32 v57, v57, v58
    v_mov_b32 v58, v57
    s_nop 1
    v_permlane32_swap_b32 v57, v58
    v_add_f32 v57, v57, v58
    ds_write_b64 v7, v[56:57]
    s_waitcnt lgkmcnt(0)
    s_barrier
    ds_read_b64 v[62:63], v60 offset:0
    ds_read_b64 v[64:65], v60 offset:64
    ds_read_b64 v[66:67], v60 offset:128
    ds_read_b64 v[68:69], v60 offset:192
    s_waitcnt lgkmcnt(0)
    v_pk_add_f32 v[56:57], v[62:63], v[64:65]
    v_pk_add_f32 v[58:59], v[66:67], v[68:69]
    v_pk_add_f32 v[56:57], v[56:57], v[58:59]
    v_mul_f32 v56, 0x3e800000, v56
    v_sub_f32 v59, v62, v56
    v_mul_f32 v58, v59, v59
    v_sub_f32 v59, v64, v56
    v_fmac_f32 v58, v59, v59
    v_sub_f32 v59, v66, v56
    v_fmac_f32 v58, v59, v59
    v_sub_f32 v59, v68, v56
    v_fmac_f32 v58, v59, v59
    v_fmac_f32 v57, 0x43800000, v58
    v_mul_f32 v57, 0x3a800000, v57
    v_cvt_pk_bf16_f32 v58, v56, v57
    v_lshlrev_b32 v56, 16, v58
    v_and_b32 v57, 0xffff0000, v58
    v_add_f32 v57, 0x3727c5ac, v57
    v_cvt_pk_bf16_f32 v57, v57, v57
    v_and_b32 v57, 0xffff0000, v57
    v_sqrt_f32 v57, v57
    s_nop 0
    v_cvt_pk_bf16_f32 v57, v57, v57
    v_and_b32 v57, 0xffff0000, v57
    v_rcp_f32 v58, v57
    v_pk_add_f32 v[24:25], v[24:25], v[56:57] op_sel_hi:[1,0] neg_lo:[0,1] neg_hi:[0,1]
    v_pk_add_f32 v[26:27], v[26:27], v[56:57] op_sel_hi:[1,0] neg_lo:[0,1] neg_hi:[0,1]
    v_cvt_pk_bf16_f32 v25, v24, v25
    v_lshlrev_b32 v24, 16, v25
    v_and_b32 v25, 0xffff0000, v25
    v_pk_mul_f32 v[24:25], v[24:25], v[58:59] op_sel_hi:[1,0]
    v_cvt_pk_bf16_f32 v8, v24, v25
    v_pk_add_f32 v[28:29], v[28:29], v[56:57] op_sel_hi:[1,0] neg_lo:[0,1] neg_hi:[0,1]
    v_cvt_pk_bf16_f32 v27, v26, v27
    v_lshlrev_b32 v26, 16, v27
    v_and_b32 v27, 0xffff0000, v27
    v_pk_mul_f32 v[26:27], v[26:27], v[58:59] op_sel_hi:[1,0]
    v_cvt_pk_bf16_f32 v9, v26, v27
    v_pk_add_f32 v[30:31], v[30:31], v[56:57] op_sel_hi:[1,0] neg_lo:[0,1] neg_hi:[0,1]
    v_cvt_pk_bf16_f32 v29, v28, v29
    v_lshlrev_b32 v28, 16, v29
    v_and_b32 v29, 0xffff0000, v29
    v_pk_mul_f32 v[28:29], v[28:29], v[58:59] op_sel_hi:[1,0]
    v_cvt_pk_bf16_f32 v10, v28, v29
    v_pk_add_f32 v[32:33], v[32:33], v[56:57] op_sel_hi:[1,0] neg_lo:[0,1] neg_hi:[0,1]
    v_cvt_pk_bf16_f32 v31, v30, v31
    v_lshlrev_b32 v30, 16, v31
    v_and_b32 v31, 0xffff0000, v31
    v_pk_mul_f32 v[30:31], v[30:31], v[58:59] op_sel_hi:[1,0]
    v_cvt_pk_bf16_f32 v11, v30, v31
    buffer_store_dwordx4 v[8:11], v6, s[36:39], s56 offen sc1
    s_add_u32 s56, s56, 8192
    v_pk_add_f32 v[34:35], v[34:35], v[56:57] op_sel_hi:[1,0] neg_lo:[0,1] neg_hi:[0,1]
    v_cvt_pk_bf16_f32 v33, v32, v33
    v_lshlrev_b32 v32, 16, v33
    v_and_b32 v33, 0xffff0000, v33
    v_pk_mul_f32 v[32:33], v[32:33], v[58:59] op_sel_hi:[1,0]
    v_cvt_pk_bf16_f32 v12, v32, v33
    v_pk_add_f32 v[36:37], v[36:37], v[56:57] op_sel_hi:[1,0] neg_lo:[0,1] neg_hi:[0,1]
    v_cvt_pk_bf16_f32 v35, v34, v35
    v_lshlrev_b32 v34, 16, v35
    v_and_b32 v35, 0xffff0000, v35
    v_pk_mul_f32 v[34:35], v[34:35], v[58:59] op_sel_hi:[1,0]
    v_cvt_pk_bf16_f32 v13, v34, v35
    v_pk_add_f32 v[38:39], v[38:39], v[56:57] op_sel_hi:[1,0] neg_lo:[0,1] neg_hi:[0,1]
    v_cvt_pk_bf16_f32 v37, v36, v37
    v_lshlrev_b32 v36, 16, v37
    v_and_b32 v37, 0xffff0000, v37
    v_pk_mul_f32 v[36:37], v[36:37], v[58:59] op_sel_hi:[1,0]
    v_cvt_pk_bf16_f32 v14, v36, v37
    v_pk_add_f32 v[40:41], v[40:41], v[56:57] op_sel_hi:[1,0] neg_lo:[0,1] neg_hi:[0,1]
    v_cvt_pk_bf16_f32 v39, v38, v39
    v_lshlrev_b32 v38, 16, v39
    v_and_b32 v39, 0xffff0000, v39
    v_pk_mul_f32 v[38:39], v[38:39], v[58:59] op_sel_hi:[1,0]
    v_cvt_pk_bf16_f32 v15, v38, v39
    buffer_store_dwordx4 v[12:15], v6, s[36:39], s56 offen sc1
    s_add_u32 s56, s56, 8192
    v_pk_add_f32 v[42:43], v[42:43], v[56:57] op_sel_hi:[1,0] neg_lo:[0,1] neg_hi:[0,1]
    v_cvt_pk_bf16_f32 v41, v40, v41
    v_lshlrev_b32 v40, 16, v41
    v_and_b32 v41, 0xffff0000, v41
    v_pk_mul_f32 v[40:41], v[40:41], v[58:59] op_sel_hi:[1,0]
    v_cvt_pk_bf16_f32 v16, v40, v41
    v_pk_add_f32 v[44:45], v[44:45], v[56:57] op_sel_hi:[1,0] neg_lo:[0,1] neg_hi:[0,1]
    v_cvt_pk_bf16_f32 v43, v42, v43
    v_lshlrev_b32 v42, 16, v43
    v_and_b32 v43, 0xffff0000, v43
    v_pk_mul_f32 v[42:43], v[42:43], v[58:59] op_sel_hi:[1,0]
    v_cvt_pk_bf16_f32 v17, v42, v43
    v_pk_add_f32 v[46:47], v[46:47], v[56:57] op_sel_hi:[1,0] neg_lo:[0,1] neg_hi:[0,1]
    v_cvt_pk_bf16_f32 v45, v44, v45
    v_lshlrev_b32 v44, 16, v45
    v_and_b32 v45, 0xffff0000, v45
    v_pk_mul_f32 v[44:45], v[44:45], v[58:59] op_sel_hi:[1,0]
    v_cvt_pk_bf16_f32 v18, v44, v45
    v_pk_add_f32 v[48:49], v[48:49], v[56:57] op_sel_hi:[1,0] neg_lo:[0,1] neg_hi:[0,1]
    v_cvt_pk_bf16_f32 v47, v46, v47
    v_lshlrev_b32 v46, 16, v47
    v_and_b32 v47, 0xffff0000, v47
    v_pk_mul_f32 v[46:47], v[46:47], v[58:59] op_sel_hi:[1,0]
    v_cvt_pk_bf16_f32 v19, v46, v47
    buffer_store_dwordx4 v[16:19], v6, s[36:39], s56 offen sc1
    s_add_u32 s56, s56, 8192
    v_pk_add_f32 v[50:51], v[50:51], v[56:57] op_sel_hi:[1,0] neg_lo:[0,1] neg_hi:[0,1]
    v_cvt_pk_bf16_f32 v49, v48, v49
    v_lshlrev_b32 v48, 16, v49
    v_and_b32 v49, 0xffff0000, v49
    v_pk_mul_f32 v[48:49], v[48:49], v[58:59] op_sel_hi:[1,0]
    v_cvt_pk_bf16_f32 v20, v48, v49
    v_pk_add_f32 v[52:53], v[52:53], v[56:57] op_sel_hi:[1,0] neg_lo:[0,1] neg_hi:[0,1]
    v_cvt_pk_bf16_f32 v51, v50, v51
    v_lshlrev_b32 v50, 16, v51
    v_and_b32 v51, 0xffff0000, v51
    v_pk_mul_f32 v[50:51], v[50:51], v[58:59] op_sel_hi:[1,0]
    v_cvt_pk_bf16_f32 v21, v50, v51
    v_pk_add_f32 v[54:55], v[54:55], v[56:57] op_sel_hi:[1,0] neg_lo:[0,1] neg_hi:[0,1]
    v_cvt_pk_bf16_f32 v53, v52, v53
    v_lshlrev_b32 v52, 16, v53
    v_and_b32 v53, 0xffff0000, v53
    v_pk_mul_f32 v[52:53], v[52:53], v[58:59] op_sel_hi:[1,0]
    v_cvt_pk_bf16_f32 v22, v52, v53
    v_cvt_pk_bf16_f32 v55, v54, v55
    v_lshlrev_b32 v54, 16, v55
    v_and_b32 v55, 0xffff0000, v55
    v_pk_mul_f32 v[54:55], v[54:55], v[58:59] op_sel_hi:[1,0]
    v_cvt_pk_bf16_f32 v23, v54, v55
    buffer_store_dwordx4 v[20:23], v6, s[36:39], s56 offen sc1
    s_mov_b32 s28, s12
    s_and_b32 s29, s13, 0xffff
    s_mov_b32 s30, 0x700000
    s_mov_b32 s31, 0x00020000
    s_mov_b32 s32, s14
    s_and_b32 s33, s15, 0xffff
    s_mov_b32 s34, 0x200000
    s_mov_b32 s35, 0x00020000
    s_bfe_u32 s52, s2, 0x30003
    v_bfrev_b32 v238, 1
    v_lshlrev_b32 v231, 7, v224
    v_cmp_le_u32 vcc, 56, v224
    s_nop 1
    v_cndmask_b32 v231, v231, v238, vcc
    s_bfe_u32 s53, s2, 0x10000
    s_lshl_b32 s53, s53, 4
    s_or_b32 s52, s52, s53
    v_lshrrev_b32 v234, 5, v224
    v_mul_u32_u24 v234, 7168, v234
    v_and_b32 v235, 3, v224
    v_lshl_add_u32 v234, v235, 3, v234
    v_bfe_u32 v235, v224, 2, 2
    v_bfe_u32 v236, v224, 4, 1
    v_mul_u32_u24 v212, 192, v235
    v_add_u32 v212, v212, v234
    v_mul_u32_u24 v237, 1568, v236
    v_add_u32 v212, v212, v237
    v_xor_b32 v213, 32, v212
    v_lshl_add_u32 v214, v235, 5, v234
    v_lshl_add_u32 v214, v236, 7, v214
    v_add_u32 v215, 57344, v212
    v_add_u32 v216, 57344, v213
    v_add_u32 v217, 57344, v214
    v_add_u32 v218, 114688, v212
    v_add_u32 v219, 114688, v213
    v_add_u32 v220, 114688, v214
    s_lshl_b32 s66, s42, 7
    s_lshl_b32 s53, s41, 4
    s_add_u32 s66, s66, s53
    s_lshl_b32 s53, s40, 2
    s_add_u32 s66, s66, s53
    s_lshl_b32 s66, s66, 10
    s_add_u32 s67, s66, 0xd00000
    s_add_u32 s66, s66, 0x900000
    s_sub_u32 s68, s66, 16384
    s_sub_u32 s69, s67, 16384
    s_cmp_eq_u32 s41, 0
    s_cselect_b32 s68, 0x40000000, s68
    s_cselect_b32 s69, 0x40000000, s69
    s_lshl_b32 s71, s2, 2
    s_add_u32 s71, s71, s40
    s_lshl_b32 s71, s71, 7
    s_add_u32 s71, s71, 0x2f00000
    s_add_u32 s53, s41, 1
    s_and_b32 s54, s53, 3
    s_lshl_b32 s54, s54, 3
    s_lshr_b32 s53, s53, 2
    s_or_b32 s54, s54, s53
    s_and_b32 s53, s2, 0xe6
    s_or_b32 s54, s54, s53
    s_lshl_b32 s54, s54, 2
    s_add_u32 s54, s54, s40
    s_lshl_b32 s54, s54, 7
    s_add_u32 s70, s54, 0x2f0000c
    s_cmp_eq_u32 s41, 7
    s_cselect_b32 s70, 0x40000000, s70
    s_cselect_b32 s66, 0x40000000, s66
    s_cselect_b32 s67, 0x40000000, s67
    v_cmp_ne_u32 vcc, 0, v224
    v_mov_b32 v226, 1
    v_and_b32 v230, 31, v224
    v_cndmask_b32 v225, 0, v238, vcc
    v_lshlrev_b32 v230, 2, v230
    s_and_b32 s53, s2, 31
    s_lshl_b32 s53, s53, 2
    s_add_u32 s53, s53, s40
    s_lshl_b32 s53, s53, 7
    s_lshl_b32 s54, s45, 2
    s_add_u32 s53, s53, s54
    s_add_u32 s53, s53, 0x2f00000
    v_lshlrev_b32 v229, 14, v224
    v_add_u32 v229, s53, v229
    v_cmp_le_u32 vcc, 8, v224
    s_lshl_b32 s53, s40, 12
    s_add_u32 s53, s53, 98304
    v_cndmask_b32 v229, v229, v238, vcc
    v_add_u32 v228, s53, v208
    s_lshl_b32 s53, s41, 2
    s_add_u32 s53, s53, s40
    s_lshl_b32 s82, s53, 17
    s_mul_i32 s53, s53, 144
    s_mul_i32 s54, s44, 36
    s_add_u32 s53, s53, s54
    s_lshl_b32 s53, s53, 12
    s_add_u32 s53, s53, 0x1100000
    s_add_u32 s80, s53, 114688
    s_lshl_b32 s54, s45, 12
    s_add_u32 s77, s80, s54
    s_lshr_b32 s54, s54, 1
    s_add_u32 s75, s53, s54
    s_add_u32 s75, s75, 98304
    s_mul_i32 s54, s45, 12288
    s_add_u32 s72, s53, s54
    s_add_u32 s73, s72, 4096
    s_add_u32 s74, s72, 8192
    s_lshl_b32 s53, s45, 8
    s_add_u32 s82, s82, s53
    s_lshl_b32 s53, s44, 6
    s_add_u32 s82, s82, s53
    s_mov_b32 s76, 0x3e8293ee
    s_waitcnt vmcnt(0)
    s_barrier
    s_lshl_b32 s53, s41, 5
    v_mov_b32 v1, s53
    s_cmp_lg_u32 s40, 0
    s_cbranch_scc1 F_ln_2
    v_add_u32 v82, 1, v81
    s_lshl_b64 exec, 1, s42
    buffer_store_dword v82, v80, s[36:39], 0 offen sc1
    s_mov_b64 exec, -1
F_ln_2:
    s_add_u32 m0, s50, 114688
    s_nop 0
    buffer_load_dwordx4 v209, s[20:23], s46 offen offset:0 lds
    s_mul_i32 s55, s59, 393216
    s_add_u32 m0, s50, 115712
    s_nop 0
    buffer_load_dwordx4 v240, s[20:23], s46 offen offset:0 lds
    s_add_u32 m0, s50, 116736
    s_nop 0
    buffer_load_dwordx4 v241, s[20:23], s46 offen offset:0 lds
    s_add_u32 s46, s46, s55
    s_add_u32 m0, s50, 117760
    s_nop 0
    buffer_load_dwordx4 v210, s[24:27], s48 offen offset:0 lds
    s_mul_i32 s55, s59, 458752
    s_add_u32 m0, s50, 118784
    s_nop 0
    buffer_load_dwordx4 v242, s[24:27], s48 offen offset:0 lds
    s_add_u32 m0, s50, 119808
    s_nop 0
    buffer_load_dwordx4 v243, s[24:27], s48 offen offset:0 lds
    s_add_u32 s48, s48, s55
    s_add_u32 m0, s50, 120832
    s_nop 0
    buffer_load_dwordx4 v211, s[24:27], s49 offen offset:0 lds
    s_add_u32 s49, s49, s55
    s_add_u32 m0, s50, 86016
    s_nop 0
    buffer_load_dwordx4 v209, s[20:23], s46 offen offset:0 lds
    s_mul_i32 s55, s60, 393216
    s_add_u32 m0, s50, 87040
    s_nop 0
    buffer_load_dwordx4 v240, s[20:23], s46 offen offset:0 lds
    s_add_u32 m0, s50, 88064
    s_nop 0
    buffer_load_dwordx4 v241, s[20:23], s46 offen offset:0 lds
    s_add_u32 s46, s46, s55
    s_add_u32 m0, s50, 89088
    s_nop 0
    buffer_load_dwordx4 v210, s[24:27], s48 offen offset:0 lds
    s_mul_i32 s55, s60, 458752
    s_add_u32 m0, s50, 90112
    s_nop 0
    buffer_load_dwordx4 v242, s[24:27], s48 offen offset:0 lds
    s_add_u32 m0, s50, 91136
    s_nop 0
    buffer_load_dwordx4 v243, s[24:27], s48 offen offset:0 lds
    s_add_u32 s48, s48, s55
    s_add_u32 m0, s50, 92160
    s_nop 0
    buffer_load_dwordx4 v211, s[24:27], s49 offen offset:0 lds
    s_add_u32 s49, s49, s55
    s_add_u32 m0, s50, 57344
    s_nop 0
    buffer_load_dwordx4 v209, s[20:23], s46 offen offset:0 lds
    s_mul_i32 s55, s61, 393216
    s_add_u32 m0, s50, 58368
    s_nop 0
    buffer_load_dwordx4 v240, s[20:23], s46 offen offset:0 lds
    s_add_u32 m0, s50, 59392
    s_nop 0
    buffer_load_dwordx4 v241, s[20:23], s46 offen offset:0 lds
    s_add_u32 s46, s46, s55
    s_add_u32 m0, s50, 60416
    s_nop 0
    buffer_load_dwordx4 v210, s[24:27], s48 offen offset:0 lds
    s_mul_i32 s55, s61, 458752
    s_add_u32 m0, s50, 61440
    s_nop 0
    buffer_load_dwordx4 v242, s[24:27], s48 offen offset:0 lds
    s_add_u32 m0, s50, 62464
    s_nop 0
    buffer_load_dwordx4 v243, s[24:27], s48 offen offset:0 lds
    s_add_u32 s48, s48, s55
    s_add_u32 m0, s50, 63488
    s_nop 0
    buffer_load_dwordx4 v211, s[24:27], s49 offen offset:0 lds
    s_add_u32 s49, s49, s55
    s_cmp_lg_u32 s40, 1
    s_cbranch_scc1 F_la_5
    s_mov_b64 exec, 1
    global_atomic_add v1, v226, s[100:101] sc1
    s_mov_b64 exec, -1
F_la_5:
    s_cmp_lg_u32 s40, 0
    s_cbranch_scc1 F_lq_4
    s_mov_b32 s83, 0x40000
F_lp_3:
    buffer_load_dword v82, v80, s[36:39], 0 offen sc1
    s_waitcnt vmcnt(0)
    v_cmp_ne_u32 vcc, v81, v82
    s_cmp_eq_u32 vcc_lo, -1
    s_cbranch_scc1 F_lq_4
    s_sub_u32 s83, s83, 1
    s_cbranch_scc1 F_lq_4
    s_and_b32 s53, s83, 7
    s_cbranch_scc1 F_lp_3
    global_load_dword v2, v1, s[100:101] sc1
    s_waitcnt vmcnt(0)
    v_readfirstlane_b32 s53, v2
    s_cmp_lt_u32 s53, 32
    s_cbranch_scc1 F_lp_3
F_lq_4:
    s_barrier
    buffer_load_dwordx4 a[0:3], v208, s[36:39], s51 offen offset:0 sc1
    buffer_load_dwordx4 a[4:7], v208, s[36:39], s51 offen offset:1024 sc1
    buffer_load_dwordx4 a[8:11], v208, s[36:39], s51 offen offset:2048 sc1
    buffer_load_dwordx4 a[12:15], v208, s[36:39], s51 offen offset:3072 sc1
    s_add_u32 s51, s51, 4096
    buffer_load_dwordx4 a[16:19], v208, s[36:39], s51 offen offset:0 sc1
    buffer_load_dwordx4 a[20:23], v208, s[36:39], s51 offen offset:1024 sc1
    buffer_load_dwordx4 a[24:27], v208, s[36:39], s51 offen offset:2048 sc1
    buffer_load_dwordx4 a[28:31], v208, s[36:39], s51 offen offset:3072 sc1
    s_add_u32 s51, s51, s62
    s_barrier
    ds_read_b64_tr_b16 a[192:193], v212 offset:0
    ds_read_b64_tr_b16 a[194:195], v212 offset:768
    ds_read_b64_tr_b16 a[196:197], v212 offset:14336
    ds_read_b64_tr_b16 a[198:199], v212 offset:15104
    ds_read_b64_tr_b16 a[200:201], v213 offset:0
    ds_read_b64_tr_b16 a[202:203], v213 offset:768
    ds_read_b64_tr_b16 a[204:205], v213 offset:14336
    ds_read_b64_tr_b16 a[206:207], v213 offset:15104
    ds_read_b64_tr_b16 a[208:209], v212 offset:64
    ds_read_b64_tr_b16 a[210:211], v212 offset:832
    ds_read_b64_tr_b16 a[212:213], v212 offset:14400
    ds_read_b64_tr_b16 a[214:215], v212 offset:15168
    s_waitcnt vmcnt(0) lgkmcnt(8)
    v_mfma_f32_16x16x32_bf16 v[0:3], a[192:195], a[0:3], 0
    ds_read_b64_tr_b16 a[216:217], v213 offset:64
    v_mfma_f32_16x16x32_bf16 v[0:3], a[196:199], a[16:19], v[0:3]
    ds_read_b64_tr_b16 a[218:219], v213 offset:832
    v_mfma_f32_16x16x32_bf16 v[4:7], a[192:195], a[4:7], 0
    buffer_load_dwordx4 a[32:35], v208, s[36:39], s51 offen offset:0 sc1
    v_mfma_f32_16x16x32_bf16 v[4:7], a[196:199], a[20:23], v[4:7]
    v_mfma_f32_16x16x32_bf16 v[8:11], a[192:195], a[8:11], 0
    ds_read_b64_tr_b16 a[220:221], v213 offset:14400
    v_mfma_f32_16x16x32_bf16 v[8:11], a[196:199], a[24:27], v[8:11]
    ds_read_b64_tr_b16 a[222:223], v213 offset:15168
    v_mfma_f32_16x16x32_bf16 v[12:15], a[192:195], a[12:15], 0
    v_mfma_f32_16x16x32_bf16 v[12:15], a[196:199], a[28:31], v[12:15]
    s_waitcnt lgkmcnt(8)
    v_mfma_f32_16x16x32_bf16 v[28:31], a[200:203], a[12:15], 0
    ds_read_b64_tr_b16 a[224:225], v212 offset:128
    v_mfma_f32_16x16x32_bf16 v[28:31], a[204:207], a[28:31], v[28:31]
    ds_read_b64_tr_b16 a[226:227], v212 offset:896
    v_mfma_f32_16x16x32_bf16 v[24:27], a[200:203], a[8:11], 0
    buffer_load_dwordx4 a[36:39], v208, s[36:39], s51 offen offset:1024 sc1
    v_mfma_f32_16x16x32_bf16 v[24:27], a[204:207], a[24:27], v[24:27]
    v_mfma_f32_16x16x32_bf16 v[20:23], a[200:203], a[4:7], 0
    ds_read_b64_tr_b16 a[228:229], v212 offset:14464
    v_mfma_f32_16x16x32_bf16 v[20:23], a[204:207], a[20:23], v[20:23]
    ds_read_b64_tr_b16 a[230:231], v212 offset:15232
    v_mfma_f32_16x16x32_bf16 v[16:19], a[200:203], a[0:3], 0
    buffer_load_dwordx4 a[40:43], v208, s[36:39], s51 offen offset:2048 sc1
    v_mfma_f32_16x16x32_bf16 v[16:19], a[204:207], a[16:19], v[16:19]
    s_waitcnt lgkmcnt(8)
    v_mfma_f32_16x16x32_bf16 v[32:35], a[208:211], a[0:3], 0
    ds_read_b64_tr_b16 a[192:193], v213 offset:128
    v_mfma_f32_16x16x32_bf16 v[32:35], a[212:215], a[16:19], v[32:35]
    ds_read_b64_tr_b16 a[194:195], v213 offset:896
    v_mfma_f32_16x16x32_bf16 v[36:39], a[208:211], a[4:7], 0
    buffer_load_dwordx4 a[44:47], v208, s[36:39], s51 offen offset:3072 sc1
    v_mfma_f32_16x16x32_bf16 v[36:39], a[212:215], a[20:23], v[36:39]
    s_add_u32 s51, s51, 4096
    v_mfma_f32_16x16x32_bf16 v[40:43], a[208:211], a[8:11], 0
    ds_read_b64_tr_b16 a[196:197], v213 offset:14464
    v_mfma_f32_16x16x32_bf16 v[40:43], a[212:215], a[24:27], v[40:43]
    ds_read_b64_tr_b16 a[198:199], v213 offset:15232
    v_mfma_f32_16x16x32_bf16 v[44:47], a[208:211], a[12:15], 0
    v_mfma_f32_16x16x32_bf16 v[44:47], a[212:215], a[28:31], v[44:47]
    s_waitcnt lgkmcnt(8)
    v_mfma_f32_16x16x32_bf16 v[60:63], a[216:219], a[12:15], 0
    ds_read_b64_tr_b16 a[200:201], v212 offset:3072
    v_mfma_f32_16x16x32_bf16 v[60:63], a[220:223], a[28:31], v[60:63]
    ds_read_b64_tr_b16 a[202:203], v212 offset:3840
    v_mfma_f32_16x16x32_bf16 v[56:59], a[216:219], a[8:11], 0
    buffer_load_dwordx4 a[48:51], v208, s[36:39], s51 offen offset:0 sc1
    v_mfma_f32_16x16x32_bf16 v[56:59], a[220:223], a[24:27], v[56:59]
    v_mfma_f32_16x16x32_bf16 v[52:55], a[216:219], a[4:7], 0
    ds_read_b64_tr_b16 a[204:205], v212 offset:17408
    v_mfma_f32_16x16x32_bf16 v[52:55], a[220:223], a[20:23], v[52:55]
    ds_read_b64_tr_b16 a[206:207], v212 offset:18176
    v_mfma_f32_16x16x32_bf16 v[48:51], a[216:219], a[0:3], 0
    buffer_load_dwordx4 a[52:55], v208, s[36:39], s51 offen offset:1024 sc1
    v_mfma_f32_16x16x32_bf16 v[48:51], a[220:223], a[16:19], v[48:51]
    s_waitcnt lgkmcnt(8)
    v_mfma_f32_16x16x32_bf16 v[64:67], a[0:3], a[224:227], 0
    ds_read_b64_tr_b16 a[208:209], v213 offset:3072
    v_mfma_f32_16x16x32_bf16 v[64:67], a[16:19], a[228:231], v[64:67]
    ds_read_b64_tr_b16 a[210:211], v213 offset:3840
    v_mfma_f32_16x16x32_bf16 v[68:71], a[4:7], a[224:227], 0
    buffer_load_dwordx4 a[56:59], v208, s[36:39], s51 offen offset:2048 sc1
    v_mfma_f32_16x16x32_bf16 v[68:71], a[20:23], a[228:231], v[68:71]
    v_mfma_f32_16x16x32_bf16 v[72:75], a[8:11], a[224:227], 0
    ds_read_b64_tr_b16 a[212:213], v213 offset:17408
    v_mfma_f32_16x16x32_bf16 v[72:75], a[24:27], a[228:231], v[72:75]
    ds_read_b64_tr_b16 a[214:215], v213 offset:18176
    v_mfma_f32_16x16x32_bf16 v[76:79], a[12:15], a[224:227], 0
    buffer_load_dwordx4 a[60:63], v208, s[36:39], s51 offen offset:3072 sc1
    v_mfma_f32_16x16x32_bf16 v[76:79], a[28:31], a[228:231], v[76:79]
    s_waitcnt lgkmcnt(8)
    s_add_u32 s51, s51, s63
    v_mfma_f32_16x16x32_bf16 v[92:95], a[12:15], a[192:195], 0
    ds_read_b64_tr_b16 a[216:217], v212 offset:3136
    v_mfma_f32_16x16x32_bf16 v[92:95], a[28:31], a[196:199], v[92:95]
    ds_read_b64_tr_b16 a[218:219], v212 offset:3904
    v_mfma_f32_16x16x32_bf16 v[88:91], a[8:11], a[192:195], 0
    v_mfma_f32_16x16x32_bf16 v[88:91], a[24:27], a[196:199], v[88:91]
    v_mfma_f32_16x16x32_bf16 v[84:87], a[4:7], a[192:195], 0
    ds_read_b64_tr_b16 a[220:221], v212 offset:17472
    v_mfma_f32_16x16x32_bf16 v[84:87], a[20:23], a[196:199], v[84:87]
    ds_read_b64_tr_b16 a[222:223], v212 offset:18240
    v_mfma_f32_16x16x32_bf16 v[80:83], a[0:3], a[192:195], 0
    buffer_load_dwordx4 a[64:67], v208, s[36:39], s51 offen offset:0 sc1
    v_mfma_f32_16x16x32_bf16 v[80:83], a[16:19], a[196:199], v[80:83]
    s_waitcnt lgkmcnt(8)
    v_mfma_f32_16x16x32_bf16 v[96:99], a[200:203], a[0:3], 0
    ds_read_b64_tr_b16 a[224:225], v213 offset:3136
    v_mfma_f32_16x16x32_bf16 v[96:99], a[204:207], a[16:19], v[96:99]
    ds_read_b64_tr_b16 a[226:227], v213 offset:3904
    v_mfma_f32_16x16x32_bf16 v[100:103], a[200:203], a[4:7], 0
    buffer_load_dwordx4 a[68:71], v208, s[36:39], s51 offen offset:1024 sc1
    v_mfma_f32_16x16x32_bf16 v[100:103], a[204:207], a[20:23], v[100:103]
    v_mfma_f32_16x16x32_bf16 v[104:107], a[200:203], a[8:11], 0
    ds_read_b64_tr_b16 a[228:229], v213 offset:17472
    v_mfma_f32_16x16x32_bf16 v[104:107], a[204:207], a[24:27], v[104:107]
    ds_read_b64_tr_b16 a[230:231], v213 offset:18240
    v_mfma_f32_16x16x32_bf16 v[108:111], a[200:203], a[12:15], 0
    buffer_load_dwordx4 a[72:75], v208, s[36:39], s51 offen offset:2048 sc1
    v_mfma_f32_16x16x32_bf16 v[108:111], a[204:207], a[28:31], v[108:111]
    s_waitcnt lgkmcnt(8)
    v_mfma_f32_16x16x32_bf16 v[124:127], a[208:211], a[12:15], 0
    ds_read_b64_tr_b16 a[192:193], v212 offset:3200
    v_mfma_f32_16x16x32_bf16 v[124:127], a[212:215], a[28:31], v[124:127]
    ds_read_b64_tr_b16 a[194:195], v212 offset:3968
    v_mfma_f32_16x16x32_bf16 v[120:123], a[208:211], a[8:11], 0
    v_mfma_f32_16x16x32_bf16 v[120:123], a[212:215], a[24:27], v[120:123]
    v_mfma_f32_16x16x32_bf16 v[116:119], a[208:211], a[4:7], 0
    ds_read_b64_tr_b16 a[196:197], v212 offset:17536
    v_mfma_f32_16x16x32_bf16 v[116:119], a[212:215], a[20:23], v[116:119]
    ds_read_b64_tr_b16 a[198:199], v212 offset:18304
    v_mfma_f32_16x16x32_bf16 v[112:115], a[208:211], a[0:3], 0
    buffer_load_dwordx4 a[76:79], v208, s[36:39], s51 offen offset:3072 sc1
    v_mfma_f32_16x16x32_bf16 v[112:115], a[212:215], a[16:19], v[112:115]
    s_waitcnt lgkmcnt(8)
    s_add_u32 s51, s51, 4096
    v_mfma_f32_16x16x32_bf16 v[128:131], a[216:219], a[0:3], 0
    ds_read_b64_tr_b16 a[200:201], v213 offset:3200
    v_mfma_f32_16x16x32_bf16 v[128:131], a[220:223], a[16:19], v[128:131]
    ds_read_b64_tr_b16 a[202:203], v213 offset:3968
    v_mfma_f32_16x16x32_bf16 v[132:135], a[216:219], a[4:7], 0
    buffer_load_dwordx4 a[80:83], v208, s[36:39], s51 offen offset:0 sc1
    v_mfma_f32_16x16x32_bf16 v[132:135], a[220:223], a[20:23], v[132:135]
    v_mfma_f32_16x16x32_bf16 v[136:139], a[216:219], a[8:11], 0
    ds_read_b64_tr_b16 a[204:205], v213 offset:17536
    v_mfma_f32_16x16x32_bf16 v[136:139], a[220:223], a[24:27], v[136:139]
    ds_read_b64_tr_b16 a[206:207], v213 offset:18304
    v_mfma_f32_16x16x32_bf16 v[140:143], a[216:219], a[12:15], 0
    buffer_load_dwordx4 a[84:87], v208, s[36:39], s51 offen offset:1024 sc1
    v_mfma_f32_16x16x32_bf16 v[140:143], a[220:223], a[28:31], v[140:143]
    s_waitcnt lgkmcnt(8)
    v_mfma_f32_16x16x32_bf16 v[156:159], a[224:227], a[12:15], 0
    ds_read_b64_tr_b16 a[208:209], v214 offset:6144
    v_mfma_f32_16x16x32_bf16 v[156:159], a[228:231], a[28:31], v[156:159]
    ds_read_b64_tr_b16 a[210:211], v214 offset:6400
    v_mfma_f32_16x16x32_bf16 v[152:155], a[224:227], a[8:11], 0
    buffer_load_dwordx4 a[88:91], v208, s[36:39], s51 offen offset:2048 sc1
    v_mfma_f32_16x16x32_bf16 v[152:155], a[228:231], a[24:27], v[152:155]
    v_mfma_f32_16x16x32_bf16 v[148:151], a[224:227], a[4:7], 0
    ds_read_b64_tr_b16 a[212:213], v214 offset:20480
    v_mfma_f32_16x16x32_bf16 v[148:151], a[228:231], a[20:23], v[148:151]
    ds_read_b64_tr_b16 a[214:215], v214 offset:20736
    v_mfma_f32_16x16x32_bf16 v[144:147], a[224:227], a[0:3], 0
    v_mfma_f32_16x16x32_bf16 v[144:147], a[228:231], a[16:19], v[144:147]
    s_waitcnt lgkmcnt(8)
    s_barrier
    v_mfma_f32_16x16x32_bf16 v[160:163], a[192:195], a[0:3], 0
    ds_read_b64_tr_b16 a[216:217], v218 offset:0
    v_mfma_f32_16x16x32_bf16 v[160:163], a[196:199], a[16:19], v[160:163]
    ds_read_b64_tr_b16 a[218:219], v218 offset:768
    v_mfma_f32_16x16x32_bf16 v[164:167], a[192:195], a[4:7], 0
    buffer_load_dwordx4 a[92:95], v208, s[36:39], s51 offen offset:3072 sc1
    v_mfma_f32_16x16x32_bf16 v[164:167], a[196:199], a[20:23], v[164:167]
    s_add_u32 s51, s51, s64
    v_mfma_f32_16x16x32_bf16 v[168:171], a[192:195], a[8:11], 0
    ds_read_b64_tr_b16 a[220:221], v218 offset:14336
    v_mfma_f32_16x16x32_bf16 v[168:171], a[196:199], a[24:27], v[168:171]
    ds_read_b64_tr_b16 a[222:223], v218 offset:15104
    v_mfma_f32_16x16x32_bf16 v[172:175], a[192:195], a[12:15], 0
    buffer_load_dwordx4 a[96:99], v208, s[36:39], s51 offen offset:0 sc1
    v_mfma_f32_16x16x32_bf16 v[172:175], a[196:199], a[28:31], v[172:175]
    s_waitcnt lgkmcnt(8)
    v_mfma_f32_16x16x32_bf16 v[188:191], a[200:203], a[12:15], 0
    ds_read_b64_tr_b16 a[224:225], v219 offset:0
    v_mfma_f32_16x16x32_bf16 v[188:191], a[204:207], a[28:31], v[188:191]
    ds_read_b64_tr_b16 a[226:227], v219 offset:768
    v_mfma_f32_16x16x32_bf16 v[184:187], a[200:203], a[8:11], 0
    buffer_load_dwordx4 a[100:103], v208, s[36:39], s51 offen offset:1024 sc1
    v_mfma_f32_16x16x32_bf16 v[184:187], a[204:207], a[24:27], v[184:187]
    v_mfma_f32_16x16x32_bf16 v[180:183], a[200:203], a[4:7], 0
    ds_read_b64_tr_b16 a[228:229], v219 offset:14336
    v_mfma_f32_16x16x32_bf16 v[180:183], a[204:207], a[20:23], v[180:183]
    ds_read_b64_tr_b16 a[230:231], v219 offset:15104
    v_mfma_f32_16x16x32_bf16 v[176:179], a[200:203], a[0:3], 0
    v_mfma_f32_16x16x32_bf16 v[176:179], a[204:207], a[16:19], v[176:179]
    s_waitcnt lgkmcnt(8)
    v_mfma_f32_16x16x32_bf16 v[192:195], a[208:211], a[0:3], 0
    ds_read_b64_tr_b16 a[192:193], v218 offset:64
    v_mfma_f32_16x16x32_bf16 v[192:195], a[212:215], a[16:19], v[192:195]
    ds_read_b64_tr_b16 a[194:195], v218 offset:832
    v_mfma_f32_16x16x32_bf16 v[196:199], a[208:211], a[4:7], 0
    buffer_load_dwordx4 a[104:107], v208, s[36:39], s51 offen offset:2048 sc1
    v_mfma_f32_16x16x32_bf16 v[196:199], a[212:215], a[20:23], v[196:199]
    v_mfma_f32_16x16x32_bf16 v[200:203], a[208:211], a[8:11], 0
    ds_read_b64_tr_b16 a[196:197], v218 offset:14400
    v_mfma_f32_16x16x32_bf16 v[200:203], a[212:215], a[24:27], v[200:203]
    ds_read_b64_tr_b16 a[198:199], v218 offset:15168
    v_mfma_f32_16x16x32_bf16 v[204:207], a[208:211], a[12:15], 0
    buffer_load_dwordx4 a[108:111], v208, s[36:39], s51 offen offset:3072 sc1
    v_mfma_f32_16x16x32_bf16 v[204:207], a[212:215], a[28:31], v[204:207]
    s_waitcnt vmcnt(12) lgkmcnt(8)
    s_add_u32 s51, s51, 4096
    v_mfma_f32_16x16x32_bf16 v[12:15], a[216:219], a[44:47], v[12:15]
    ds_read_b64_tr_b16 a[200:201], v219 offset:64
    v_mfma_f32_16x16x32_bf16 v[12:15], a[220:223], a[60:63], v[12:15]
    ds_read_b64_tr_b16 a[202:203], v219 offset:832
    v_mfma_f32_16x16x32_bf16 v[8:11], a[220:223], a[56:59], v[8:11]
    buffer_load_dwordx4 a[112:115], v208, s[36:39], s51 offen offset:0 sc1
    v_mfma_f32_16x16x32_bf16 v[8:11], a[216:219], a[40:43], v[8:11]
    v_mfma_f32_16x16x32_bf16 v[4:7], a[216:219], a[36:39], v[4:7]
    ds_read_b64_tr_b16 a[204:205], v219 offset:14400
    v_mfma_f32_16x16x32_bf16 v[4:7], a[220:223], a[52:55], v[4:7]
    ds_read_b64_tr_b16 a[206:207], v219 offset:15168
    v_mfma_f32_16x16x32_bf16 v[0:3], a[220:223], a[48:51], v[0:3]
    buffer_load_dwordx4 a[116:119], v208, s[36:39], s51 offen offset:1024 sc1
    v_mfma_f32_16x16x32_bf16 v[0:3], a[216:219], a[32:35], v[0:3]
    s_waitcnt lgkmcnt(8)
    v_mfma_f32_16x16x32_bf16 v[16:19], a[224:227], a[32:35], v[16:19]
    ds_read_b64_tr_b16 a[208:209], v218 offset:128
    v_mfma_f32_16x16x32_bf16 v[16:19], a[228:231], a[48:51], v[16:19]
    ds_read_b64_tr_b16 a[210:211], v218 offset:896
    v_mfma_f32_16x16x32_bf16 v[20:23], a[228:231], a[52:55], v[20:23]
    v_mfma_f32_16x16x32_bf16 v[20:23], a[224:227], a[36:39], v[20:23]
    v_mfma_f32_16x16x32_bf16 v[24:27], a[224:227], a[40:43], v[24:27]
    ds_read_b64_tr_b16 a[212:213], v218 offset:14464
    v_mfma_f32_16x16x32_bf16 v[24:27], a[228:231], a[56:59], v[24:27]
    ds_read_b64_tr_b16 a[214:215], v218 offset:15232
    v_mfma_f32_16x16x32_bf16 v[28:31], a[228:231], a[60:63], v[28:31]
    buffer_load_dwordx4 a[120:123], v208, s[36:39], s51 offen offset:2048 sc1
    v_mfma_f32_16x16x32_bf16 v[28:31], a[224:227], a[44:47], v[28:31]
    s_waitcnt lgkmcnt(8)
    v_mfma_f32_16x16x32_bf16 v[44:47], a[192:195], a[44:47], v[44:47]
    ds_read_b64_tr_b16 a[216:217], v219 offset:128
    v_mfma_f32_16x16x32_bf16 v[44:47], a[196:199], a[60:63], v[44:47]
    ds_read_b64_tr_b16 a[218:219], v219 offset:896
    v_mfma_f32_16x16x32_bf16 v[40:43], a[196:199], a[56:59], v[40:43]
    buffer_load_dwordx4 a[124:127], v208, s[36:39], s51 offen offset:3072 sc1
    v_mfma_f32_16x16x32_bf16 v[40:43], a[192:195], a[40:43], v[40:43]
    s_add_u32 s51, s51, s65
    v_mfma_f32_16x16x32_bf16 v[36:39], a[192:195], a[36:39], v[36:39]
    ds_read_b64_tr_b16 a[220:221], v219 offset:14464
    v_mfma_f32_16x16x32_bf16 v[36:39], a[196:199], a[52:55], v[36:39]
    s_add_u32 m0, s50, 28672
    ds_read_b64_tr_b16 a[222:223], v219 offset:15232
    v_mfma_f32_16x16x32_bf16 v[32:35], a[196:199], a[48:51], v[32:35]
    buffer_load_dwordx4 v209, s[20:23], s46 offen offset:0 lds
    v_mfma_f32_16x16x32_bf16 v[32:35], a[192:195], a[32:35], v[32:35]
    s_waitcnt lgkmcnt(8)
    s_mul_i32 s55, s58, 393216
    v_mfma_f32_16x16x32_bf16 v[48:51], a[200:203], a[32:35], v[48:51]
    ds_read_b64_tr_b16 a[224:225], v218 offset:3072
    v_mfma_f32_16x16x32_bf16 v[48:51], a[204:207], a[48:51], v[48:51]
    ds_read_b64_tr_b16 a[226:227], v218 offset:3840
    v_mfma_f32_16x16x32_bf16 v[52:55], a[204:207], a[52:55], v[52:55]
    v_mfma_f32_16x16x32_bf16 v[52:55], a[200:203], a[36:39], v[52:55]
    v_mfma_f32_16x16x32_bf16 v[56:59], a[200:203], a[40:43], v[56:59]
    ds_read_b64_tr_b16 a[228:229], v218 offset:17408
    v_mfma_f32_16x16x32_bf16 v[56:59], a[204:207], a[56:59], v[56:59]
    ds_read_b64_tr_b16 a[230:231], v218 offset:18176
    v_mfma_f32_16x16x32_bf16 v[60:63], a[204:207], a[60:63], v[60:63]
    v_mfma_f32_16x16x32_bf16 v[60:63], a[200:203], a[44:47], v[60:63]
    s_waitcnt lgkmcnt(8)
    v_mfma_f32_16x16x32_bf16 v[76:79], a[44:47], a[208:211], v[76:79]
    ds_read_b64_tr_b16 a[192:193], v219 offset:3072
    v_mfma_f32_16x16x32_bf16 v[76:79], a[60:63], a[212:215], v[76:79]
    s_add_u32 m0, s50, 29696
    ds_read_b64_tr_b16 a[194:195], v219 offset:3840
    v_mfma_f32_16x16x32_bf16 v[72:75], a[56:59], a[212:215], v[72:75]
    buffer_load_dwordx4 v240, s[20:23], s46 offen offset:0 lds
    v_mfma_f32_16x16x32_bf16 v[72:75], a[40:43], a[208:211], v[72:75]
    v_mfma_f32_16x16x32_bf16 v[68:71], a[36:39], a[208:211], v[68:71]
    ds_read_b64_tr_b16 a[196:197], v219 offset:17408
    v_mfma_f32_16x16x32_bf16 v[68:71], a[52:55], a[212:215], v[68:71]
    ds_read_b64_tr_b16 a[198:199], v219 offset:18176
    v_mfma_f32_16x16x32_bf16 v[64:67], a[48:51], a[212:215], v[64:67]
    v_mfma_f32_16x16x32_bf16 v[64:67], a[32:35], a[208:211], v[64:67]
    s_waitcnt lgkmcnt(8)
    v_mfma_f32_16x16x32_bf16 v[80:83], a[32:35], a[216:219], v[80:83]
    ds_read_b64_tr_b16 a[200:201], v218 offset:3136
    v_mfma_f32_16x16x32_bf16 v[80:83], a[48:51], a[220:223], v[80:83]
    s_add_u32 m0, s50, 30720
    ds_read_b64_tr_b16 a[202:203], v218 offset:3904
    v_mfma_f32_16x16x32_bf16 v[84:87], a[52:55], a[220:223], v[84:87]
    buffer_load_dwordx4 v241, s[20:23], s46 offen offset:0 lds
    v_mfma_f32_16x16x32_bf16 v[84:87], a[36:39], a[216:219], v[84:87]
    s_add_u32 s46, s46, s55
    v_mfma_f32_16x16x32_bf16 v[88:91], a[40:43], a[216:219], v[88:91]
    ds_read_b64_tr_b16 a[204:205], v218 offset:17472
    v_mfma_f32_16x16x32_bf16 v[88:91], a[56:59], a[220:223], v[88:91]
    ds_read_b64_tr_b16 a[206:207], v218 offset:18240
    v_mfma_f32_16x16x32_bf16 v[92:95], a[60:63], a[220:223], v[92:95]
    v_mfma_f32_16x16x32_bf16 v[92:95], a[44:47], a[216:219], v[92:95]
    s_waitcnt lgkmcnt(8)
    v_mfma_f32_16x16x32_bf16 v[108:111], a[224:227], a[44:47], v[108:111]
    ds_read_b64_tr_b16 a[208:209], v219 offset:3136
    v_mfma_f32_16x16x32_bf16 v[108:111], a[228:231], a[60:63], v[108:111]
    ds_read_b64_tr_b16 a[210:211], v219 offset:3904
    v_mfma_f32_16x16x32_bf16 v[104:107], a[228:231], a[56:59], v[104:107]
    v_mfma_f32_16x16x32_bf16 v[104:107], a[224:227], a[40:43], v[104:107]
    v_mfma_f32_16x16x32_bf16 v[100:103], a[224:227], a[36:39], v[100:103]
    ds_read_b64_tr_b16 a[212:213], v219 offset:17472
    v_mfma_f32_16x16x32_bf16 v[100:103], a[228:231], a[52:55], v[100:103]
    s_add_u32 m0, s50, 31744
    ds_read_b64_tr_b16 a[214:215], v219 offset:18240
    v_mfma_f32_16x16x32_bf16 v[96:99], a[228:231], a[48:51], v[96:99]
    buffer_load_dwordx4 v210, s[24:27], s48 offen offset:0 lds
    v_mfma_f32_16x16x32_bf16 v[96:99], a[224:227], a[32:35], v[96:99]
    s_waitcnt lgkmcnt(8)
    s_mul_i32 s55, s58, 458752
    v_mfma_f32_16x16x32_bf16 v[112:115], a[192:195], a[32:35], v[112:115]
    ds_read_b64_tr_b16 a[216:217], v218 offset:3200
    v_mfma_f32_16x16x32_bf16 v[112:115], a[196:199], a[48:51], v[112:115]
    ds_read_b64_tr_b16 a[218:219], v218 offset:3968
    v_mfma_f32_16x16x32_bf16 v[116:119], a[196:199], a[52:55], v[116:119]
    v_mfma_f32_16x16x32_bf16 v[116:119], a[192:195], a[36:39], v[116:119]
    v_mfma_f32_16x16x32_bf16 v[120:123], a[192:195], a[40:43], v[120:123]
    ds_read_b64_tr_b16 a[220:221], v218 offset:17536
    v_mfma_f32_16x16x32_bf16 v[120:123], a[196:199], a[56:59], v[120:123]
    ds_read_b64_tr_b16 a[222:223], v218 offset:18304
    v_mfma_f32_16x16x32_bf16 v[124:127], a[196:199], a[60:63], v[124:127]
    v_mfma_f32_16x16x32_bf16 v[124:127], a[192:195], a[44:47], v[124:127]
    s_waitcnt lgkmcnt(8)
    v_mfma_f32_16x16x32_bf16 v[140:143], a[200:203], a[44:47], v[140:143]
    ds_read_b64_tr_b16 a[224:225], v219 offset:3200
    v_mfma_f32_16x16x32_bf16 v[140:143], a[204:207], a[60:63], v[140:143]
    s_add_u32 m0, s50, 32768
    ds_read_b64_tr_b16 a[226:227], v219 offset:3968
    v_mfma_f32_16x16x32_bf16 v[136:139], a[204:207], a[56:59], v[136:139]
    buffer_load_dwordx4 v242, s[24:27], s48 offen offset:0 lds
    v_mfma_f32_16x16x32_bf16 v[136:139], a[200:203], a[40:43], v[136:139]
    v_mfma_f32_16x16x32_bf16 v[132:135], a[200:203], a[36:39], v[132:135]
    ds_read_b64_tr_b16 a[228:229], v219 offset:17536
    v_mfma_f32_16x16x32_bf16 v[132:135], a[204:207], a[52:55], v[132:135]
    ds_read_b64_tr_b16 a[230:231], v219 offset:18304
    v_mfma_f32_16x16x32_bf16 v[128:131], a[204:207], a[48:51], v[128:131]
    v_mfma_f32_16x16x32_bf16 v[128:131], a[200:203], a[32:35], v[128:131]
    s_waitcnt lgkmcnt(8)
    v_mfma_f32_16x16x32_bf16 v[144:147], a[208:211], a[32:35], v[144:147]
    ds_read_b64_tr_b16 a[192:193], v220 offset:6144
    v_mfma_f32_16x16x32_bf16 v[144:147], a[212:215], a[48:51], v[144:147]
    s_add_u32 m0, s50, 33792
    ds_read_b64_tr_b16 a[194:195], v220 offset:6400
    v_mfma_f32_16x16x32_bf16 v[148:151], a[212:215], a[52:55], v[148:151]
    buffer_load_dwordx4 v243, s[24:27], s48 offen offset:0 lds
    v_mfma_f32_16x16x32_bf16 v[148:151], a[208:211], a[36:39], v[148:151]
    s_add_u32 s48, s48, s55
    v_mfma_f32_16x16x32_bf16 v[152:155], a[208:211], a[40:43], v[152:155]
    ds_read_b64_tr_b16 a[196:197], v220 offset:20480
    v_mfma_f32_16x16x32_bf16 v[152:155], a[212:215], a[56:59], v[152:155]
    ds_read_b64_tr_b16 a[198:199], v220 offset:20736
    v_mfma_f32_16x16x32_bf16 v[156:159], a[212:215], a[60:63], v[156:159]
    v_mfma_f32_16x16x32_bf16 v[156:159], a[208:211], a[44:47], v[156:159]
    s_waitcnt lgkmcnt(8)
    s_barrier
    v_mfma_f32_16x16x32_bf16 v[172:175], a[216:219], a[44:47], v[172:175]
    ds_read_b64_tr_b16 a[200:201], v215 offset:28672
    v_mfma_f32_16x16x32_bf16 v[172:175], a[220:223], a[60:63], v[172:175]
    ds_read_b64_tr_b16 a[202:203], v215 offset:29440
    v_mfma_f32_16x16x32_bf16 v[168:171], a[220:223], a[56:59], v[168:171]
    v_mfma_f32_16x16x32_bf16 v[168:171], a[216:219], a[40:43], v[168:171]
    v_mfma_f32_16x16x32_bf16 v[164:167], a[216:219], a[36:39], v[164:167]
    ds_read_b64_tr_b16 a[204:205], v215 offset:43008
    v_mfma_f32_16x16x32_bf16 v[164:167], a[220:223], a[52:55], v[164:167]
    s_add_u32 m0, s50, 34816
    ds_read_b64_tr_b16 a[206:207], v215 offset:43776
    v_mfma_f32_16x16x32_bf16 v[160:163], a[220:223], a[48:51], v[160:163]
    buffer_load_dwordx4 v211, s[24:27], s49 offen offset:0 lds
    v_mfma_f32_16x16x32_bf16 v[160:163], a[216:219], a[32:35], v[160:163]
    s_waitcnt lgkmcnt(8)
    s_add_u32 s49, s49, s55
    v_mfma_f32_16x16x32_bf16 v[176:179], a[224:227], a[32:35], v[176:179]
    ds_read_b64_tr_b16 a[208:209], v216 offset:28672
    v_mfma_f32_16x16x32_bf16 v[176:179], a[228:231], a[48:51], v[176:179]
    ds_read_b64_tr_b16 a[210:211], v216 offset:29440
    v_mfma_f32_16x16x32_bf16 v[180:183], a[228:231], a[52:55], v[180:183]
    v_mfma_f32_16x16x32_bf16 v[180:183], a[224:227], a[36:39], v[180:183]
    v_mfma_f32_16x16x32_bf16 v[184:187], a[224:227], a[40:43], v[184:187]
    ds_read_b64_tr_b16 a[212:213], v216 offset:43008
    v_mfma_f32_16x16x32_bf16 v[184:187], a[228:231], a[56:59], v[184:187]
    ds_read_b64_tr_b16 a[214:215], v216 offset:43776
    v_mfma_f32_16x16x32_bf16 v[188:191], a[228:231], a[60:63], v[188:191]
    buffer_load_dwordx4 a[128:131], v208, s[36:39], s51 offen offset:0 sc1
    v_mfma_f32_16x16x32_bf16 v[188:191], a[224:227], a[44:47], v[188:191]
    s_waitcnt lgkmcnt(8)
    v_mfma_f32_16x16x32_bf16 v[204:207], a[192:195], a[44:47], v[204:207]
    ds_read_b64_tr_b16 a[216:217], v215 offset:28736
    v_mfma_f32_16x16x32_bf16 v[204:207], a[196:199], a[60:63], v[204:207]
    ds_read_b64_tr_b16 a[218:219], v215 offset:29504
    v_mfma_f32_16x16x32_bf16 v[200:203], a[196:199], a[56:59], v[200:203]
    v_mfma_f32_16x16x32_bf16 v[200:203], a[192:195], a[40:43], v[200:203]
    v_mfma_f32_16x16x32_bf16 v[196:199], a[192:195], a[36:39], v[196:199]
    ds_read_b64_tr_b16 a[220:221], v215 offset:43072
    v_mfma_f32_16x16x32_bf16 v[196:199], a[196:199], a[52:55], v[196:199]
    ds_read_b64_tr_b16 a[222:223], v215 offset:43840
    v_mfma_f32_16x16x32_bf16 v[192:195], a[196:199], a[48:51], v[192:195]
    v_mfma_f32_16x16x32_bf16 v[192:195], a[192:195], a[32:35], v[192:195]
    s_waitcnt vmcnt(16) lgkmcnt(8)
    v_mfma_f32_16x16x32_bf16 v[0:3], a[200:203], a[64:67], v[0:3]
    ds_read_b64_tr_b16 a[224:225], v216 offset:28736
    v_mfma_f32_16x16x32_bf16 v[0:3], a[204:207], a[80:83], v[0:3]
    ds_read_b64_tr_b16 a[226:227], v216 offset:29504
    v_mfma_f32_16x16x32_bf16 v[4:7], a[204:207], a[84:87], v[4:7]
    buffer_load_dwordx4 a[132:135], v208, s[36:39], s51 offen offset:1024 sc1
    v_mfma_f32_16x16x32_bf16 v[4:7], a[200:203], a[68:71], v[4:7]
    v_mfma_f32_16x16x32_bf16 v[8:11], a[200:203], a[72:75], v[8:11]
    ds_read_b64_tr_b16 a[228:229], v216 offset:43072
    v_mfma_f32_16x16x32_bf16 v[8:11], a[204:207], a[88:91], v[8:11]
    ds_read_b64_tr_b16 a[230:231], v216 offset:43840
    v_mfma_f32_16x16x32_bf16 v[12:15], a[204:207], a[92:95], v[12:15]
    v_mfma_f32_16x16x32_bf16 v[12:15], a[200:203], a[76:79], v[12:15]
    s_waitcnt lgkmcnt(8)
    v_mfma_f32_16x16x32_bf16 v[28:31], a[208:211], a[76:79], v[28:31]
    ds_read_b64_tr_b16 a[192:193], v215 offset:28800
    v_mfma_f32_16x16x32_bf16 v[28:31], a[212:215], a[92:95], v[28:31]
    ds_read_b64_tr_b16 a[194:195], v215 offset:29568
    v_mfma_f32_16x16x32_bf16 v[24:27], a[212:215], a[88:91], v[24:27]
    buffer_load_dwordx4 a[136:139], v208, s[36:39], s51 offen offset:2048 sc1
    v_mfma_f32_16x16x32_bf16 v[24:27], a[208:211], a[72:75], v[24:27]
    v_mfma_f32_16x16x32_bf16 v[20:23], a[208:211], a[68:71], v[20:23]
    ds_read_b64_tr_b16 a[196:197], v215 offset:43136
    v_mfma_f32_16x16x32_bf16 v[20:23], a[212:215], a[84:87], v[20:23]
    ds_read_b64_tr_b16 a[198:199], v215 offset:43904
    v_mfma_f32_16x16x32_bf16 v[16:19], a[212:215], a[80:83], v[16:19]
    v_mfma_f32_16x16x32_bf16 v[16:19], a[208:211], a[64:67], v[16:19]
    s_waitcnt lgkmcnt(8)
    v_mfma_f32_16x16x32_bf16 v[32:35], a[216:219], a[64:67], v[32:35]
    ds_read_b64_tr_b16 a[200:201], v216 offset:28800
    v_mfma_f32_16x16x32_bf16 v[32:35], a[220:223], a[80:83], v[32:35]
    ds_read_b64_tr_b16 a[202:203], v216 offset:29568
    v_mfma_f32_16x16x32_bf16 v[36:39], a[220:223], a[84:87], v[36:39]
    v_mfma_f32_16x16x32_bf16 v[36:39], a[216:219], a[68:71], v[36:39]
    v_mfma_f32_16x16x32_bf16 v[40:43], a[216:219], a[72:75], v[40:43]
    ds_read_b64_tr_b16 a[204:205], v216 offset:43136
    v_mfma_f32_16x16x32_bf16 v[40:43], a[220:223], a[88:91], v[40:43]
    ds_read_b64_tr_b16 a[206:207], v216 offset:43904
    v_mfma_f32_16x16x32_bf16 v[44:47], a[220:223], a[92:95], v[44:47]
    buffer_load_dwordx4 a[140:143], v208, s[36:39], s51 offen offset:3072 sc1
    v_mfma_f32_16x16x32_bf16 v[44:47], a[216:219], a[76:79], v[44:47]
    s_waitcnt lgkmcnt(8)
    s_add_u32 s51, s51, 4096
    v_mfma_f32_16x16x32_bf16 v[60:63], a[224:227], a[76:79], v[60:63]
    ds_read_b64_tr_b16 a[208:209], v215 offset:31744
    v_mfma_f32_16x16x32_bf16 v[60:63], a[228:231], a[92:95], v[60:63]
    ds_read_b64_tr_b16 a[210:211], v215 offset:32512
    v_mfma_f32_16x16x32_bf16 v[56:59], a[228:231], a[88:91], v[56:59]
    v_mfma_f32_16x16x32_bf16 v[56:59], a[224:227], a[72:75], v[56:59]
    v_mfma_f32_16x16x32_bf16 v[52:55], a[224:227], a[68:71], v[52:55]
    ds_read_b64_tr_b16 a[212:213], v215 offset:46080
    v_mfma_f32_16x16x32_bf16 v[52:55], a[228:231], a[84:87], v[52:55]
    ds_read_b64_tr_b16 a[214:215], v215 offset:46848
    v_mfma_f32_16x16x32_bf16 v[48:51], a[228:231], a[80:83], v[48:51]
    v_mfma_f32_16x16x32_bf16 v[48:51], a[224:227], a[64:67], v[48:51]
    s_waitcnt lgkmcnt(8)
    s_cmp_lg_u32 s52, 0
    s_cbranch_scc1 F_pw_6
    s_xor_b32 s53, s2, 1
    s_lshl_b32 s53, s53, 2
    s_add_u32 s53, s53, s40
    s_mul_i32 s54, s53, 7168
    buffer_load_dword a255, v231, s[28:31], s54 offen
    s_lshl_b32 s54, s53, 11
    s_mov_b64 exec, 0xffff
    buffer_load_dword a254, v231, s[32:35], s54 offen
    s_mov_b64 exec, -1
F_pw_6:
    v_mfma_f32_16x16x32_bf16 v[64:67], a[64:67], a[192:195], v[64:67]
    ds_read_b64_tr_b16 a[216:217], v216 offset:31744
    v_mfma_f32_16x16x32_bf16 v[64:67], a[80:83], a[196:199], v[64:67]
    ds_read_b64_tr_b16 a[218:219], v216 offset:32512
    v_mfma_f32_16x16x32_bf16 v[68:71], a[84:87], a[196:199], v[68:71]
    buffer_load_dwordx4 a[144:147], v208, s[36:39], s51 offen offset:0 sc1
    v_mfma_f32_16x16x32_bf16 v[68:71], a[68:71], a[192:195], v[68:71]
    v_mfma_f32_16x16x32_bf16 v[72:75], a[72:75], a[192:195], v[72:75]
    ds_read_b64_tr_b16 a[220:221], v216 offset:46080
    v_mfma_f32_16x16x32_bf16 v[72:75], a[88:91], a[196:199], v[72:75]
    ds_read_b64_tr_b16 a[222:223], v216 offset:46848
    v_mfma_f32_16x16x32_bf16 v[76:79], a[92:95], a[196:199], v[76:79]
    v_mfma_f32_16x16x32_bf16 v[76:79], a[76:79], a[192:195], v[76:79]
    s_waitcnt lgkmcnt(8)
    v_mfma_f32_16x16x32_bf16 v[92:95], a[76:79], a[200:203], v[92:95]
    ds_read_b64_tr_b16 a[224:225], v215 offset:31808
    v_mfma_f32_16x16x32_bf16 v[92:95], a[92:95], a[204:207], v[92:95]
    ds_read_b64_tr_b16 a[226:227], v215 offset:32576
    v_mfma_f32_16x16x32_bf16 v[88:91], a[88:91], a[204:207], v[88:91]
    buffer_load_dwordx4 a[148:151], v208, s[36:39], s51 offen offset:1024 sc1
    v_mfma_f32_16x16x32_bf16 v[88:91], a[72:75], a[200:203], v[88:91]
    v_mfma_f32_16x16x32_bf16 v[84:87], a[68:71], a[200:203], v[84:87]
    ds_read_b64_tr_b16 a[228:229], v215 offset:46144
    v_mfma_f32_16x16x32_bf16 v[84:87], a[84:87], a[204:207], v[84:87]
    ds_read_b64_tr_b16 a[230:231], v215 offset:46912
    v_mfma_f32_16x16x32_bf16 v[80:83], a[80:83], a[204:207], v[80:83]
    v_mfma_f32_16x16x32_bf16 v[80:83], a[64:67], a[200:203], v[80:83]
    s_waitcnt lgkmcnt(8)
    v_mfma_f32_16x16x32_bf16 v[96:99], a[208:211], a[64:67], v[96:99]
    ds_read_b64_tr_b16 a[192:193], v216 offset:31808
    v_mfma_f32_16x16x32_bf16 v[96:99], a[212:215], a[80:83], v[96:99]
    ds_read_b64_tr_b16 a[194:195], v216 offset:32576
    v_mfma_f32_16x16x32_bf16 v[100:103], a[212:215], a[84:87], v[100:103]
    v_mfma_f32_16x16x32_bf16 v[100:103], a[208:211], a[68:71], v[100:103]
    v_mfma_f32_16x16x32_bf16 v[104:107], a[208:211], a[72:75], v[104:107]
    ds_read_b64_tr_b16 a[196:197], v216 offset:46144
    v_mfma_f32_16x16x32_bf16 v[104:107], a[212:215], a[88:91], v[104:107]
    ds_read_b64_tr_b16 a[198:199], v216 offset:46912
    v_mfma_f32_16x16x32_bf16 v[108:111], a[212:215], a[92:95], v[108:111]
    buffer_load_dwordx4 a[152:155], v208, s[36:39], s51 offen offset:2048 sc1
    v_mfma_f32_16x16x32_bf16 v[108:111], a[208:211], a[76:79], v[108:111]
    s_waitcnt lgkmcnt(8)
    v_mfma_f32_16x16x32_bf16 v[124:127], a[216:219], a[76:79], v[124:127]
    ds_read_b64_tr_b16 a[200:201], v215 offset:31872
    v_mfma_f32_16x16x32_bf16 v[124:127], a[220:223], a[92:95], v[124:127]
    ds_read_b64_tr_b16 a[202:203], v215 offset:32640
    v_mfma_f32_16x16x32_bf16 v[120:123], a[220:223], a[88:91], v[120:123]
    v_mfma_f32_16x16x32_bf16 v[120:123], a[216:219], a[72:75], v[120:123]
    v_mfma_f32_16x16x32_bf16 v[116:119], a[216:219], a[68:71], v[116:119]
    ds_read_b64_tr_b16 a[204:205], v215 offset:46208
    v_mfma_f32_16x16x32_bf16 v[116:119], a[220:223], a[84:87], v[116:119]
    ds_read_b64_tr_b16 a[206:207], v215 offset:46976
    v_mfma_f32_16x16x32_bf16 v[112:115], a[220:223], a[80:83], v[112:115]
    buffer_load_dwordx4 a[156:159], v208, s[36:39], s51 offen offset:3072 sc1
    v_mfma_f32_16x16x32_bf16 v[112:115], a[216:219], a[64:67], v[112:115]
    s_waitcnt lgkmcnt(8)
    s_add_u32 s51, s51, s62
    v_mfma_f32_16x16x32_bf16 v[128:131], a[224:227], a[64:67], v[128:131]
    ds_read_b64_tr_b16 a[208:209], v216 offset:31872
    v_mfma_f32_16x16x32_bf16 v[128:131], a[228:231], a[80:83], v[128:131]
    ds_read_b64_tr_b16 a[210:211], v216 offset:32640
    v_mfma_f32_16x16x32_bf16 v[132:135], a[228:231], a[84:87], v[132:135]
    v_mfma_f32_16x16x32_bf16 v[132:135], a[224:227], a[68:71], v[132:135]
    v_mfma_f32_16x16x32_bf16 v[136:139], a[224:227], a[72:75], v[136:139]
    ds_read_b64_tr_b16 a[212:213], v216 offset:46208
    v_mfma_f32_16x16x32_bf16 v[136:139], a[228:231], a[88:91], v[136:139]
    ds_read_b64_tr_b16 a[214:215], v216 offset:46976
    v_mfma_f32_16x16x32_bf16 v[140:143], a[228:231], a[92:95], v[140:143]
    v_mfma_f32_16x16x32_bf16 v[140:143], a[224:227], a[76:79], v[140:143]
    s_waitcnt lgkmcnt(8)
    v_mfma_f32_16x16x32_bf16 v[156:159], a[192:195], a[76:79], v[156:159]
    ds_read_b64_tr_b16 a[216:217], v217 offset:34816
    v_mfma_f32_16x16x32_bf16 v[156:159], a[196:199], a[92:95], v[156:159]
    s_add_u32 m0, s50, 0
    ds_read_b64_tr_b16 a[218:219], v217 offset:35072
    v_mfma_f32_16x16x32_bf16 v[152:155], a[196:199], a[88:91], v[152:155]
    buffer_load_dwordx4 v209, s[20:23], s46 offen offset:0 lds
    v_mfma_f32_16x16x32_bf16 v[152:155], a[192:195], a[72:75], v[152:155]
    s_mul_i32 s55, s59, 393216
    v_mfma_f32_16x16x32_bf16 v[148:151], a[192:195], a[68:71], v[148:151]
    ds_read_b64_tr_b16 a[220:221], v217 offset:49152
    v_mfma_f32_16x16x32_bf16 v[148:151], a[196:199], a[84:87], v[148:151]
    s_add_u32 m0, s50, 1024
    ds_read_b64_tr_b16 a[222:223], v217 offset:49408
    v_mfma_f32_16x16x32_bf16 v[144:147], a[196:199], a[80:83], v[144:147]
    buffer_load_dwordx4 v240, s[20:23], s46 offen offset:0 lds
    v_mfma_f32_16x16x32_bf16 v[144:147], a[192:195], a[64:67], v[144:147]
    s_waitcnt lgkmcnt(8)
    s_barrier
    v_mfma_f32_16x16x32_bf16 v[160:163], a[200:203], a[64:67], v[160:163]
    ds_read_b64_tr_b16 a[224:225], v215 offset:0
    v_mfma_f32_16x16x32_bf16 v[160:163], a[204:207], a[80:83], v[160:163]
    s_add_u32 m0, s50, 2048
    ds_read_b64_tr_b16 a[226:227], v215 offset:768
    v_mfma_f32_16x16x32_bf16 v[164:167], a[204:207], a[84:87], v[164:167]
    buffer_load_dwordx4 v241, s[20:23], s46 offen offset:0 lds
    v_mfma_f32_16x16x32_bf16 v[164:167], a[200:203], a[68:71], v[164:167]
    s_add_u32 s46, s46, s55
    s_cmp_lg_u32 s52, 1
    s_cbranch_scc1 F_pw_7
    s_xor_b32 s53, s2, 1
    s_lshl_b32 s53, s53, 2
    s_add_u32 s53, s53, s40
    s_mul_i32 s54, s53, 7168
    buffer_load_dword a255, v231, s[28:31], s54 offen
    s_lshl_b32 s54, s53, 11
    s_mov_b64 exec, 0xffff
    buffer_load_dword a254, v231, s[32:35], s54 offen
    s_mov_b64 exec, -1
F_pw_7:
    v_mfma_f32_16x16x32_bf16 v[168:171], a[200:203], a[72:75], v[168:171]
    ds_read_b64_tr_b16 a[228:229], v215 offset:14336
    v_mfma_f32_16x16x32_bf16 v[168:171], a[204:207], a[88:91], v[168:171]
    ds_read_b64_tr_b16 a[230:231], v215 offset:15104
    v_mfma_f32_16x16x32_bf16 v[172:175], a[204:207], a[92:95], v[172:175]
    v_mfma_f32_16x16x32_bf16 v[172:175], a[200:203], a[76:79], v[172:175]
    s_waitcnt lgkmcnt(8)
    v_mfma_f32_16x16x32_bf16 v[188:191], a[208:211], a[76:79], v[188:191]
    ds_read_b64_tr_b16 a[192:193], v216 offset:0
    v_mfma_f32_16x16x32_bf16 v[188:191], a[212:215], a[92:95], v[188:191]
    s_add_u32 m0, s50, 3072
    ds_read_b64_tr_b16 a[194:195], v216 offset:768
    v_mfma_f32_16x16x32_bf16 v[184:187], a[212:215], a[88:91], v[184:187]
    buffer_load_dwordx4 v210, s[24:27], s48 offen offset:0 lds
    v_mfma_f32_16x16x32_bf16 v[184:187], a[208:211], a[72:75], v[184:187]
    s_mul_i32 s55, s59, 458752
    v_mfma_f32_16x16x32_bf16 v[180:183], a[208:211], a[68:71], v[180:183]
    ds_read_b64_tr_b16 a[196:197], v216 offset:14336
    v_mfma_f32_16x16x32_bf16 v[180:183], a[212:215], a[84:87], v[180:183]
    s_add_u32 m0, s50, 4096
    ds_read_b64_tr_b16 a[198:199], v216 offset:15104
    v_mfma_f32_16x16x32_bf16 v[176:179], a[212:215], a[80:83], v[176:179]
    buffer_load_dwordx4 v242, s[24:27], s48 offen offset:0 lds
    v_mfma_f32_16x16x32_bf16 v[176:179], a[208:211], a[64:67], v[176:179]
    s_waitcnt lgkmcnt(8)
    v_mfma_f32_16x16x32_bf16 v[192:195], a[216:219], a[64:67], v[192:195]
    ds_read_b64_tr_b16 a[200:201], v215 offset:64
    v_mfma_f32_16x16x32_bf16 v[192:195], a[220:223], a[80:83], v[192:195]
    s_add_u32 m0, s50, 5120
    ds_read_b64_tr_b16 a[202:203], v215 offset:832
    v_mfma_f32_16x16x32_bf16 v[196:199], a[220:223], a[84:87], v[196:199]
    buffer_load_dwordx4 v243, s[24:27], s48 offen offset:0 lds
    v_mfma_f32_16x16x32_bf16 v[196:199], a[216:219], a[68:71], v[196:199]
    s_add_u32 s48, s48, s55
    v_mfma_f32_16x16x32_bf16 v[200:203], a[216:219], a[72:75], v[200:203]
    ds_read_b64_tr_b16 a[204:205], v215 offset:14400
    v_mfma_f32_16x16x32_bf16 v[200:203], a[220:223], a[88:91], v[200:203]
    ds_read_b64_tr_b16 a[206:207], v215 offset:15168
    v_mfma_f32_16x16x32_bf16 v[204:207], a[220:223], a[92:95], v[204:207]
    v_mfma_f32_16x16x32_bf16 v[204:207], a[216:219], a[76:79], v[204:207]
    s_waitcnt vmcnt(21) lgkmcnt(8)
    v_mfma_f32_16x16x32_bf16 v[12:15], a[224:227], a[108:111], v[12:15]
    ds_read_b64_tr_b16 a[208:209], v216 offset:64
    v_mfma_f32_16x16x32_bf16 v[12:15], a[228:231], a[124:127], v[12:15]
    s_add_u32 m0, s50, 6144
    ds_read_b64_tr_b16 a[210:211], v216 offset:832
    v_mfma_f32_16x16x32_bf16 v[8:11], a[228:231], a[120:123], v[8:11]
    buffer_load_dwordx4 v211, s[24:27], s49 offen offset:0 lds
    v_mfma_f32_16x16x32_bf16 v[8:11], a[224:227], a[104:107], v[8:11]
    s_add_u32 s49, s49, s55
    v_mfma_f32_16x16x32_bf16 v[4:7], a[224:227], a[100:103], v[4:7]
    ds_read_b64_tr_b16 a[212:213], v216 offset:14400
    v_mfma_f32_16x16x32_bf16 v[4:7], a[228:231], a[116:119], v[4:7]
    ds_read_b64_tr_b16 a[214:215], v216 offset:15168
    v_mfma_f32_16x16x32_bf16 v[0:3], a[228:231], a[112:115], v[0:3]
    buffer_load_dwordx4 a[160:163], v208, s[36:39], s51 offen offset:0 sc1
    v_mfma_f32_16x16x32_bf16 v[0:3], a[224:227], a[96:99], v[0:3]
    s_waitcnt lgkmcnt(8)
    v_mfma_f32_16x16x32_bf16 v[16:19], a[192:195], a[96:99], v[16:19]
    ds_read_b64_tr_b16 a[216:217], v215 offset:128
    v_mfma_f32_16x16x32_bf16 v[16:19], a[196:199], a[112:115], v[16:19]
    ds_read_b64_tr_b16 a[218:219], v215 offset:896
    v_mfma_f32_16x16x32_bf16 v[20:23], a[196:199], a[116:119], v[20:23]
    buffer_load_dwordx4 a[164:167], v208, s[36:39], s51 offen offset:1024 sc1
    v_mfma_f32_16x16x32_bf16 v[20:23], a[192:195], a[100:103], v[20:23]
    v_mfma_f32_16x16x32_bf16 v[24:27], a[192:195], a[104:107], v[24:27]
    ds_read_b64_tr_b16 a[220:221], v215 offset:14464
    v_mfma_f32_16x16x32_bf16 v[24:27], a[196:199], a[120:123], v[24:27]
    ds_read_b64_tr_b16 a[222:223], v215 offset:15232
    v_mfma_f32_16x16x32_bf16 v[28:31], a[196:199], a[124:127], v[28:31]
    buffer_load_dwordx4 a[168:171], v208, s[36:39], s51 offen offset:2048 sc1
    v_mfma_f32_16x16x32_bf16 v[28:31], a[192:195], a[108:111], v[28:31]
    s_waitcnt lgkmcnt(8)
    v_mfma_f32_16x16x32_bf16 v[44:47], a[200:203], a[108:111], v[44:47]
    ds_read_b64_tr_b16 a[224:225], v216 offset:128
    v_mfma_f32_16x16x32_bf16 v[44:47], a[204:207], a[124:127], v[44:47]
    ds_read_b64_tr_b16 a[226:227], v216 offset:896
    v_mfma_f32_16x16x32_bf16 v[40:43], a[204:207], a[120:123], v[40:43]
    v_mfma_f32_16x16x32_bf16 v[40:43], a[200:203], a[104:107], v[40:43]
    v_mfma_f32_16x16x32_bf16 v[36:39], a[200:203], a[100:103], v[36:39]
    ds_read_b64_tr_b16 a[228:229], v216 offset:14464
    v_mfma_f32_16x16x32_bf16 v[36:39], a[204:207], a[116:119], v[36:39]
    ds_read_b64_tr_b16 a[230:231], v216 offset:15232
    v_mfma_f32_16x16x32_bf16 v[32:35], a[204:207], a[112:115], v[32:35]
    buffer_load_dwordx4 a[172:175], v208, s[36:39], s51 offen offset:3072 sc1
    v_mfma_f32_16x16x32_bf16 v[32:35], a[200:203], a[96:99], v[32:35]
    s_waitcnt lgkmcnt(8)
    s_add_u32 s51, s51, 4096
    v_mfma_f32_16x16x32_bf16 v[48:51], a[208:211], a[96:99], v[48:51]
    ds_read_b64_tr_b16 a[192:193], v215 offset:3072
    v_mfma_f32_16x16x32_bf16 v[48:51], a[212:215], a[112:115], v[48:51]
    ds_read_b64_tr_b16 a[194:195], v215 offset:3840
    v_mfma_f32_16x16x32_bf16 v[52:55], a[212:215], a[116:119], v[52:55]
    buffer_load_dwordx4 a[176:179], v208, s[36:39], s51 offen offset:0 sc1
    v_mfma_f32_16x16x32_bf16 v[52:55], a[208:211], a[100:103], v[52:55]
    v_mfma_f32_16x16x32_bf16 v[56:59], a[208:211], a[104:107], v[56:59]
    ds_read_b64_tr_b16 a[196:197], v215 offset:17408
    v_mfma_f32_16x16x32_bf16 v[56:59], a[212:215], a[120:123], v[56:59]
    ds_read_b64_tr_b16 a[198:199], v215 offset:18176
    v_mfma_f32_16x16x32_bf16 v[60:63], a[212:215], a[124:127], v[60:63]
    buffer_load_dwordx4 a[180:183], v208, s[36:39], s51 offen offset:1024 sc1
    v_mfma_f32_16x16x32_bf16 v[60:63], a[208:211], a[108:111], v[60:63]
    s_waitcnt lgkmcnt(8)
    s_cmp_lg_u32 s52, 2
    s_cbranch_scc1 F_pw_8
    s_xor_b32 s53, s2, 1
    s_lshl_b32 s53, s53, 2
    s_add_u32 s53, s53, s40
    s_mul_i32 s54, s53, 7168
    buffer_load_dword a255, v231, s[28:31], s54 offen
    s_lshl_b32 s54, s53, 11
    s_mov_b64 exec, 0xffff
    buffer_load_dword a254, v231, s[32:35], s54 offen
    s_mov_b64 exec, -1
F_pw_8:
    v_mfma_f32_16x16x32_bf16 v[76:79], a[108:111], a[216:219], v[76:79]
    ds_read_b64_tr_b16 a[200:201], v216 offset:3072
    v_mfma_f32_16x16x32_bf16 v[76:79], a[124:127], a[220:223], v[76:79]
    ds_read_b64_tr_b16 a[202:203], v216 offset:3840
    v_mfma_f32_16x16x32_bf16 v[72:75], a[120:123], a[220:223], v[72:75]
    v_mfma_f32_16x16x32_bf16 v[72:75], a[104:107], a[216:219], v[72:75]
    v_mfma_f32_16x16x32_bf16 v[68:71], a[100:103], a[216:219], v[68:71]
    ds_read_b64_tr_b16 a[204:205], v216 offset:17408
    v_mfma_f32_16x16x32_bf16 v[68:71], a[116:119], a[220:223], v[68:71]
    ds_read_b64_tr_b16 a[206:207], v216 offset:18176
    v_mfma_f32_16x16x32_bf16 v[64:67], a[112:115], a[220:223], v[64:67]
    buffer_load_dwordx4 a[184:187], v208, s[36:39], s51 offen offset:2048 sc1
    v_mfma_f32_16x16x32_bf16 v[64:67], a[96:99], a[216:219], v[64:67]
    s_waitcnt lgkmcnt(8)
    v_mfma_f32_16x16x32_bf16 v[80:83], a[96:99], a[224:227], v[80:83]
    ds_read_b64_tr_b16 a[208:209], v215 offset:3136
    v_mfma_f32_16x16x32_bf16 v[80:83], a[112:115], a[228:231], v[80:83]
    ds_read_b64_tr_b16 a[210:211], v215 offset:3904
    v_mfma_f32_16x16x32_bf16 v[84:87], a[116:119], a[228:231], v[84:87]
    buffer_load_dwordx4 a[188:191], v208, s[36:39], s51 offen offset:3072 sc1
    v_mfma_f32_16x16x32_bf16 v[84:87], a[100:103], a[224:227], v[84:87]
    s_add_u32 s51, s51, s63
    v_mfma_f32_16x16x32_bf16 v[88:91], a[104:107], a[224:227], v[88:91]
    ds_read_b64_tr_b16 a[212:213], v215 offset:17472
    v_mfma_f32_16x16x32_bf16 v[88:91], a[120:123], a[228:231], v[88:91]
    s_add_u32 m0, s50, 114688
    ds_read_b64_tr_b16 a[214:215], v215 offset:18240
    v_mfma_f32_16x16x32_bf16 v[92:95], a[124:127], a[228:231], v[92:95]
    buffer_load_dwordx4 v209, s[20:23], s46 offen offset:0 lds
    v_mfma_f32_16x16x32_bf16 v[92:95], a[108:111], a[224:227], v[92:95]
    s_waitcnt lgkmcnt(8)
    s_mul_i32 s55, s60, 393216
    v_mfma_f32_16x16x32_bf16 v[108:111], a[192:195], a[108:111], v[108:111]
    ds_read_b64_tr_b16 a[216:217], v216 offset:3136
    v_mfma_f32_16x16x32_bf16 v[108:111], a[196:199], a[124:127], v[108:111]
    s_add_u32 m0, s50, 115712
    ds_read_b64_tr_b16 a[218:219], v216 offset:3904
    v_mfma_f32_16x16x32_bf16 v[104:107], a[196:199], a[120:123], v[104:107]
    buffer_load_dwordx4 v240, s[20:23], s46 offen offset:0 lds
    v_mfma_f32_16x16x32_bf16 v[104:107], a[192:195], a[104:107], v[104:107]
    v_mfma_f32_16x16x32_bf16 v[100:103], a[192:195], a[100:103], v[100:103]
    ds_read_b64_tr_b16 a[220:221], v216 offset:17472
    v_mfma_f32_16x16x32_bf16 v[100:103], a[196:199], a[116:119], v[100:103]
    ds_read_b64_tr_b16 a[222:223], v216 offset:18240
    v_mfma_f32_16x16x32_bf16 v[96:99], a[196:199], a[112:115], v[96:99]
    v_mfma_f32_16x16x32_bf16 v[96:99], a[192:195], a[96:99], v[96:99]
    s_waitcnt lgkmcnt(8)
    v_mfma_f32_16x16x32_bf16 v[112:115], a[200:203], a[96:99], v[112:115]
    ds_read_b64_tr_b16 a[224:225], v215 offset:3200
    v_mfma_f32_16x16x32_bf16 v[112:115], a[204:207], a[112:115], v[112:115]
    s_add_u32 m0, s50, 116736
    ds_read_b64_tr_b16 a[226:227], v215 offset:3968
    v_mfma_f32_16x16x32_bf16 v[116:119], a[204:207], a[116:119], v[116:119]
    buffer_load_dwordx4 v241, s[20:23], s46 offen offset:0 lds
    v_mfma_f32_16x16x32_bf16 v[116:119], a[200:203], a[100:103], v[116:119]
    s_add_u32 s46, s46, s55
    v_mfma_f32_16x16x32_bf16 v[120:123], a[200:203], a[104:107], v[120:123]
    ds_read_b64_tr_b16 a[228:229], v215 offset:17536
    v_mfma_f32_16x16x32_bf16 v[120:123], a[204:207], a[120:123], v[120:123]
    s_add_u32 m0, s50, 117760
    ds_read_b64_tr_b16 a[230:231], v215 offset:18304
    v_mfma_f32_16x16x32_bf16 v[124:127], a[204:207], a[124:127], v[124:127]
    buffer_load_dwordx4 v210, s[24:27], s48 offen offset:0 lds
    v_mfma_f32_16x16x32_bf16 v[124:127], a[200:203], a[108:111], v[124:127]
    s_waitcnt lgkmcnt(8)
    s_mul_i32 s55, s60, 458752
    v_mfma_f32_16x16x32_bf16 v[140:143], a[208:211], a[108:111], v[140:143]
    ds_read_b64_tr_b16 a[192:193], v216 offset:3200
    v_mfma_f32_16x16x32_bf16 v[140:143], a[212:215], a[124:127], v[140:143]
    s_add_u32 m0, s50, 118784
    ds_read_b64_tr_b16 a[194:195], v216 offset:3968
    v_mfma_f32_16x16x32_bf16 v[136:139], a[212:215], a[120:123], v[136:139]
    buffer_load_dwordx4 v242, s[24:27], s48 offen offset:0 lds
    v_mfma_f32_16x16x32_bf16 v[136:139], a[208:211], a[104:107], v[136:139]
    v_mfma_f32_16x16x32_bf16 v[132:135], a[208:211], a[100:103], v[132:135]
    ds_read_b64_tr_b16 a[196:197], v216 offset:17536
    v_mfma_f32_16x16x32_bf16 v[132:135], a[212:215], a[116:119], v[132:135]
    ds_read_b64_tr_b16 a[198:199], v216 offset:18304
    v_mfma_f32_16x16x32_bf16 v[128:131], a[212:215], a[112:115], v[128:131]
    v_mfma_f32_16x16x32_bf16 v[128:131], a[208:211], a[96:99], v[128:131]
    s_waitcnt lgkmcnt(8)
    v_mfma_f32_16x16x32_bf16 v[144:147], a[216:219], a[96:99], v[144:147]
    ds_read_b64_tr_b16 a[200:201], v217 offset:6144
    v_mfma_f32_16x16x32_bf16 v[144:147], a[220:223], a[112:115], v[144:147]
    s_add_u32 m0, s50, 119808
    ds_read_b64_tr_b16 a[202:203], v217 offset:6400
    v_mfma_f32_16x16x32_bf16 v[148:151], a[220:223], a[116:119], v[148:151]
    buffer_load_dwordx4 v243, s[24:27], s48 offen offset:0 lds
    v_mfma_f32_16x16x32_bf16 v[148:151], a[216:219], a[100:103], v[148:151]
    s_add_u32 s48, s48, s55
    v_mfma_f32_16x16x32_bf16 v[152:155], a[216:219], a[104:107], v[152:155]
    ds_read_b64_tr_b16 a[204:205], v217 offset:20480
    v_mfma_f32_16x16x32_bf16 v[152:155], a[220:223], a[120:123], v[152:155]
    s_add_u32 m0, s50, 120832
    ds_read_b64_tr_b16 a[206:207], v217 offset:20736
    v_mfma_f32_16x16x32_bf16 v[156:159], a[220:223], a[124:127], v[156:159]
    buffer_load_dwordx4 v211, s[24:27], s49 offen offset:0 lds
    v_mfma_f32_16x16x32_bf16 v[156:159], a[216:219], a[108:111], v[156:159]
    s_waitcnt lgkmcnt(8)
    s_add_u32 s49, s49, s55
    s_waitcnt vmcnt(30)
    s_barrier
    v_mfma_f32_16x16x32_bf16 v[172:175], a[224:227], a[108:111], v[172:175]
    ds_read_b64_tr_b16 a[208:209], v212 offset:28672
    v_mfma_f32_16x16x32_bf16 v[172:175], a[228:231], a[124:127], v[172:175]
    ds_read_b64_tr_b16 a[210:211], v212 offset:29440
    v_mfma_f32_16x16x32_bf16 v[168:171], a[228:231], a[120:123], v[168:171]
    buffer_load_dwordx4 a[0:3], v208, s[36:39], s51 offen offset:0 sc1
    v_mfma_f32_16x16x32_bf16 v[168:171], a[224:227], a[104:107], v[168:171]
    s_cmp_lg_u32 s52, 3
    s_cbranch_scc1 F_pw_9
    s_xor_b32 s53, s2, 1
    s_lshl_b32 s53, s53, 2
    s_add_u32 s53, s53, s40
    s_mul_i32 s54, s53, 7168
    buffer_load_dword a255, v231, s[28:31], s54 offen
    s_lshl_b32 s54, s53, 11
    s_mov_b64 exec, 0xffff
    buffer_load_dword a254, v231, s[32:35], s54 offen
    s_mov_b64 exec, -1
F_pw_9:
    v_mfma_f32_16x16x32_bf16 v[164:167], a[224:227], a[100:103], v[164:167]
    ds_read_b64_tr_b16 a[212:213], v212 offset:43008
    v_mfma_f32_16x16x32_bf16 v[164:167], a[228:231], a[116:119], v[164:167]
    ds_read_b64_tr_b16 a[214:215], v212 offset:43776
    v_mfma_f32_16x16x32_bf16 v[160:163], a[228:231], a[112:115], v[160:163]
    buffer_load_dwordx4 a[4:7], v208, s[36:39], s51 offen offset:1024 sc1
    v_mfma_f32_16x16x32_bf16 v[160:163], a[224:227], a[96:99], v[160:163]
    s_waitcnt lgkmcnt(8)
    v_mfma_f32_16x16x32_bf16 v[176:179], a[192:195], a[96:99], v[176:179]
    ds_read_b64_tr_b16 a[216:217], v213 offset:28672
    v_mfma_f32_16x16x32_bf16 v[176:179], a[196:199], a[112:115], v[176:179]
    ds_read_b64_tr_b16 a[218:219], v213 offset:29440
    v_mfma_f32_16x16x32_bf16 v[180:183], a[196:199], a[116:119], v[180:183]
    v_mfma_f32_16x16x32_bf16 v[180:183], a[192:195], a[100:103], v[180:183]
    v_mfma_f32_16x16x32_bf16 v[184:187], a[192:195], a[104:107], v[184:187]
    ds_read_b64_tr_b16 a[220:221], v213 offset:43008
    v_mfma_f32_16x16x32_bf16 v[184:187], a[196:199], a[120:123], v[184:187]
    ds_read_b64_tr_b16 a[222:223], v213 offset:43776
    v_mfma_f32_16x16x32_bf16 v[188:191], a[196:199], a[124:127], v[188:191]
    buffer_load_dwordx4 a[8:11], v208, s[36:39], s51 offen offset:2048 sc1
    v_mfma_f32_16x16x32_bf16 v[188:191], a[192:195], a[108:111], v[188:191]
    s_waitcnt lgkmcnt(8)
    v_mfma_f32_16x16x32_bf16 v[204:207], a[200:203], a[108:111], v[204:207]
    ds_read_b64_tr_b16 a[224:225], v212 offset:28736
    v_mfma_f32_16x16x32_bf16 v[204:207], a[204:207], a[124:127], v[204:207]
    ds_read_b64_tr_b16 a[226:227], v212 offset:29504
    v_mfma_f32_16x16x32_bf16 v[200:203], a[204:207], a[120:123], v[200:203]
    buffer_load_dwordx4 a[12:15], v208, s[36:39], s51 offen offset:3072 sc1
    v_mfma_f32_16x16x32_bf16 v[200:203], a[200:203], a[104:107], v[200:203]
    s_add_u32 s51, s51, 4096
    v_mfma_f32_16x16x32_bf16 v[196:199], a[200:203], a[100:103], v[196:199]
    ds_read_b64_tr_b16 a[228:229], v212 offset:43072
    v_mfma_f32_16x16x32_bf16 v[196:199], a[204:207], a[116:119], v[196:199]
    ds_read_b64_tr_b16 a[230:231], v212 offset:43840
    v_mfma_f32_16x16x32_bf16 v[192:195], a[204:207], a[112:115], v[192:195]
    buffer_load_dwordx4 a[16:19], v208, s[36:39], s51 offen offset:0 sc1
    v_mfma_f32_16x16x32_bf16 v[192:195], a[200:203], a[96:99], v[192:195]
    s_waitcnt vmcnt(27) lgkmcnt(8)
    v_mfma_f32_16x16x32_bf16 v[0:3], a[208:211], a[128:131], v[0:3]
    ds_read_b64_tr_b16 a[192:193], v213 offset:28736
    v_mfma_f32_16x16x32_bf16 v[0:3], a[212:215], a[144:147], v[0:3]
    ds_read_b64_tr_b16 a[194:195], v213 offset:29504
    v_mfma_f32_16x16x32_bf16 v[4:7], a[212:215], a[148:151], v[4:7]
    v_mfma_f32_16x16x32_bf16 v[4:7], a[208:211], a[132:135], v[4:7]
    v_mfma_f32_16x16x32_bf16 v[8:11], a[208:211], a[136:139], v[8:11]
    ds_read_b64_tr_b16 a[196:197], v213 offset:43072
    v_mfma_f32_16x16x32_bf16 v[8:11], a[212:215], a[152:155], v[8:11]
    ds_read_b64_tr_b16 a[198:199], v213 offset:43840
    v_mfma_f32_16x16x32_bf16 v[12:15], a[212:215], a[156:159], v[12:15]
    buffer_load_dwordx4 a[20:23], v208, s[36:39], s51 offen offset:1024 sc1
    v_mfma_f32_16x16x32_bf16 v[12:15], a[208:211], a[140:143], v[12:15]
    s_waitcnt lgkmcnt(8)
    v_mfma_f32_16x16x32_bf16 v[28:31], a[216:219], a[140:143], v[28:31]
    ds_read_b64_tr_b16 a[200:201], v212 offset:28800
    v_mfma_f32_16x16x32_bf16 v[28:31], a[220:223], a[156:159], v[28:31]
    ds_read_b64_tr_b16 a[202:203], v212 offset:29568
    v_mfma_f32_16x16x32_bf16 v[24:27], a[220:223], a[152:155], v[24:27]
    buffer_load_dwordx4 a[24:27], v208, s[36:39], s51 offen offset:2048 sc1
    v_mfma_f32_16x16x32_bf16 v[24:27], a[216:219], a[136:139], v[24:27]
    v_mfma_f32_16x16x32_bf16 v[20:23], a[216:219], a[132:135], v[20:23]
    ds_read_b64_tr_b16 a[204:205], v212 offset:43136
    v_mfma_f32_16x16x32_bf16 v[20:23], a[220:223], a[148:151], v[20:23]
    ds_read_b64_tr_b16 a[206:207], v212 offset:43904
    v_mfma_f32_16x16x32_bf16 v[16:19], a[220:223], a[144:147], v[16:19]
    buffer_load_dwordx4 a[28:31], v208, s[36:39], s51 offen offset:3072 sc1
    v_mfma_f32_16x16x32_bf16 v[16:19], a[216:219], a[128:131], v[16:19]
    s_waitcnt lgkmcnt(8)
    s_add_u32 s51, s51, s64
    v_mfma_f32_16x16x32_bf16 v[32:35], a[224:227], a[128:131], v[32:35]
    ds_read_b64_tr_b16 a[208:209], v213 offset:28800
    v_mfma_f32_16x16x32_bf16 v[32:35], a[228:231], a[144:147], v[32:35]
    s_add_u32 m0, s50, 86016
    ds_read_b64_tr_b16 a[210:211], v213 offset:29568
    v_mfma_f32_16x16x32_bf16 v[36:39], a[228:231], a[148:151], v[36:39]
    buffer_load_dwordx4 v209, s[20:23], s46 offen offset:0 lds
    v_mfma_f32_16x16x32_bf16 v[36:39], a[224:227], a[132:135], v[36:39]
    s_mul_i32 s55, s61, 393216
    v_mfma_f32_16x16x32_bf16 v[40:43], a[224:227], a[136:139], v[40:43]
    ds_read_b64_tr_b16 a[212:213], v213 offset:43136
    v_mfma_f32_16x16x32_bf16 v[40:43], a[228:231], a[152:155], v[40:43]
    ds_read_b64_tr_b16 a[214:215], v213 offset:43904
    v_mfma_f32_16x16x32_bf16 v[44:47], a[228:231], a[156:159], v[44:47]
    v_mfma_f32_16x16x32_bf16 v[44:47], a[224:227], a[140:143], v[44:47]
    s_waitcnt lgkmcnt(8)
    v_mfma_f32_16x16x32_bf16 v[60:63], a[192:195], a[140:143], v[60:63]
    ds_read_b64_tr_b16 a[216:217], v212 offset:31744
    v_mfma_f32_16x16x32_bf16 v[60:63], a[196:199], a[156:159], v[60:63]
    s_add_u32 m0, s50, 87040
    ds_read_b64_tr_b16 a[218:219], v212 offset:32512
    v_mfma_f32_16x16x32_bf16 v[56:59], a[196:199], a[152:155], v[56:59]
    buffer_load_dwordx4 v240, s[20:23], s46 offen offset:0 lds
    v_mfma_f32_16x16x32_bf16 v[56:59], a[192:195], a[136:139], v[56:59]
    v_mfma_f32_16x16x32_bf16 v[52:55], a[192:195], a[132:135], v[52:55]
    ds_read_b64_tr_b16 a[220:221], v212 offset:46080
    v_mfma_f32_16x16x32_bf16 v[52:55], a[196:199], a[148:151], v[52:55]
    s_add_u32 m0, s50, 88064
    ds_read_b64_tr_b16 a[222:223], v212 offset:46848
    v_mfma_f32_16x16x32_bf16 v[48:51], a[196:199], a[144:147], v[48:51]
    buffer_load_dwordx4 v241, s[20:23], s46 offen offset:0 lds
    v_mfma_f32_16x16x32_bf16 v[48:51], a[192:195], a[128:131], v[48:51]
    s_waitcnt lgkmcnt(8)
    s_add_u32 s46, s46, s55
    s_cmp_lg_u32 s52, 4
    s_cbranch_scc1 F_pw_10
    s_xor_b32 s53, s2, 1
    s_lshl_b32 s53, s53, 2
    s_add_u32 s53, s53, s40
    s_mul_i32 s54, s53, 7168
    buffer_load_dword a255, v231, s[28:31], s54 offen
    s_lshl_b32 s54, s53, 11
    s_mov_b64 exec, 0xffff
    buffer_load_dword a254, v231, s[32:35], s54 offen
    s_mov_b64 exec, -1
F_pw_10:
    v_mfma_f32_16x16x32_bf16 v[64:67], a[128:131], a[200:203], v[64:67]
    ds_read_b64_tr_b16 a[224:225], v213 offset:31744
    v_mfma_f32_16x16x32_bf16 v[64:67], a[144:147], a[204:207], v[64:67]
    s_add_u32 m0, s50, 89088
    ds_read_b64_tr_b16 a[226:227], v213 offset:32512
    v_mfma_f32_16x16x32_bf16 v[68:71], a[148:151], a[204:207], v[68:71]
    buffer_load_dwordx4 v210, s[24:27], s48 offen offset:0 lds
    v_mfma_f32_16x16x32_bf16 v[68:71], a[132:135], a[200:203], v[68:71]
    s_mul_i32 s55, s61, 458752
    v_mfma_f32_16x16x32_bf16 v[72:75], a[136:139], a[200:203], v[72:75]
    ds_read_b64_tr_b16 a[228:229], v213 offset:46080
    v_mfma_f32_16x16x32_bf16 v[72:75], a[152:155], a[204:207], v[72:75]
    ds_read_b64_tr_b16 a[230:231], v213 offset:46848
    v_mfma_f32_16x16x32_bf16 v[76:79], a[156:159], a[204:207], v[76:79]
    v_mfma_f32_16x16x32_bf16 v[76:79], a[140:143], a[200:203], v[76:79]
    s_waitcnt lgkmcnt(8)
    v_mfma_f32_16x16x32_bf16 v[92:95], a[140:143], a[208:211], v[92:95]
    ds_read_b64_tr_b16 a[192:193], v212 offset:31808
    v_mfma_f32_16x16x32_bf16 v[92:95], a[156:159], a[212:215], v[92:95]
    s_add_u32 m0, s50, 90112
    ds_read_b64_tr_b16 a[194:195], v212 offset:32576
    v_mfma_f32_16x16x32_bf16 v[88:91], a[152:155], a[212:215], v[88:91]
    buffer_load_dwordx4 v242, s[24:27], s48 offen offset:0 lds
    v_mfma_f32_16x16x32_bf16 v[88:91], a[136:139], a[208:211], v[88:91]
    v_mfma_f32_16x16x32_bf16 v[84:87], a[132:135], a[208:211], v[84:87]
    ds_read_b64_tr_b16 a[196:197], v212 offset:46144
    v_mfma_f32_16x16x32_bf16 v[84:87], a[148:151], a[212:215], v[84:87]
    s_add_u32 m0, s50, 91136
    ds_read_b64_tr_b16 a[198:199], v212 offset:46912
    v_mfma_f32_16x16x32_bf16 v[80:83], a[144:147], a[212:215], v[80:83]
    buffer_load_dwordx4 v243, s[24:27], s48 offen offset:0 lds
    v_mfma_f32_16x16x32_bf16 v[80:83], a[128:131], a[208:211], v[80:83]
    s_waitcnt lgkmcnt(8)
    s_add_u32 s48, s48, s55
    v_mfma_f32_16x16x32_bf16 v[96:99], a[216:219], a[128:131], v[96:99]
    ds_read_b64_tr_b16 a[200:201], v213 offset:31808
    v_mfma_f32_16x16x32_bf16 v[96:99], a[220:223], a[144:147], v[96:99]
    s_add_u32 m0, s50, 92160
    ds_read_b64_tr_b16 a[202:203], v213 offset:32576
    v_mfma_f32_16x16x32_bf16 v[100:103], a[220:223], a[148:151], v[100:103]
    buffer_load_dwordx4 v211, s[24:27], s49 offen offset:0 lds
    v_mfma_f32_16x16x32_bf16 v[100:103], a[216:219], a[132:135], v[100:103]
    s_add_u32 s49, s49, s55
    v_mfma_f32_16x16x32_bf16 v[104:107], a[216:219], a[136:139], v[104:107]
    ds_read_b64_tr_b16 a[204:205], v213 offset:46144
    v_mfma_f32_16x16x32_bf16 v[104:107], a[220:223], a[152:155], v[104:107]
    ds_read_b64_tr_b16 a[206:207], v213 offset:46912
    v_mfma_f32_16x16x32_bf16 v[108:111], a[220:223], a[156:159], v[108:111]
    buffer_load_dwordx4 a[32:35], v208, s[36:39], s51 offen offset:0 sc1
    v_mfma_f32_16x16x32_bf16 v[108:111], a[216:219], a[140:143], v[108:111]
    s_waitcnt lgkmcnt(8)
    v_mfma_f32_16x16x32_bf16 v[124:127], a[224:227], a[140:143], v[124:127]
    ds_read_b64_tr_b16 a[208:209], v212 offset:31872
    v_mfma_f32_16x16x32_bf16 v[124:127], a[228:231], a[156:159], v[124:127]
    ds_read_b64_tr_b16 a[210:211], v212 offset:32640
    v_mfma_f32_16x16x32_bf16 v[120:123], a[228:231], a[152:155], v[120:123]
    v_mfma_f32_16x16x32_bf16 v[120:123], a[224:227], a[136:139], v[120:123]
    v_mfma_f32_16x16x32_bf16 v[116:119], a[224:227], a[132:135], v[116:119]
    ds_read_b64_tr_b16 a[212:213], v212 offset:46208
    v_mfma_f32_16x16x32_bf16 v[116:119], a[228:231], a[148:151], v[116:119]
    ds_read_b64_tr_b16 a[214:215], v212 offset:46976
    v_mfma_f32_16x16x32_bf16 v[112:115], a[228:231], a[144:147], v[112:115]
    buffer_load_dwordx4 a[36:39], v208, s[36:39], s51 offen offset:1024 sc1
    v_mfma_f32_16x16x32_bf16 v[112:115], a[224:227], a[128:131], v[112:115]
    s_waitcnt lgkmcnt(8)
    v_mfma_f32_16x16x32_bf16 v[128:131], a[192:195], a[128:131], v[128:131]
    ds_read_b64_tr_b16 a[216:217], v213 offset:31872
    v_mfma_f32_16x16x32_bf16 v[128:131], a[196:199], a[144:147], v[128:131]
    ds_read_b64_tr_b16 a[218:219], v213 offset:32640
    v_mfma_f32_16x16x32_bf16 v[132:135], a[196:199], a[148:151], v[132:135]
    buffer_load_dwordx4 a[40:43], v208, s[36:39], s51 offen offset:2048 sc1
    v_mfma_f32_16x16x32_bf16 v[132:135], a[192:195], a[132:135], v[132:135]
    v_mfma_f32_16x16x32_bf16 v[136:139], a[192:195], a[136:139], v[136:139]
    ds_read_b64_tr_b16 a[220:221], v213 offset:46208
    v_mfma_f32_16x16x32_bf16 v[136:139], a[196:199], a[152:155], v[136:139]
    ds_read_b64_tr_b16 a[222:223], v213 offset:46976
    v_mfma_f32_16x16x32_bf16 v[140:143], a[196:199], a[156:159], v[140:143]
    buffer_load_dwordx4 a[44:47], v208, s[36:39], s51 offen offset:3072 sc1
    v_mfma_f32_16x16x32_bf16 v[140:143], a[192:195], a[140:143], v[140:143]
    s_waitcnt lgkmcnt(8)
    s_add_u32 s51, s51, 4096
    v_mfma_f32_16x16x32_bf16 v[156:159], a[200:203], a[140:143], v[156:159]
    ds_read_b64_tr_b16 a[224:225], v214 offset:34816
    v_mfma_f32_16x16x32_bf16 v[156:159], a[204:207], a[156:159], v[156:159]
    ds_read_b64_tr_b16 a[226:227], v214 offset:35072
    v_mfma_f32_16x16x32_bf16 v[152:155], a[204:207], a[152:155], v[152:155]
    v_mfma_f32_16x16x32_bf16 v[152:155], a[200:203], a[136:139], v[152:155]
    v_mfma_f32_16x16x32_bf16 v[148:151], a[200:203], a[132:135], v[148:151]
    ds_read_b64_tr_b16 a[228:229], v214 offset:49152
    v_mfma_f32_16x16x32_bf16 v[148:151], a[204:207], a[148:151], v[148:151]
    ds_read_b64_tr_b16 a[230:231], v214 offset:49408
    v_mfma_f32_16x16x32_bf16 v[144:147], a[204:207], a[144:147], v[144:147]
    buffer_load_dwordx4 a[48:51], v208, s[36:39], s51 offen offset:0 sc1
    v_mfma_f32_16x16x32_bf16 v[144:147], a[200:203], a[128:131], v[144:147]
    s_waitcnt lgkmcnt(8)
    s_waitcnt vmcnt(35)
    s_barrier
    v_mfma_f32_16x16x32_bf16 v[160:163], a[208:211], a[128:131], v[160:163]
    ds_read_b64_tr_b16 a[192:193], v212 offset:0
    v_mfma_f32_16x16x32_bf16 v[160:163], a[212:215], a[144:147], v[160:163]
    ds_read_b64_tr_b16 a[194:195], v212 offset:768
    v_mfma_f32_16x16x32_bf16 v[164:167], a[212:215], a[148:151], v[164:167]
    buffer_load_dwordx4 a[52:55], v208, s[36:39], s51 offen offset:1024 sc1
    v_mfma_f32_16x16x32_bf16 v[164:167], a[208:211], a[132:135], v[164:167]
    s_cmp_lg_u32 s52, 5
    s_cbranch_scc1 F_pw_11
    s_xor_b32 s53, s2, 1
    s_lshl_b32 s53, s53, 2
    s_add_u32 s53, s53, s40
    s_mul_i32 s54, s53, 7168
    buffer_load_dword a255, v231, s[28:31], s54 offen
    s_lshl_b32 s54, s53, 11
    s_mov_b64 exec, 0xffff
    buffer_load_dword a254, v231, s[32:35], s54 offen
    s_mov_b64 exec, -1
F_pw_11:
    v_mfma_f32_16x16x32_bf16 v[168:171], a[208:211], a[136:139], v[168:171]
    ds_read_b64_tr_b16 a[196:197], v212 offset:14336
    v_mfma_f32_16x16x32_bf16 v[168:171], a[212:215], a[152:155], v[168:171]
    ds_read_b64_tr_b16 a[198:199], v212 offset:15104
    v_mfma_f32_16x16x32_bf16 v[172:175], a[212:215], a[156:159], v[172:175]
    buffer_load_dwordx4 a[56:59], v208, s[36:39], s51 offen offset:2048 sc1
    v_mfma_f32_16x16x32_bf16 v[172:175], a[208:211], a[140:143], v[172:175]
    s_waitcnt lgkmcnt(8)
    v_mfma_f32_16x16x32_bf16 v[188:191], a[216:219], a[140:143], v[188:191]
    ds_read_b64_tr_b16 a[200:201], v213 offset:0
    v_mfma_f32_16x16x32_bf16 v[188:191], a[220:223], a[156:159], v[188:191]
    ds_read_b64_tr_b16 a[202:203], v213 offset:768
    v_mfma_f32_16x16x32_bf16 v[184:187], a[220:223], a[152:155], v[184:187]
    buffer_load_dwordx4 a[60:63], v208, s[36:39], s51 offen offset:3072 sc1
    v_mfma_f32_16x16x32_bf16 v[184:187], a[216:219], a[136:139], v[184:187]
    s_add_u32 s51, s51, s65
    v_mfma_f32_16x16x32_bf16 v[180:183], a[216:219], a[132:135], v[180:183]
    ds_read_b64_tr_b16 a[204:205], v213 offset:14336
    v_mfma_f32_16x16x32_bf16 v[180:183], a[220:223], a[148:151], v[180:183]
    ds_read_b64_tr_b16 a[206:207], v213 offset:15104
    v_mfma_f32_16x16x32_bf16 v[176:179], a[220:223], a[144:147], v[176:179]
    v_mfma_f32_16x16x32_bf16 v[176:179], a[216:219], a[128:131], v[176:179]
    s_waitcnt lgkmcnt(8)
    v_mfma_f32_16x16x32_bf16 v[192:195], a[224:227], a[128:131], v[192:195]
    ds_read_b64_tr_b16 a[208:209], v212 offset:64
    v_mfma_f32_16x16x32_bf16 v[192:195], a[228:231], a[144:147], v[192:195]
    s_add_u32 m0, s50, 57344
    ds_read_b64_tr_b16 a[210:211], v212 offset:832
    v_mfma_f32_16x16x32_bf16 v[196:199], a[228:231], a[148:151], v[196:199]
    buffer_load_dwordx4 v209, s[20:23], s46 offen offset:0 lds
    v_mfma_f32_16x16x32_bf16 v[196:199], a[224:227], a[132:135], v[196:199]
    s_mul_i32 s55, s58, 393216
    v_mfma_f32_16x16x32_bf16 v[200:203], a[224:227], a[136:139], v[200:203]
    ds_read_b64_tr_b16 a[212:213], v212 offset:14400
    v_mfma_f32_16x16x32_bf16 v[200:203], a[228:231], a[152:155], v[200:203]
    ds_read_b64_tr_b16 a[214:215], v212 offset:15168
    v_mfma_f32_16x16x32_bf16 v[204:207], a[228:231], a[156:159], v[204:207]
    v_mfma_f32_16x16x32_bf16 v[204:207], a[224:227], a[140:143], v[204:207]
    s_waitcnt vmcnt(31) lgkmcnt(8)
    v_mfma_f32_16x16x32_bf16 v[12:15], a[192:195], a[172:175], v[12:15]
    ds_read_b64_tr_b16 a[216:217], v213 offset:64
    v_mfma_f32_16x16x32_bf16 v[12:15], a[196:199], a[188:191], v[12:15]
    s_add_u32 m0, s50, 58368
    ds_read_b64_tr_b16 a[218:219], v213 offset:832
    v_mfma_f32_16x16x32_bf16 v[8:11], a[196:199], a[184:187], v[8:11]
    buffer_load_dwordx4 v240, s[20:23], s46 offen offset:0 lds
    v_mfma_f32_16x16x32_bf16 v[8:11], a[192:195], a[168:171], v[8:11]
    v_mfma_f32_16x16x32_bf16 v[4:7], a[192:195], a[164:167], v[4:7]
    ds_read_b64_tr_b16 a[220:221], v213 offset:14400
    v_mfma_f32_16x16x32_bf16 v[4:7], a[196:199], a[180:183], v[4:7]
    ds_read_b64_tr_b16 a[222:223], v213 offset:15168
    v_mfma_f32_16x16x32_bf16 v[0:3], a[196:199], a[176:179], v[0:3]
    v_mfma_f32_16x16x32_bf16 v[0:3], a[192:195], a[160:163], v[0:3]
    s_waitcnt lgkmcnt(8)
    v_mfma_f32_16x16x32_bf16 v[16:19], a[200:203], a[160:163], v[16:19]
    ds_read_b64_tr_b16 a[224:225], v212 offset:128
    v_mfma_f32_16x16x32_bf16 v[16:19], a[204:207], a[176:179], v[16:19]
    ds_read_b64_tr_b16 a[226:227], v212 offset:896
    v_mfma_f32_16x16x32_bf16 v[20:23], a[204:207], a[180:183], v[20:23]
    v_mfma_f32_16x16x32_bf16 v[20:23], a[200:203], a[164:167], v[20:23]
    v_mfma_f32_16x16x32_bf16 v[24:27], a[200:203], a[168:171], v[24:27]
    ds_read_b64_tr_b16 a[228:229], v212 offset:14464
    v_mfma_f32_16x16x32_bf16 v[24:27], a[204:207], a[184:187], v[24:27]
    s_add_u32 m0, s50, 59392
    ds_read_b64_tr_b16 a[230:231], v212 offset:15232
    v_mfma_f32_16x16x32_bf16 v[28:31], a[204:207], a[188:191], v[28:31]
    buffer_load_dwordx4 v241, s[20:23], s46 offen offset:0 lds
    v_mfma_f32_16x16x32_bf16 v[28:31], a[200:203], a[172:175], v[28:31]
    s_waitcnt lgkmcnt(8)
    s_add_u32 s46, s46, s55
    v_mfma_f32_16x16x32_bf16 v[44:47], a[208:211], a[172:175], v[44:47]
    ds_read_b64_tr_b16 a[192:193], v213 offset:128
    v_mfma_f32_16x16x32_bf16 v[44:47], a[212:215], a[188:191], v[44:47]
    ds_read_b64_tr_b16 a[194:195], v213 offset:896
    v_mfma_f32_16x16x32_bf16 v[40:43], a[212:215], a[184:187], v[40:43]
    v_mfma_f32_16x16x32_bf16 v[40:43], a[208:211], a[168:171], v[40:43]
    v_mfma_f32_16x16x32_bf16 v[36:39], a[208:211], a[164:167], v[36:39]
    ds_read_b64_tr_b16 a[196:197], v213 offset:14464
    v_mfma_f32_16x16x32_bf16 v[36:39], a[212:215], a[180:183], v[36:39]
    s_add_u32 m0, s50, 60416
    ds_read_b64_tr_b16 a[198:199], v213 offset:15232
    v_mfma_f32_16x16x32_bf16 v[32:35], a[212:215], a[176:179], v[32:35]
    buffer_load_dwordx4 v210, s[24:27], s48 offen offset:0 lds
    v_mfma_f32_16x16x32_bf16 v[32:35], a[208:211], a[160:163], v[32:35]
    s_waitcnt lgkmcnt(8)
    s_mul_i32 s55, s58, 458752
    v_mfma_f32_16x16x32_bf16 v[48:51], a[216:219], a[160:163], v[48:51]
    ds_read_b64_tr_b16 a[200:201], v212 offset:3072
    v_mfma_f32_16x16x32_bf16 v[48:51], a[220:223], a[176:179], v[48:51]
    ds_read_b64_tr_b16 a[202:203], v212 offset:3840
    v_mfma_f32_16x16x32_bf16 v[52:55], a[220:223], a[180:183], v[52:55]
    v_mfma_f32_16x16x32_bf16 v[52:55], a[216:219], a[164:167], v[52:55]
    v_mfma_f32_16x16x32_bf16 v[56:59], a[216:219], a[168:171], v[56:59]
    ds_read_b64_tr_b16 a[204:205], v212 offset:17408
    v_mfma_f32_16x16x32_bf16 v[56:59], a[220:223], a[184:187], v[56:59]
    ds_read_b64_tr_b16 a[206:207], v212 offset:18176
    v_mfma_f32_16x16x32_bf16 v[60:63], a[220:223], a[188:191], v[60:63]
    v_mfma_f32_16x16x32_bf16 v[60:63], a[216:219], a[172:175], v[60:63]
    s_waitcnt lgkmcnt(8)
    s_cmp_lg_u32 s52, 6
    s_cbranch_scc1 F_pw_12
    s_xor_b32 s53, s2, 1
    s_lshl_b32 s53, s53, 2
    s_add_u32 s53, s53, s40
    s_mul_i32 s54, s53, 7168
    buffer_load_dword a255, v231, s[28:31], s54 offen
    s_lshl_b32 s54, s53, 11
    s_mov_b64 exec, 0xffff
    buffer_load_dword a254, v231, s[32:35], s54 offen
    s_mov_b64 exec, -1
F_pw_12:
    v_mfma_f32_16x16x32_bf16 v[76:79], a[172:175], a[224:227], v[76:79]
    ds_read_b64_tr_b16 a[208:209], v213 offset:3072
    v_mfma_f32_16x16x32_bf16 v[76:79], a[188:191], a[228:231], v[76:79]
    s_add_u32 m0, s50, 61440
    ds_read_b64_tr_b16 a[210:211], v213 offset:3840
    v_mfma_f32_16x16x32_bf16 v[72:75], a[184:187], a[228:231], v[72:75]
    buffer_load_dwordx4 v242, s[24:27], s48 offen offset:0 lds
    v_mfma_f32_16x16x32_bf16 v[72:75], a[168:171], a[224:227], v[72:75]
    v_mfma_f32_16x16x32_bf16 v[68:71], a[164:167], a[224:227], v[68:71]
    ds_read_b64_tr_b16 a[212:213], v213 offset:17408
    v_mfma_f32_16x16x32_bf16 v[68:71], a[180:183], a[228:231], v[68:71]
    ds_read_b64_tr_b16 a[214:215], v213 offset:18176
    v_mfma_f32_16x16x32_bf16 v[64:67], a[176:179], a[228:231], v[64:67]
    v_mfma_f32_16x16x32_bf16 v[64:67], a[160:163], a[224:227], v[64:67]
    s_waitcnt lgkmcnt(8)
    v_mfma_f32_16x16x32_bf16 v[80:83], a[160:163], a[192:195], v[80:83]
    ds_read_b64_tr_b16 a[216:217], v212 offset:3136
    v_mfma_f32_16x16x32_bf16 v[80:83], a[176:179], a[196:199], v[80:83]
    ds_read_b64_tr_b16 a[218:219], v212 offset:3904
    v_mfma_f32_16x16x32_bf16 v[84:87], a[180:183], a[196:199], v[84:87]
    v_mfma_f32_16x16x32_bf16 v[84:87], a[164:167], a[192:195], v[84:87]
    v_mfma_f32_16x16x32_bf16 v[88:91], a[168:171], a[192:195], v[88:91]
    ds_read_b64_tr_b16 a[220:221], v212 offset:17472
    v_mfma_f32_16x16x32_bf16 v[88:91], a[184:187], a[196:199], v[88:91]
    s_add_u32 m0, s50, 62464
    ds_read_b64_tr_b16 a[222:223], v212 offset:18240
    v_mfma_f32_16x16x32_bf16 v[92:95], a[188:191], a[196:199], v[92:95]
    buffer_load_dwordx4 v243, s[24:27], s48 offen offset:0 lds
    v_mfma_f32_16x16x32_bf16 v[92:95], a[172:175], a[192:195], v[92:95]
    s_waitcnt lgkmcnt(8)
    s_add_u32 s48, s48, s55
    v_mfma_f32_16x16x32_bf16 v[108:111], a[200:203], a[172:175], v[108:111]
    ds_read_b64_tr_b16 a[224:225], v213 offset:3136
    v_mfma_f32_16x16x32_bf16 v[108:111], a[204:207], a[188:191], v[108:111]
    ds_read_b64_tr_b16 a[226:227], v213 offset:3904
    v_mfma_f32_16x16x32_bf16 v[104:107], a[204:207], a[184:187], v[104:107]
    v_mfma_f32_16x16x32_bf16 v[104:107], a[200:203], a[168:171], v[104:107]
    v_mfma_f32_16x16x32_bf16 v[100:103], a[200:203], a[164:167], v[100:103]
    ds_read_b64_tr_b16 a[228:229], v213 offset:17472
    v_mfma_f32_16x16x32_bf16 v[100:103], a[204:207], a[180:183], v[100:103]
    s_add_u32 m0, s50, 63488
    ds_read_b64_tr_b16 a[230:231], v213 offset:18240
    v_mfma_f32_16x16x32_bf16 v[96:99], a[204:207], a[176:179], v[96:99]
    buffer_load_dwordx4 v211, s[24:27], s49 offen offset:0 lds
    v_mfma_f32_16x16x32_bf16 v[96:99], a[200:203], a[160:163], v[96:99]
    s_waitcnt lgkmcnt(8)
    s_add_u32 s49, s49, s55
    v_mfma_f32_16x16x32_bf16 v[112:115], a[208:211], a[160:163], v[112:115]
    ds_read_b64_tr_b16 a[192:193], v212 offset:3200
    v_mfma_f32_16x16x32_bf16 v[112:115], a[212:215], a[176:179], v[112:115]
    ds_read_b64_tr_b16 a[194:195], v212 offset:3968
    v_mfma_f32_16x16x32_bf16 v[116:119], a[212:215], a[180:183], v[116:119]
    v_mfma_f32_16x16x32_bf16 v[116:119], a[208:211], a[164:167], v[116:119]
    v_mfma_f32_16x16x32_bf16 v[120:123], a[208:211], a[168:171], v[120:123]
    ds_read_b64_tr_b16 a[196:197], v212 offset:17536
    v_mfma_f32_16x16x32_bf16 v[120:123], a[212:215], a[184:187], v[120:123]
    ds_read_b64_tr_b16 a[198:199], v212 offset:18304
    v_mfma_f32_16x16x32_bf16 v[124:127], a[212:215], a[188:191], v[124:127]
    v_mfma_f32_16x16x32_bf16 v[124:127], a[208:211], a[172:175], v[124:127]
    s_waitcnt lgkmcnt(8)
    v_mfma_f32_16x16x32_bf16 v[140:143], a[216:219], a[172:175], v[140:143]
    ds_read_b64_tr_b16 a[200:201], v213 offset:3200
    v_mfma_f32_16x16x32_bf16 v[140:143], a[220:223], a[188:191], v[140:143]
    ds_read_b64_tr_b16 a[202:203], v213 offset:3968
    v_mfma_f32_16x16x32_bf16 v[136:139], a[220:223], a[184:187], v[136:139]
    buffer_load_dwordx4 a[64:67], v208, s[36:39], s51 offen offset:0 sc1
    v_mfma_f32_16x16x32_bf16 v[136:139], a[216:219], a[168:171], v[136:139]
    v_mfma_f32_16x16x32_bf16 v[132:135], a[216:219], a[164:167], v[132:135]
    ds_read_b64_tr_b16 a[204:205], v213 offset:17536
    v_mfma_f32_16x16x32_bf16 v[132:135], a[220:223], a[180:183], v[132:135]
    ds_read_b64_tr_b16 a[206:207], v213 offset:18304
    v_mfma_f32_16x16x32_bf16 v[128:131], a[220:223], a[176:179], v[128:131]
    v_mfma_f32_16x16x32_bf16 v[128:131], a[216:219], a[160:163], v[128:131]
    s_waitcnt lgkmcnt(8)
    v_mfma_f32_16x16x32_bf16 v[144:147], a[224:227], a[160:163], v[144:147]
    ds_read_b64_tr_b16 a[208:209], v214 offset:6144
    v_mfma_f32_16x16x32_bf16 v[144:147], a[228:231], a[176:179], v[144:147]
    ds_read_b64_tr_b16 a[210:211], v214 offset:6400
    v_mfma_f32_16x16x32_bf16 v[148:151], a[228:231], a[180:183], v[148:151]
    buffer_load_dwordx4 a[68:71], v208, s[36:39], s51 offen offset:1024 sc1
    v_mfma_f32_16x16x32_bf16 v[148:151], a[224:227], a[164:167], v[148:151]
    v_mfma_f32_16x16x32_bf16 v[152:155], a[224:227], a[168:171], v[152:155]
    ds_read_b64_tr_b16 a[212:213], v214 offset:20480
    v_mfma_f32_16x16x32_bf16 v[152:155], a[228:231], a[184:187], v[152:155]
    ds_read_b64_tr_b16 a[214:215], v214 offset:20736
    v_mfma_f32_16x16x32_bf16 v[156:159], a[228:231], a[188:191], v[156:159]
    v_mfma_f32_16x16x32_bf16 v[156:159], a[224:227], a[172:175], v[156:159]
    s_waitcnt lgkmcnt(8)
    s_waitcnt vmcnt(32)
    s_barrier
    v_mfma_f32_16x16x32_bf16 v[172:175], a[192:195], a[172:175], v[172:175]
    ds_read_b64_tr_b16 a[216:217], v218 offset:0
    v_mfma_f32_16x16x32_bf16 v[172:175], a[196:199], a[188:191], v[172:175]
    ds_read_b64_tr_b16 a[218:219], v218 offset:768
    v_mfma_f32_16x16x32_bf16 v[168:171], a[196:199], a[184:187], v[168:171]
    v_mfma_f32_16x16x32_bf16 v[168:171], a[192:195], a[168:171], v[168:171]
    s_cmp_lg_u32 s52, 7
    s_cbranch_scc1 F_pw_13
    s_xor_b32 s53, s2, 1
    s_lshl_b32 s53, s53, 2
    s_add_u32 s53, s53, s40
    s_mul_i32 s54, s53, 7168
    buffer_load_dword a255, v231, s[28:31], s54 offen
    s_lshl_b32 s54, s53, 11
    s_mov_b64 exec, 0xffff
    buffer_load_dword a254, v231, s[32:35], s54 offen
    s_mov_b64 exec, -1
F_pw_13:
    v_mfma_f32_16x16x32_bf16 v[164:167], a[192:195], a[164:167], v[164:167]
    ds_read_b64_tr_b16 a[220:221], v218 offset:14336
    v_mfma_f32_16x16x32_bf16 v[164:167], a[196:199], a[180:183], v[164:167]
    ds_read_b64_tr_b16 a[222:223], v218 offset:15104
    v_mfma_f32_16x16x32_bf16 v[160:163], a[196:199], a[176:179], v[160:163]
    buffer_load_dwordx4 a[72:75], v208, s[36:39], s51 offen offset:2048 sc1
    v_mfma_f32_16x16x32_bf16 v[160:163], a[192:195], a[160:163], v[160:163]
    s_waitcnt lgkmcnt(8)
    v_mfma_f32_16x16x32_bf16 v[176:179], a[200:203], a[160:163], v[176:179]
    ds_read_b64_tr_b16 a[224:225], v219 offset:0
    v_mfma_f32_16x16x32_bf16 v[176:179], a[204:207], a[176:179], v[176:179]
    ds_read_b64_tr_b16 a[226:227], v219 offset:768
    v_mfma_f32_16x16x32_bf16 v[180:183], a[204:207], a[180:183], v[180:183]
    v_mfma_f32_16x16x32_bf16 v[180:183], a[200:203], a[164:167], v[180:183]
    v_mfma_f32_16x16x32_bf16 v[184:187], a[200:203], a[168:171], v[184:187]
    ds_read_b64_tr_b16 a[228:229], v219 offset:14336
    v_mfma_f32_16x16x32_bf16 v[184:187], a[204:207], a[184:187], v[184:187]
    ds_read_b64_tr_b16 a[230:231], v219 offset:15104
    v_mfma_f32_16x16x32_bf16 v[188:191], a[204:207], a[188:191], v[188:191]
    buffer_load_dwordx4 a[76:79], v208, s[36:39], s51 offen offset:3072 sc1
    v_mfma_f32_16x16x32_bf16 v[188:191], a[200:203], a[172:175], v[188:191]
    s_waitcnt lgkmcnt(8)
    s_add_u32 s51, s51, 4096
    v_mfma_f32_16x16x32_bf16 v[204:207], a[208:211], a[172:175], v[204:207]
    ds_read_b64_tr_b16 a[192:193], v218 offset:64
    v_mfma_f32_16x16x32_bf16 v[204:207], a[212:215], a[188:191], v[204:207]
    ds_read_b64_tr_b16 a[194:195], v218 offset:832
    v_mfma_f32_16x16x32_bf16 v[200:203], a[212:215], a[184:187], v[200:203]
    v_mfma_f32_16x16x32_bf16 v[200:203], a[208:211], a[168:171], v[200:203]
    v_mfma_f32_16x16x32_bf16 v[196:199], a[208:211], a[164:167], v[196:199]
    ds_read_b64_tr_b16 a[196:197], v218 offset:14400
    v_mfma_f32_16x16x32_bf16 v[196:199], a[212:215], a[180:183], v[196:199]
    ds_read_b64_tr_b16 a[198:199], v218 offset:15168
    v_mfma_f32_16x16x32_bf16 v[192:195], a[212:215], a[176:179], v[192:195]
    v_mfma_f32_16x16x32_bf16 v[192:195], a[208:211], a[160:163], v[192:195]
    s_waitcnt vmcnt(26) lgkmcnt(8)
    v_mfma_f32_16x16x32_bf16 v[0:3], a[216:219], a[0:3], v[0:3]
    ds_read_b64_tr_b16 a[200:201], v219 offset:64
    v_mfma_f32_16x16x32_bf16 v[0:3], a[220:223], a[16:19], v[0:3]
    ds_read_b64_tr_b16 a[202:203], v219 offset:832
    v_mfma_f32_16x16x32_bf16 v[4:7], a[220:223], a[20:23], v[4:7]
    buffer_load_dwordx4 a[80:83], v208, s[36:39], s51 offen offset:0 sc1
    v_mfma_f32_16x16x32_bf16 v[4:7], a[216:219], a[4:7], v[4:7]
    v_mfma_f32_16x16x32_bf16 v[8:11], a[216:219], a[8:11], v[8:11]
    ds_read_b64_tr_b16 a[204:205], v219 offset:14400
    v_mfma_f32_16x16x32_bf16 v[8:11], a[220:223], a[24:27], v[8:11]
    ds_read_b64_tr_b16 a[206:207], v219 offset:15168
    v_mfma_f32_16x16x32_bf16 v[12:15], a[220:223], a[28:31], v[12:15]
    v_mfma_f32_16x16x32_bf16 v[12:15], a[216:219], a[12:15], v[12:15]
    s_waitcnt lgkmcnt(8)
    v_mfma_f32_16x16x32_bf16 v[28:31], a[224:227], a[12:15], v[28:31]
    ds_read_b64_tr_b16 a[208:209], v218 offset:128
    v_mfma_f32_16x16x32_bf16 v[28:31], a[228:231], a[28:31], v[28:31]
    ds_read_b64_tr_b16 a[210:211], v218 offset:896
    v_mfma_f32_16x16x32_bf16 v[24:27], a[228:231], a[24:27], v[24:27]
    v_mfma_f32_16x16x32_bf16 v[24:27], a[224:227], a[8:11], v[24:27]
    v_mfma_f32_16x16x32_bf16 v[20:23], a[224:227], a[4:7], v[20:23]
    ds_read_b64_tr_b16 a[212:213], v218 offset:14464
    v_mfma_f32_16x16x32_bf16 v[20:23], a[228:231], a[20:23], v[20:23]
    ds_read_b64_tr_b16 a[214:215], v218 offset:15232
    v_mfma_f32_16x16x32_bf16 v[16:19], a[228:231], a[16:19], v[16:19]
    buffer_load_dwordx4 a[84:87], v208, s[36:39], s51 offen offset:1024 sc1
    v_mfma_f32_16x16x32_bf16 v[16:19], a[224:227], a[0:3], v[16:19]
    s_waitcnt lgkmcnt(8)
    v_mfma_f32_16x16x32_bf16 v[32:35], a[192:195], a[0:3], v[32:35]
    ds_read_b64_tr_b16 a[216:217], v219 offset:128
    v_mfma_f32_16x16x32_bf16 v[32:35], a[196:199], a[16:19], v[32:35]
    ds_read_b64_tr_b16 a[218:219], v219 offset:896
    v_mfma_f32_16x16x32_bf16 v[36:39], a[196:199], a[20:23], v[36:39]
    v_mfma_f32_16x16x32_bf16 v[36:39], a[192:195], a[4:7], v[36:39]
    v_mfma_f32_16x16x32_bf16 v[40:43], a[192:195], a[8:11], v[40:43]
    ds_read_b64_tr_b16 a[220:221], v219 offset:14464
    v_mfma_f32_16x16x32_bf16 v[40:43], a[196:199], a[24:27], v[40:43]
    ds_read_b64_tr_b16 a[222:223], v219 offset:15232
    v_mfma_f32_16x16x32_bf16 v[44:47], a[196:199], a[28:31], v[44:47]
    buffer_load_dwordx4 a[88:91], v208, s[36:39], s51 offen offset:2048 sc1
    v_mfma_f32_16x16x32_bf16 v[44:47], a[192:195], a[12:15], v[44:47]
    s_waitcnt lgkmcnt(8)
    v_mfma_f32_16x16x32_bf16 v[60:63], a[200:203], a[12:15], v[60:63]
    ds_read_b64_tr_b16 a[224:225], v218 offset:3072
    v_mfma_f32_16x16x32_bf16 v[60:63], a[204:207], a[28:31], v[60:63]
    ds_read_b64_tr_b16 a[226:227], v218 offset:3840
    v_mfma_f32_16x16x32_bf16 v[56:59], a[204:207], a[24:27], v[56:59]
    v_mfma_f32_16x16x32_bf16 v[56:59], a[200:203], a[8:11], v[56:59]
    v_mfma_f32_16x16x32_bf16 v[52:55], a[200:203], a[4:7], v[52:55]
    ds_read_b64_tr_b16 a[228:229], v218 offset:17408
    v_mfma_f32_16x16x32_bf16 v[52:55], a[204:207], a[20:23], v[52:55]
    ds_read_b64_tr_b16 a[230:231], v218 offset:18176
    v_mfma_f32_16x16x32_bf16 v[48:51], a[204:207], a[16:19], v[48:51]
    v_mfma_f32_16x16x32_bf16 v[48:51], a[200:203], a[0:3], v[48:51]
    s_waitcnt lgkmcnt(8)
    s_cmp_lg_u32 s52, 0
    s_cbranch_scc1 F_pw_14
    s_lshl_b32 s53, s2, 2
    s_add_u32 s53, s53, s40
    s_mul_i32 s54, s53, 7168
    buffer_load_dword a255, v231, s[28:31], s54 offen
    s_lshl_b32 s54, s53, 11
    s_mov_b64 exec, 0xffff
    buffer_load_dword a254, v231, s[32:35], s54 offen
    s_mov_b64 exec, -1
F_pw_14:
    v_mfma_f32_16x16x32_bf16 v[64:67], a[0:3], a[208:211], v[64:67]
    ds_read_b64_tr_b16 a[192:193], v219 offset:3072
    v_mfma_f32_16x16x32_bf16 v[64:67], a[16:19], a[212:215], v[64:67]
    ds_read_b64_tr_b16 a[194:195], v219 offset:3840
    v_mfma_f32_16x16x32_bf16 v[68:71], a[20:23], a[212:215], v[68:71]
    buffer_load_dwordx4 a[92:95], v208, s[36:39], s51 offen offset:3072 sc1
    v_mfma_f32_16x16x32_bf16 v[68:71], a[4:7], a[208:211], v[68:71]
    s_add_u32 s51, s51, s62
    v_mfma_f32_16x16x32_bf16 v[72:75], a[8:11], a[208:211], v[72:75]
    ds_read_b64_tr_b16 a[196:197], v219 offset:17408
    v_mfma_f32_16x16x32_bf16 v[72:75], a[24:27], a[212:215], v[72:75]
    ds_read_b64_tr_b16 a[198:199], v219 offset:18176
    v_mfma_f32_16x16x32_bf16 v[76:79], a[28:31], a[212:215], v[76:79]
    v_mfma_f32_16x16x32_bf16 v[76:79], a[12:15], a[208:211], v[76:79]
    s_waitcnt lgkmcnt(8)
    v_mfma_f32_16x16x32_bf16 v[92:95], a[12:15], a[216:219], v[92:95]
    ds_read_b64_tr_b16 a[200:201], v218 offset:3136
    v_mfma_f32_16x16x32_bf16 v[92:95], a[28:31], a[220:223], v[92:95]
    s_add_u32 m0, s50, 28672
    ds_read_b64_tr_b16 a[202:203], v218 offset:3904
    v_mfma_f32_16x16x32_bf16 v[88:91], a[24:27], a[220:223], v[88:91]
    buffer_load_dwordx4 v209, s[20:23], s46 offen offset:0 lds
    v_mfma_f32_16x16x32_bf16 v[88:91], a[8:11], a[216:219], v[88:91]
    s_mul_i32 s55, s59, 393216
    v_mfma_f32_16x16x32_bf16 v[84:87], a[4:7], a[216:219], v[84:87]
    ds_read_b64_tr_b16 a[204:205], v218 offset:17472
    v_mfma_f32_16x16x32_bf16 v[84:87], a[20:23], a[220:223], v[84:87]
    ds_read_b64_tr_b16 a[206:207], v218 offset:18240
    v_mfma_f32_16x16x32_bf16 v[80:83], a[16:19], a[220:223], v[80:83]
    v_mfma_f32_16x16x32_bf16 v[80:83], a[0:3], a[216:219], v[80:83]
    s_waitcnt lgkmcnt(8)
    v_mfma_f32_16x16x32_bf16 v[96:99], a[224:227], a[0:3], v[96:99]
    ds_read_b64_tr_b16 a[208:209], v219 offset:3136
    v_mfma_f32_16x16x32_bf16 v[96:99], a[228:231], a[16:19], v[96:99]
    s_add_u32 m0, s50, 29696
    ds_read_b64_tr_b16 a[210:211], v219 offset:3904
    v_mfma_f32_16x16x32_bf16 v[100:103], a[228:231], a[20:23], v[100:103]
    buffer_load_dwordx4 v240, s[20:23], s46 offen offset:0 lds
    v_mfma_f32_16x16x32_bf16 v[100:103], a[224:227], a[4:7], v[100:103]
    v_mfma_f32_16x16x32_bf16 v[104:107], a[224:227], a[8:11], v[104:107]
    ds_read_b64_tr_b16 a[212:213], v219 offset:17472
    v_mfma_f32_16x16x32_bf16 v[104:107], a[228:231], a[24:27], v[104:107]
    s_add_u32 m0, s50, 30720
    ds_read_b64_tr_b16 a[214:215], v219 offset:18240
    v_mfma_f32_16x16x32_bf16 v[108:111], a[228:231], a[28:31], v[108:111]
    buffer_load_dwordx4 v241, s[20:23], s46 offen offset:0 lds
    v_mfma_f32_16x16x32_bf16 v[108:111], a[224:227], a[12:15], v[108:111]
    s_waitcnt lgkmcnt(8)
    s_add_u32 s46, s46, s55
    v_mfma_f32_16x16x32_bf16 v[124:127], a[192:195], a[12:15], v[124:127]
    ds_read_b64_tr_b16 a[216:217], v218 offset:3200
    v_mfma_f32_16x16x32_bf16 v[124:127], a[196:199], a[28:31], v[124:127]
    s_add_u32 m0, s50, 31744
    ds_read_b64_tr_b16 a[218:219], v218 offset:3968
    v_mfma_f32_16x16x32_bf16 v[120:123], a[196:199], a[24:27], v[120:123]
    buffer_load_dwordx4 v210, s[24:27], s48 offen offset:0 lds
    v_mfma_f32_16x16x32_bf16 v[120:123], a[192:195], a[8:11], v[120:123]
    s_mul_i32 s55, s59, 458752
    v_mfma_f32_16x16x32_bf16 v[116:119], a[192:195], a[4:7], v[116:119]
    ds_read_b64_tr_b16 a[220:221], v218 offset:17536
    v_mfma_f32_16x16x32_bf16 v[116:119], a[196:199], a[20:23], v[116:119]
    s_add_u32 m0, s50, 32768
    ds_read_b64_tr_b16 a[222:223], v218 offset:18304
    v_mfma_f32_16x16x32_bf16 v[112:115], a[196:199], a[16:19], v[112:115]
    buffer_load_dwordx4 v242, s[24:27], s48 offen offset:0 lds
    v_mfma_f32_16x16x32_bf16 v[112:115], a[192:195], a[0:3], v[112:115]
    s_waitcnt lgkmcnt(8)
    v_mfma_f32_16x16x32_bf16 v[128:131], a[200:203], a[0:3], v[128:131]
    ds_read_b64_tr_b16 a[224:225], v219 offset:3200
    v_mfma_f32_16x16x32_bf16 v[128:131], a[204:207], a[16:19], v[128:131]
    ds_read_b64_tr_b16 a[226:227], v219 offset:3968
    v_mfma_f32_16x16x32_bf16 v[132:135], a[204:207], a[20:23], v[132:135]
    v_mfma_f32_16x16x32_bf16 v[132:135], a[200:203], a[4:7], v[132:135]
    v_mfma_f32_16x16x32_bf16 v[136:139], a[200:203], a[8:11], v[136:139]
    ds_read_b64_tr_b16 a[228:229], v219 offset:17536
    v_mfma_f32_16x16x32_bf16 v[136:139], a[204:207], a[24:27], v[136:139]
    s_add_u32 m0, s50, 33792
    ds_read_b64_tr_b16 a[230:231], v219 offset:18304
    v_mfma_f32_16x16x32_bf16 v[140:143], a[204:207], a[28:31], v[140:143]
    buffer_load_dwordx4 v243, s[24:27], s48 offen offset:0 lds
    v_mfma_f32_16x16x32_bf16 v[140:143], a[200:203], a[12:15], v[140:143]
    s_waitcnt lgkmcnt(8)
    s_add_u32 s48, s48, s55
    v_mfma_f32_16x16x32_bf16 v[156:159], a[208:211], a[12:15], v[156:159]
    ds_read_b64_tr_b16 a[192:193], v220 offset:6144
    v_mfma_f32_16x16x32_bf16 v[156:159], a[212:215], a[28:31], v[156:159]
    s_add_u32 m0, s50, 34816
    ds_read_b64_tr_b16 a[194:195], v220 offset:6400
    v_mfma_f32_16x16x32_bf16 v[152:155], a[212:215], a[24:27], v[152:155]
    buffer_load_dwordx4 v211, s[24:27], s49 offen offset:0 lds
    v_mfma_f32_16x16x32_bf16 v[152:155], a[208:211], a[8:11], v[152:155]
    s_add_u32 s49, s49, s55
    v_mfma_f32_16x16x32_bf16 v[148:151], a[208:211], a[4:7], v[148:151]
    ds_read_b64_tr_b16 a[196:197], v220 offset:20480
    v_mfma_f32_16x16x32_bf16 v[148:151], a[212:215], a[20:23], v[148:151]
    ds_read_b64_tr_b16 a[198:199], v220 offset:20736
    v_mfma_f32_16x16x32_bf16 v[144:147], a[212:215], a[16:19], v[144:147]
    buffer_load_dwordx4 a[96:99], v208, s[36:39], s51 offen offset:0 sc1
    v_mfma_f32_16x16x32_bf16 v[144:147], a[208:211], a[0:3], v[144:147]
    s_waitcnt lgkmcnt(8)
    s_waitcnt vmcnt(31)
    s_barrier
    v_mfma_f32_16x16x32_bf16 v[160:163], a[216:219], a[0:3], v[160:163]
    ds_read_b64_tr_b16 a[200:201], v215 offset:28672
    v_mfma_f32_16x16x32_bf16 v[160:163], a[220:223], a[16:19], v[160:163]
    ds_read_b64_tr_b16 a[202:203], v215 offset:29440
    v_mfma_f32_16x16x32_bf16 v[164:167], a[220:223], a[20:23], v[164:167]
    v_mfma_f32_16x16x32_bf16 v[164:167], a[216:219], a[4:7], v[164:167]
    s_cmp_lg_u32 s52, 1
    s_cbranch_scc1 F_pw_15
    s_lshl_b32 s53, s2, 2
    s_add_u32 s53, s53, s40
    s_mul_i32 s54, s53, 7168
    buffer_load_dword a255, v231, s[28:31], s54 offen
    s_lshl_b32 s54, s53, 11
    s_mov_b64 exec, 0xffff
    buffer_load_dword a254, v231, s[32:35], s54 offen
    s_mov_b64 exec, -1
F_pw_15:
    v_mfma_f32_16x16x32_bf16 v[168:171], a[216:219], a[8:11], v[168:171]
    ds_read_b64_tr_b16 a[204:205], v215 offset:43008
    v_mfma_f32_16x16x32_bf16 v[168:171], a[220:223], a[24:27], v[168:171]
    ds_read_b64_tr_b16 a[206:207], v215 offset:43776
    v_mfma_f32_16x16x32_bf16 v[172:175], a[220:223], a[28:31], v[172:175]
    buffer_load_dwordx4 a[100:103], v208, s[36:39], s51 offen offset:1024 sc1
    v_mfma_f32_16x16x32_bf16 v[172:175], a[216:219], a[12:15], v[172:175]
    s_waitcnt lgkmcnt(8)
    v_mfma_f32_16x16x32_bf16 v[188:191], a[224:227], a[12:15], v[188:191]
    ds_read_b64_tr_b16 a[208:209], v216 offset:28672
    v_mfma_f32_16x16x32_bf16 v[188:191], a[228:231], a[28:31], v[188:191]
    ds_read_b64_tr_b16 a[210:211], v216 offset:29440
    v_mfma_f32_16x16x32_bf16 v[184:187], a[228:231], a[24:27], v[184:187]
    buffer_load_dwordx4 a[104:107], v208, s[36:39], s51 offen offset:2048 sc1
    v_mfma_f32_16x16x32_bf16 v[184:187], a[224:227], a[8:11], v[184:187]
    v_mfma_f32_16x16x32_bf16 v[180:183], a[224:227], a[4:7], v[180:183]
    ds_read_b64_tr_b16 a[212:213], v216 offset:43008
    v_mfma_f32_16x16x32_bf16 v[180:183], a[228:231], a[20:23], v[180:183]
    ds_read_b64_tr_b16 a[214:215], v216 offset:43776
    v_mfma_f32_16x16x32_bf16 v[176:179], a[228:231], a[16:19], v[176:179]
    buffer_load_dwordx4 a[108:111], v208, s[36:39], s51 offen offset:3072 sc1
    v_mfma_f32_16x16x32_bf16 v[176:179], a[224:227], a[0:3], v[176:179]
    s_waitcnt lgkmcnt(8)
    s_add_u32 s51, s51, 4096
    v_mfma_f32_16x16x32_bf16 v[192:195], a[192:195], a[0:3], v[192:195]
    ds_read_b64_tr_b16 a[216:217], v215 offset:28736
    v_mfma_f32_16x16x32_bf16 v[192:195], a[196:199], a[16:19], v[192:195]
    ds_read_b64_tr_b16 a[218:219], v215 offset:29504
    v_mfma_f32_16x16x32_bf16 v[196:199], a[196:199], a[20:23], v[196:199]
    buffer_load_dwordx4 a[112:115], v208, s[36:39], s51 offen offset:0 sc1
    v_mfma_f32_16x16x32_bf16 v[196:199], a[192:195], a[4:7], v[196:199]
    v_mfma_f32_16x16x32_bf16 v[200:203], a[192:195], a[8:11], v[200:203]
    ds_read_b64_tr_b16 a[220:221], v215 offset:43072
    v_mfma_f32_16x16x32_bf16 v[200:203], a[196:199], a[24:27], v[200:203]
    ds_read_b64_tr_b16 a[222:223], v215 offset:43840
    v_mfma_f32_16x16x32_bf16 v[204:207], a[196:199], a[28:31], v[204:207]
    v_mfma_f32_16x16x32_bf16 v[204:207], a[192:195], a[12:15], v[204:207]
    s_waitcnt vmcnt(27) lgkmcnt(8)
    v_mfma_f32_16x16x32_bf16 v[12:15], a[200:203], a[44:47], v[12:15]
    ds_read_b64_tr_b16 a[224:225], v216 offset:28736
    v_mfma_f32_16x16x32_bf16 v[12:15], a[204:207], a[60:63], v[12:15]
    ds_read_b64_tr_b16 a[226:227], v216 offset:29504
    v_mfma_f32_16x16x32_bf16 v[8:11], a[204:207], a[56:59], v[8:11]
    buffer_load_dwordx4 a[116:119], v208, s[36:39], s51 offen offset:1024 sc1
    v_mfma_f32_16x16x32_bf16 v[8:11], a[200:203], a[40:43], v[8:11]
    v_mfma_f32_16x16x32_bf16 v[4:7], a[200:203], a[36:39], v[4:7]
    ds_read_b64_tr_b16 a[228:229], v216 offset:43072
    v_mfma_f32_16x16x32_bf16 v[4:7], a[204:207], a[52:55], v[4:7]
    ds_read_b64_tr_b16 a[230:231], v216 offset:43840
    v_mfma_f32_16x16x32_bf16 v[0:3], a[204:207], a[48:51], v[0:3]
    buffer_load_dwordx4 a[120:123], v208, s[36:39], s51 offen offset:2048 sc1
    v_mfma_f32_16x16x32_bf16 v[0:3], a[200:203], a[32:35], v[0:3]
    s_waitcnt lgkmcnt(8)
    v_mfma_f32_16x16x32_bf16 v[16:19], a[208:211], a[32:35], v[16:19]
    ds_read_b64_tr_b16 a[192:193], v215 offset:28800
    v_mfma_f32_16x16x32_bf16 v[16:19], a[212:215], a[48:51], v[16:19]
    ds_read_b64_tr_b16 a[194:195], v215 offset:29568
    v_mfma_f32_16x16x32_bf16 v[20:23], a[212:215], a[52:55], v[20:23]
    buffer_load_dwordx4 a[124:127], v208, s[36:39], s51 offen offset:3072 sc1
    v_mfma_f32_16x16x32_bf16 v[20:23], a[208:211], a[36:39], v[20:23]
    s_add_u32 s51, s51, s63
    v_mfma_f32_16x16x32_bf16 v[24:27], a[208:211], a[40:43], v[24:27]
    ds_read_b64_tr_b16 a[196:197], v215 offset:43136
    v_mfma_f32_16x16x32_bf16 v[24:27], a[212:215], a[56:59], v[24:27]
    ds_read_b64_tr_b16 a[198:199], v215 offset:43904
    v_mfma_f32_16x16x32_bf16 v[28:31], a[212:215], a[60:63], v[28:31]
    v_mfma_f32_16x16x32_bf16 v[28:31], a[208:211], a[44:47], v[28:31]
    s_waitcnt lgkmcnt(8)
    v_mfma_f32_16x16x32_bf16 v[44:47], a[216:219], a[44:47], v[44:47]
    ds_read_b64_tr_b16 a[200:201], v216 offset:28800
    v_mfma_f32_16x16x32_bf16 v[44:47], a[220:223], a[60:63], v[44:47]
    s_add_u32 m0, s50, 0
    ds_read_b64_tr_b16 a[202:203], v216 offset:29568
    v_mfma_f32_16x16x32_bf16 v[40:43], a[220:223], a[56:59], v[40:43]
    buffer_load_dwordx4 v209, s[20:23], s46 offen offset:0 lds
    v_mfma_f32_16x16x32_bf16 v[40:43], a[216:219], a[40:43], v[40:43]
    s_mul_i32 s55, s60, 393216
    v_mfma_f32_16x16x32_bf16 v[36:39], a[216:219], a[36:39], v[36:39]
    ds_read_b64_tr_b16 a[204:205], v216 offset:43136
    v_mfma_f32_16x16x32_bf16 v[36:39], a[220:223], a[52:55], v[36:39]
    s_add_u32 m0, s50, 1024
    ds_read_b64_tr_b16 a[206:207], v216 offset:43904
    v_mfma_f32_16x16x32_bf16 v[32:35], a[220:223], a[48:51], v[32:35]
    buffer_load_dwordx4 v240, s[20:23], s46 offen offset:0 lds
    v_mfma_f32_16x16x32_bf16 v[32:35], a[216:219], a[32:35], v[32:35]
    s_waitcnt lgkmcnt(8)
    v_mfma_f32_16x16x32_bf16 v[48:51], a[224:227], a[32:35], v[48:51]
    ds_read_b64_tr_b16 a[208:209], v215 offset:31744
    v_mfma_f32_16x16x32_bf16 v[48:51], a[228:231], a[48:51], v[48:51]
    s_add_u32 m0, s50, 2048
    ds_read_b64_tr_b16 a[210:211], v215 offset:32512
    v_mfma_f32_16x16x32_bf16 v[52:55], a[228:231], a[52:55], v[52:55]
    buffer_load_dwordx4 v241, s[20:23], s46 offen offset:0 lds
    v_mfma_f32_16x16x32_bf16 v[52:55], a[224:227], a[36:39], v[52:55]
    s_add_u32 s46, s46, s55
    v_mfma_f32_16x16x32_bf16 v[56:59], a[224:227], a[40:43], v[56:59]
    ds_read_b64_tr_b16 a[212:213], v215 offset:46080
    v_mfma_f32_16x16x32_bf16 v[56:59], a[228:231], a[56:59], v[56:59]
    s_add_u32 m0, s50, 3072
    ds_read_b64_tr_b16 a[214:215], v215 offset:46848
    v_mfma_f32_16x16x32_bf16 v[60:63], a[228:231], a[60:63], v[60:63]
    buffer_load_dwordx4 v210, s[24:27], s48 offen offset:0 lds
    v_mfma_f32_16x16x32_bf16 v[60:63], a[224:227], a[44:47], v[60:63]
    s_waitcnt lgkmcnt(8)
    s_mul_i32 s55, s60, 458752
    s_cmp_lg_u32 s52, 2
    s_cbranch_scc1 F_pw_16
    s_lshl_b32 s53, s2, 2
    s_add_u32 s53, s53, s40
    s_mul_i32 s54, s53, 7168
    buffer_load_dword a255, v231, s[28:31], s54 offen
    s_lshl_b32 s54, s53, 11
    s_mov_b64 exec, 0xffff
    buffer_load_dword a254, v231, s[32:35], s54 offen
    s_mov_b64 exec, -1
F_pw_16:
    v_mfma_f32_16x16x32_bf16 v[76:79], a[44:47], a[192:195], v[76:79]
    ds_read_b64_tr_b16 a[216:217], v216 offset:31744
    v_mfma_f32_16x16x32_bf16 v[76:79], a[60:63], a[196:199], v[76:79]
    ds_read_b64_tr_b16 a[218:219], v216 offset:32512
    v_mfma_f32_16x16x32_bf16 v[72:75], a[56:59], a[196:199], v[72:75]
    v_mfma_f32_16x16x32_bf16 v[72:75], a[40:43], a[192:195], v[72:75]
    v_mfma_f32_16x16x32_bf16 v[68:71], a[36:39], a[192:195], v[68:71]
    ds_read_b64_tr_b16 a[220:221], v216 offset:46080
    v_mfma_f32_16x16x32_bf16 v[68:71], a[52:55], a[196:199], v[68:71]
    s_add_u32 m0, s50, 4096
    ds_read_b64_tr_b16 a[222:223], v216 offset:46848
    v_mfma_f32_16x16x32_bf16 v[64:67], a[48:51], a[196:199], v[64:67]
    buffer_load_dwordx4 v242, s[24:27], s48 offen offset:0 lds
    v_mfma_f32_16x16x32_bf16 v[64:67], a[32:35], a[192:195], v[64:67]
    s_waitcnt lgkmcnt(8)
    v_mfma_f32_16x16x32_bf16 v[80:83], a[32:35], a[200:203], v[80:83]
    ds_read_b64_tr_b16 a[224:225], v215 offset:31808
    v_mfma_f32_16x16x32_bf16 v[80:83], a[48:51], a[204:207], v[80:83]
    s_add_u32 m0, s50, 5120
    ds_read_b64_tr_b16 a[226:227], v215 offset:32576
    v_mfma_f32_16x16x32_bf16 v[84:87], a[52:55], a[204:207], v[84:87]
    buffer_load_dwordx4 v243, s[24:27], s48 offen offset:0 lds
    v_mfma_f32_16x16x32_bf16 v[84:87], a[36:39], a[200:203], v[84:87]
    s_add_u32 s48, s48, s55
    v_mfma_f32_16x16x32_bf16 v[88:91], a[40:43], a[200:203], v[88:91]
    ds_read_b64_tr_b16 a[228:229], v215 offset:46144
    v_mfma_f32_16x16x32_bf16 v[88:91], a[56:59], a[204:207], v[88:91]
    s_add_u32 m0, s50, 6144
    ds_read_b64_tr_b16 a[230:231], v215 offset:46912
    v_mfma_f32_16x16x32_bf16 v[92:95], a[60:63], a[204:207], v[92:95]
    buffer_load_dwordx4 v211, s[24:27], s49 offen offset:0 lds
    v_mfma_f32_16x16x32_bf16 v[92:95], a[44:47], a[200:203], v[92:95]
    s_waitcnt lgkmcnt(8)
    s_add_u32 s49, s49, s55
    v_mfma_f32_16x16x32_bf16 v[108:111], a[208:211], a[44:47], v[108:111]
    ds_read_b64_tr_b16 a[192:193], v216 offset:31808
    v_mfma_f32_16x16x32_bf16 v[108:111], a[212:215], a[60:63], v[108:111]
    ds_read_b64_tr_b16 a[194:195], v216 offset:32576
    v_mfma_f32_16x16x32_bf16 v[104:107], a[212:215], a[56:59], v[104:107]
    v_mfma_f32_16x16x32_bf16 v[104:107], a[208:211], a[40:43], v[104:107]
    v_mfma_f32_16x16x32_bf16 v[100:103], a[208:211], a[36:39], v[100:103]
    ds_read_b64_tr_b16 a[196:197], v216 offset:46144
    v_mfma_f32_16x16x32_bf16 v[100:103], a[212:215], a[52:55], v[100:103]
    ds_read_b64_tr_b16 a[198:199], v216 offset:46912
    v_mfma_f32_16x16x32_bf16 v[96:99], a[212:215], a[48:51], v[96:99]
    buffer_load_dwordx4 a[128:131], v208, s[36:39], s51 offen offset:0 sc1
    v_mfma_f32_16x16x32_bf16 v[96:99], a[208:211], a[32:35], v[96:99]
    s_waitcnt lgkmcnt(8)
    v_mfma_f32_16x16x32_bf16 v[112:115], a[216:219], a[32:35], v[112:115]
    ds_read_b64_tr_b16 a[200:201], v215 offset:31872
    v_mfma_f32_16x16x32_bf16 v[112:115], a[220:223], a[48:51], v[112:115]
    ds_read_b64_tr_b16 a[202:203], v215 offset:32640
    v_mfma_f32_16x16x32_bf16 v[116:119], a[220:223], a[52:55], v[116:119]
    buffer_load_dwordx4 a[132:135], v208, s[36:39], s51 offen offset:1024 sc1
    v_mfma_f32_16x16x32_bf16 v[116:119], a[216:219], a[36:39], v[116:119]
    v_mfma_f32_16x16x32_bf16 v[120:123], a[216:219], a[40:43], v[120:123]
    ds_read_b64_tr_b16 a[204:205], v215 offset:46208
    v_mfma_f32_16x16x32_bf16 v[120:123], a[220:223], a[56:59], v[120:123]
    ds_read_b64_tr_b16 a[206:207], v215 offset:46976
    v_mfma_f32_16x16x32_bf16 v[124:127], a[220:223], a[60:63], v[124:127]
    buffer_load_dwordx4 a[136:139], v208, s[36:39], s51 offen offset:2048 sc1
    v_mfma_f32_16x16x32_bf16 v[124:127], a[216:219], a[44:47], v[124:127]
    s_waitcnt lgkmcnt(8)
    v_mfma_f32_16x16x32_bf16 v[140:143], a[224:227], a[44:47], v[140:143]
    ds_read_b64_tr_b16 a[208:209], v216 offset:31872
    v_mfma_f32_16x16x32_bf16 v[140:143], a[228:231], a[60:63], v[140:143]
    ds_read_b64_tr_b16 a[210:211], v216 offset:32640
    v_mfma_f32_16x16x32_bf16 v[136:139], a[228:231], a[56:59], v[136:139]
    buffer_load_dwordx4 a[140:143], v208, s[36:39], s51 offen offset:3072 sc1
    v_mfma_f32_16x16x32_bf16 v[136:139], a[224:227], a[40:43], v[136:139]
    s_add_u32 s51, s51, 4096
    v_mfma_f32_16x16x32_bf16 v[132:135], a[224:227], a[36:39], v[132:135]
    ds_read_b64_tr_b16 a[212:213], v216 offset:46208
    v_mfma_f32_16x16x32_bf16 v[132:135], a[228:231], a[52:55], v[132:135]
    ds_read_b64_tr_b16 a[214:215], v216 offset:46976
    v_mfma_f32_16x16x32_bf16 v[128:131], a[228:231], a[48:51], v[128:131]
    v_mfma_f32_16x16x32_bf16 v[128:131], a[224:227], a[32:35], v[128:131]
    s_waitcnt lgkmcnt(8)
    v_mfma_f32_16x16x32_bf16 v[144:147], a[192:195], a[32:35], v[144:147]
    ds_read_b64_tr_b16 a[216:217], v217 offset:34816
    v_mfma_f32_16x16x32_bf16 v[144:147], a[196:199], a[48:51], v[144:147]
    ds_read_b64_tr_b16 a[218:219], v217 offset:35072
    v_mfma_f32_16x16x32_bf16 v[148:151], a[196:199], a[52:55], v[148:151]
    buffer_load_dwordx4 a[144:147], v208, s[36:39], s51 offen offset:0 sc1
    v_mfma_f32_16x16x32_bf16 v[148:151], a[192:195], a[36:39], v[148:151]
    v_mfma_f32_16x16x32_bf16 v[152:155], a[192:195], a[40:43], v[152:155]
    ds_read_b64_tr_b16 a[220:221], v217 offset:49152
    v_mfma_f32_16x16x32_bf16 v[152:155], a[196:199], a[56:59], v[152:155]
    ds_read_b64_tr_b16 a[222:223], v217 offset:49408
    v_mfma_f32_16x16x32_bf16 v[156:159], a[196:199], a[60:63], v[156:159]
    buffer_load_dwordx4 a[148:151], v208, s[36:39], s51 offen offset:1024 sc1
    v_mfma_f32_16x16x32_bf16 v[156:159], a[192:195], a[44:47], v[156:159]
    s_waitcnt lgkmcnt(8)
    s_waitcnt vmcnt(36)
    s_barrier
    v_mfma_f32_16x16x32_bf16 v[172:175], a[200:203], a[44:47], v[172:175]
    ds_read_b64_tr_b16 a[224:225], v215 offset:0
    v_mfma_f32_16x16x32_bf16 v[172:175], a[204:207], a[60:63], v[172:175]
    ds_read_b64_tr_b16 a[226:227], v215 offset:768
    v_mfma_f32_16x16x32_bf16 v[168:171], a[204:207], a[56:59], v[168:171]
    buffer_load_dwordx4 a[152:155], v208, s[36:39], s51 offen offset:2048 sc1
    v_mfma_f32_16x16x32_bf16 v[168:171], a[200:203], a[40:43], v[168:171]
    s_cmp_lg_u32 s52, 3
    s_cbranch_scc1 F_pw_17
    s_lshl_b32 s53, s2, 2
    s_add_u32 s53, s53, s40
    s_mul_i32 s54, s53, 7168
    buffer_load_dword a255, v231, s[28:31], s54 offen
    s_lshl_b32 s54, s53, 11
    s_mov_b64 exec, 0xffff
    buffer_load_dword a254, v231, s[32:35], s54 offen
    s_mov_b64 exec, -1
F_pw_17:
    v_mfma_f32_16x16x32_bf16 v[164:167], a[200:203], a[36:39], v[164:167]
    ds_read_b64_tr_b16 a[228:229], v215 offset:14336
    v_mfma_f32_16x16x32_bf16 v[164:167], a[204:207], a[52:55], v[164:167]
    ds_read_b64_tr_b16 a[230:231], v215 offset:15104
    v_mfma_f32_16x16x32_bf16 v[160:163], a[204:207], a[48:51], v[160:163]
    v_mfma_f32_16x16x32_bf16 v[160:163], a[200:203], a[32:35], v[160:163]
    s_waitcnt lgkmcnt(8)
    v_mfma_f32_16x16x32_bf16 v[176:179], a[208:211], a[32:35], v[176:179]
    ds_read_b64_tr_b16 a[192:193], v216 offset:0
    v_mfma_f32_16x16x32_bf16 v[176:179], a[212:215], a[48:51], v[176:179]
    ds_read_b64_tr_b16 a[194:195], v216 offset:768
    v_mfma_f32_16x16x32_bf16 v[180:183], a[212:215], a[52:55], v[180:183]
    buffer_load_dwordx4 a[156:159], v208, s[36:39], s51 offen offset:3072 sc1
    v_mfma_f32_16x16x32_bf16 v[180:183], a[208:211], a[36:39], v[180:183]
    s_add_u32 s51, s51, s64
    v_mfma_f32_16x16x32_bf16 v[184:187], a[208:211], a[40:43], v[184:187]
    ds_read_b64_tr_b16 a[196:197], v216 offset:14336
    v_mfma_f32_16x16x32_bf16 v[184:187], a[212:215], a[56:59], v[184:187]
    s_add_u32 m0, s50, 114688
    ds_read_b64_tr_b16 a[198:199], v216 offset:15104
    v_mfma_f32_16x16x32_bf16 v[188:191], a[212:215], a[60:63], v[188:191]
    buffer_load_dwordx4 v209, s[20:23], s46 offen offset:0 lds
    v_mfma_f32_16x16x32_bf16 v[188:191], a[208:211], a[44:47], v[188:191]
    s_waitcnt lgkmcnt(8)
    s_mul_i32 s55, s61, 393216
    v_mfma_f32_16x16x32_bf16 v[204:207], a[216:219], a[44:47], v[204:207]
    ds_read_b64_tr_b16 a[200:201], v215 offset:64
    v_mfma_f32_16x16x32_bf16 v[204:207], a[220:223], a[60:63], v[204:207]
    s_add_u32 m0, s50, 115712
    ds_read_b64_tr_b16 a[202:203], v215 offset:832
    v_mfma_f32_16x16x32_bf16 v[200:203], a[220:223], a[56:59], v[200:203]
    buffer_load_dwordx4 v240, s[20:23], s46 offen offset:0 lds
    v_mfma_f32_16x16x32_bf16 v[200:203], a[216:219], a[40:43], v[200:203]
    v_mfma_f32_16x16x32_bf16 v[196:199], a[216:219], a[36:39], v[196:199]
    ds_read_b64_tr_b16 a[204:205], v215 offset:14400
    v_mfma_f32_16x16x32_bf16 v[196:199], a[220:223], a[52:55], v[196:199]
    s_add_u32 m0, s50, 116736
    ds_read_b64_tr_b16 a[206:207], v215 offset:15168
    v_mfma_f32_16x16x32_bf16 v[192:195], a[220:223], a[48:51], v[192:195]
    buffer_load_dwordx4 v241, s[20:23], s46 offen offset:0 lds
    v_mfma_f32_16x16x32_bf16 v[192:195], a[216:219], a[32:35], v[192:195]
    s_waitcnt vmcnt(33) lgkmcnt(8)
    s_add_u32 s46, s46, s55
    v_mfma_f32_16x16x32_bf16 v[0:3], a[224:227], a[64:67], v[0:3]
    ds_read_b64_tr_b16 a[208:209], v216 offset:64
    v_mfma_f32_16x16x32_bf16 v[0:3], a[228:231], a[80:83], v[0:3]
    ds_read_b64_tr_b16 a[210:211], v216 offset:832
    v_mfma_f32_16x16x32_bf16 v[4:7], a[228:231], a[84:87], v[4:7]
    v_mfma_f32_16x16x32_bf16 v[4:7], a[224:227], a[68:71], v[4:7]
    v_mfma_f32_16x16x32_bf16 v[8:11], a[224:227], a[72:75], v[8:11]
    ds_read_b64_tr_b16 a[212:213], v216 offset:14400
    v_mfma_f32_16x16x32_bf16 v[8:11], a[228:231], a[88:91], v[8:11]
    s_add_u32 m0, s50, 117760
    ds_read_b64_tr_b16 a[214:215], v216 offset:15168
    v_mfma_f32_16x16x32_bf16 v[12:15], a[228:231], a[92:95], v[12:15]
    buffer_load_dwordx4 v210, s[24:27], s48 offen offset:0 lds
    v_mfma_f32_16x16x32_bf16 v[12:15], a[224:227], a[76:79], v[12:15]
    s_waitcnt lgkmcnt(8)
    s_mul_i32 s55, s61, 458752
    v_mfma_f32_16x16x32_bf16 v[28:31], a[192:195], a[76:79], v[28:31]
    ds_read_b64_tr_b16 a[216:217], v215 offset:128
    v_mfma_f32_16x16x32_bf16 v[28:31], a[196:199], a[92:95], v[28:31]
    s_add_u32 m0, s50, 118784
    ds_read_b64_tr_b16 a[218:219], v215 offset:896
    v_mfma_f32_16x16x32_bf16 v[24:27], a[196:199], a[88:91], v[24:27]
    buffer_load_dwordx4 v242, s[24:27], s48 offen offset:0 lds
    v_mfma_f32_16x16x32_bf16 v[24:27], a[192:195], a[72:75], v[24:27]
    v_mfma_f32_16x16x32_bf16 v[20:23], a[192:195], a[68:71], v[20:23]
    ds_read_b64_tr_b16 a[220:221], v215 offset:14464
    v_mfma_f32_16x16x32_bf16 v[20:23], a[196:199], a[84:87], v[20:23]
    s_add_u32 m0, s50, 119808
    ds_read_b64_tr_b16 a[222:223], v215 offset:15232
    v_mfma_f32_16x16x32_bf16 v[16:19], a[196:199], a[80:83], v[16:19]
    buffer_load_dwordx4 v243, s[24:27], s48 offen offset:0 lds
    v_mfma_f32_16x16x32_bf16 v[16:19], a[192:195], a[64:67], v[16:19]
    s_waitcnt lgkmcnt(8)
    s_add_u32 s48, s48, s55
    v_mfma_f32_16x16x32_bf16 v[32:35], a[200:203], a[64:67], v[32:35]
    ds_read_b64_tr_b16 a[224:225], v216 offset:128
    v_mfma_f32_16x16x32_bf16 v[32:35], a[204:207], a[80:83], v[32:35]
    ds_read_b64_tr_b16 a[226:227], v216 offset:896
    v_mfma_f32_16x16x32_bf16 v[36:39], a[204:207], a[84:87], v[36:39]
    v_mfma_f32_16x16x32_bf16 v[36:39], a[200:203], a[68:71], v[36:39]
    v_mfma_f32_16x16x32_bf16 v[40:43], a[200:203], a[72:75], v[40:43]
    ds_read_b64_tr_b16 a[228:229], v216 offset:14464
    v_mfma_f32_16x16x32_bf16 v[40:43], a[204:207], a[88:91], v[40:43]
    s_add_u32 m0, s50, 120832
    ds_read_b64_tr_b16 a[230:231], v216 offset:15232
    v_mfma_f32_16x16x32_bf16 v[44:47], a[204:207], a[92:95], v[44:47]
    buffer_load_dwordx4 v211, s[24:27], s49 offen offset:0 lds
    v_mfma_f32_16x16x32_bf16 v[44:47], a[200:203], a[76:79], v[44:47]
    s_waitcnt lgkmcnt(8)
    s_add_u32 s49, s49, s55
    v_mfma_f32_16x16x32_bf16 v[60:63], a[208:211], a[76:79], v[60:63]
    ds_read_b64_tr_b16 a[192:193], v215 offset:3072
    v_mfma_f32_16x16x32_bf16 v[60:63], a[212:215], a[92:95], v[60:63]
    ds_read_b64_tr_b16 a[194:195], v215 offset:3840
    v_mfma_f32_16x16x32_bf16 v[56:59], a[212:215], a[88:91], v[56:59]
    buffer_load_dwordx4 a[160:163], v208, s[36:39], s51 offen offset:0 sc1
    v_mfma_f32_16x16x32_bf16 v[56:59], a[208:211], a[72:75], v[56:59]
    v_mfma_f32_16x16x32_bf16 v[52:55], a[208:211], a[68:71], v[52:55]
    ds_read_b64_tr_b16 a[196:197], v215 offset:17408
    v_mfma_f32_16x16x32_bf16 v[52:55], a[212:215], a[84:87], v[52:55]
    ds_read_b64_tr_b16 a[198:199], v215 offset:18176
    v_mfma_f32_16x16x32_bf16 v[48:51], a[212:215], a[80:83], v[48:51]
    buffer_load_dwordx4 a[164:167], v208, s[36:39], s51 offen offset:1024 sc1
    v_mfma_f32_16x16x32_bf16 v[48:51], a[208:211], a[64:67], v[48:51]
    s_waitcnt lgkmcnt(8)
    s_cmp_lg_u32 s52, 4
    s_cbranch_scc1 F_pw_18
    s_lshl_b32 s53, s2, 2
    s_add_u32 s53, s53, s40
    s_mul_i32 s54, s53, 7168
    buffer_load_dword a255, v231, s[28:31], s54 offen
    s_lshl_b32 s54, s53, 11
    s_mov_b64 exec, 0xffff
    buffer_load_dword a254, v231, s[32:35], s54 offen
    s_mov_b64 exec, -1
F_pw_18:
    v_mfma_f32_16x16x32_bf16 v[64:67], a[64:67], a[216:219], v[64:67]
    ds_read_b64_tr_b16 a[200:201], v216 offset:3072
    v_mfma_f32_16x16x32_bf16 v[64:67], a[80:83], a[220:223], v[64:67]
    ds_read_b64_tr_b16 a[202:203], v216 offset:3840
    v_mfma_f32_16x16x32_bf16 v[68:71], a[84:87], a[220:223], v[68:71]
    buffer_load_dwordx4 a[168:171], v208, s[36:39], s51 offen offset:2048 sc1
    v_mfma_f32_16x16x32_bf16 v[68:71], a[68:71], a[216:219], v[68:71]
    v_mfma_f32_16x16x32_bf16 v[72:75], a[72:75], a[216:219], v[72:75]
    ds_read_b64_tr_b16 a[204:205], v216 offset:17408
    v_mfma_f32_16x16x32_bf16 v[72:75], a[88:91], a[220:223], v[72:75]
    ds_read_b64_tr_b16 a[206:207], v216 offset:18176
    v_mfma_f32_16x16x32_bf16 v[76:79], a[92:95], a[220:223], v[76:79]
    v_mfma_f32_16x16x32_bf16 v[76:79], a[76:79], a[216:219], v[76:79]
    s_waitcnt lgkmcnt(8)
    v_mfma_f32_16x16x32_bf16 v[92:95], a[76:79], a[224:227], v[92:95]
    ds_read_b64_tr_b16 a[208:209], v215 offset:3136
    v_mfma_f32_16x16x32_bf16 v[92:95], a[92:95], a[228:231], v[92:95]
    ds_read_b64_tr_b16 a[210:211], v215 offset:3904
    v_mfma_f32_16x16x32_bf16 v[88:91], a[88:91], a[228:231], v[88:91]
    buffer_load_dwordx4 a[172:175], v208, s[36:39], s51 offen offset:3072 sc1
    v_mfma_f32_16x16x32_bf16 v[88:91], a[72:75], a[224:227], v[88:91]
    s_add_u32 s51, s51, 4096
    v_mfma_f32_16x16x32_bf16 v[84:87], a[68:71], a[224:227], v[84:87]
    ds_read_b64_tr_b16 a[212:213], v215 offset:17472
    v_mfma_f32_16x16x32_bf16 v[84:87], a[84:87], a[228:231], v[84:87]
    ds_read_b64_tr_b16 a[214:215], v215 offset:18240
    v_mfma_f32_16x16x32_bf16 v[80:83], a[80:83], a[228:231], v[80:83]
    buffer_load_dwordx4 a[176:179], v208, s[36:39], s51 offen offset:0 sc1
    v_mfma_f32_16x16x32_bf16 v[80:83], a[64:67], a[224:227], v[80:83]
    s_waitcnt lgkmcnt(8)
    v_mfma_f32_16x16x32_bf16 v[96:99], a[192:195], a[64:67], v[96:99]
    ds_read_b64_tr_b16 a[216:217], v216 offset:3136
    v_mfma_f32_16x16x32_bf16 v[96:99], a[196:199], a[80:83], v[96:99]
    ds_read_b64_tr_b16 a[218:219], v216 offset:3904
    v_mfma_f32_16x16x32_bf16 v[100:103], a[196:199], a[84:87], v[100:103]
    buffer_load_dwordx4 a[180:183], v208, s[36:39], s51 offen offset:1024 sc1
    v_mfma_f32_16x16x32_bf16 v[100:103], a[192:195], a[68:71], v[100:103]
    v_mfma_f32_16x16x32_bf16 v[104:107], a[192:195], a[72:75], v[104:107]
    ds_read_b64_tr_b16 a[220:221], v216 offset:17472
    v_mfma_f32_16x16x32_bf16 v[104:107], a[196:199], a[88:91], v[104:107]
    ds_read_b64_tr_b16 a[222:223], v216 offset:18240
    v_mfma_f32_16x16x32_bf16 v[108:111], a[196:199], a[92:95], v[108:111]
    v_mfma_f32_16x16x32_bf16 v[108:111], a[192:195], a[76:79], v[108:111]
    s_waitcnt lgkmcnt(8)
    v_mfma_f32_16x16x32_bf16 v[124:127], a[200:203], a[76:79], v[124:127]
    ds_read_b64_tr_b16 a[224:225], v215 offset:3200
    v_mfma_f32_16x16x32_bf16 v[124:127], a[204:207], a[92:95], v[124:127]
    ds_read_b64_tr_b16 a[226:227], v215 offset:3968
    v_mfma_f32_16x16x32_bf16 v[120:123], a[204:207], a[88:91], v[120:123]
    buffer_load_dwordx4 a[184:187], v208, s[36:39], s51 offen offset:2048 sc1
    v_mfma_f32_16x16x32_bf16 v[120:123], a[200:203], a[72:75], v[120:123]
    v_mfma_f32_16x16x32_bf16 v[116:119], a[200:203], a[68:71], v[116:119]
    ds_read_b64_tr_b16 a[228:229], v215 offset:17536
    v_mfma_f32_16x16x32_bf16 v[116:119], a[204:207], a[84:87], v[116:119]
    ds_read_b64_tr_b16 a[230:231], v215 offset:18304
    v_mfma_f32_16x16x32_bf16 v[112:115], a[204:207], a[80:83], v[112:115]
    buffer_load_dwordx4 a[188:191], v208, s[36:39], s51 offen offset:3072 sc1
    v_mfma_f32_16x16x32_bf16 v[112:115], a[200:203], a[64:67], v[112:115]
    s_waitcnt lgkmcnt(8)
    s_add_u32 s51, s51, s65
    v_mfma_f32_16x16x32_bf16 v[128:131], a[208:211], a[64:67], v[128:131]
    ds_read_b64_tr_b16 a[192:193], v216 offset:3200
    v_mfma_f32_16x16x32_bf16 v[128:131], a[212:215], a[80:83], v[128:131]
    ds_read_b64_tr_b16 a[194:195], v216 offset:3968
    v_mfma_f32_16x16x32_bf16 v[132:135], a[212:215], a[84:87], v[132:135]
    v_mfma_f32_16x16x32_bf16 v[132:135], a[208:211], a[68:71], v[132:135]
    v_mfma_f32_16x16x32_bf16 v[136:139], a[208:211], a[72:75], v[136:139]
    ds_read_b64_tr_b16 a[196:197], v216 offset:17536
    v_mfma_f32_16x16x32_bf16 v[136:139], a[212:215], a[88:91], v[136:139]
    ds_read_b64_tr_b16 a[198:199], v216 offset:18304
    v_mfma_f32_16x16x32_bf16 v[140:143], a[212:215], a[92:95], v[140:143]
    v_mfma_f32_16x16x32_bf16 v[140:143], a[208:211], a[76:79], v[140:143]
    s_waitcnt lgkmcnt(8)
    v_mfma_f32_16x16x32_bf16 v[156:159], a[216:219], a[76:79], v[156:159]
    ds_read_b64_tr_b16 a[200:201], v217 offset:6144
    v_mfma_f32_16x16x32_bf16 v[156:159], a[220:223], a[92:95], v[156:159]
    ds_read_b64_tr_b16 a[202:203], v217 offset:6400
    v_mfma_f32_16x16x32_bf16 v[152:155], a[220:223], a[88:91], v[152:155]
    v_mfma_f32_16x16x32_bf16 v[152:155], a[216:219], a[72:75], v[152:155]
    v_mfma_f32_16x16x32_bf16 v[148:151], a[216:219], a[68:71], v[148:151]
    ds_read_b64_tr_b16 a[204:205], v217 offset:20480
    v_mfma_f32_16x16x32_bf16 v[148:151], a[220:223], a[84:87], v[148:151]
    ds_read_b64_tr_b16 a[206:207], v217 offset:20736
    v_mfma_f32_16x16x32_bf16 v[144:147], a[220:223], a[80:83], v[144:147]
    v_mfma_f32_16x16x32_bf16 v[144:147], a[216:219], a[64:67], v[144:147]
    s_waitcnt lgkmcnt(8)
    s_waitcnt vmcnt(38)
    s_barrier
    v_mfma_f32_16x16x32_bf16 v[160:163], a[224:227], a[64:67], v[160:163]
    ds_read_b64_tr_b16 a[208:209], v212 offset:28672
    v_mfma_f32_16x16x32_bf16 v[160:163], a[228:231], a[80:83], v[160:163]
    s_add_u32 m0, s50, 86016
    ds_read_b64_tr_b16 a[210:211], v212 offset:29440
    v_mfma_f32_16x16x32_bf16 v[164:167], a[228:231], a[84:87], v[164:167]
    buffer_load_dwordx4 v209, s[20:23], s46 offen offset:0 lds
    v_mfma_f32_16x16x32_bf16 v[164:167], a[224:227], a[68:71], v[164:167]
    s_mul_i32 s55, s58, 393216
    s_cmp_lg_u32 s52, 5
    s_cbranch_scc1 F_pw_19
    s_lshl_b32 s53, s2, 2
    s_add_u32 s53, s53, s40
    s_mul_i32 s54, s53, 7168
    buffer_load_dword a255, v231, s[28:31], s54 offen
    s_lshl_b32 s54, s53, 11
    s_mov_b64 exec, 0xffff
    buffer_load_dword a254, v231, s[32:35], s54 offen
    s_mov_b64 exec, -1
F_pw_19:
    v_mfma_f32_16x16x32_bf16 v[168:171], a[224:227], a[72:75], v[168:171]
    ds_read_b64_tr_b16 a[212:213], v212 offset:43008
    v_mfma_f32_16x16x32_bf16 v[168:171], a[228:231], a[88:91], v[168:171]
    s_add_u32 m0, s50, 87040
    ds_read_b64_tr_b16 a[214:215], v212 offset:43776
    v_mfma_f32_16x16x32_bf16 v[172:175], a[228:231], a[92:95], v[172:175]
    buffer_load_dwordx4 v240, s[20:23], s46 offen offset:0 lds
    v_mfma_f32_16x16x32_bf16 v[172:175], a[224:227], a[76:79], v[172:175]
    s_waitcnt lgkmcnt(8)
    v_mfma_f32_16x16x32_bf16 v[188:191], a[192:195], a[76:79], v[188:191]
    ds_read_b64_tr_b16 a[216:217], v213 offset:28672
    v_mfma_f32_16x16x32_bf16 v[188:191], a[196:199], a[92:95], v[188:191]
    s_add_u32 m0, s50, 88064
    ds_read_b64_tr_b16 a[218:219], v213 offset:29440
    v_mfma_f32_16x16x32_bf16 v[184:187], a[196:199], a[88:91], v[184:187]
    buffer_load_dwordx4 v241, s[20:23], s46 offen offset:0 lds
    v_mfma_f32_16x16x32_bf16 v[184:187], a[192:195], a[72:75], v[184:187]
    s_add_u32 s46, s46, s55
    v_mfma_f32_16x16x32_bf16 v[180:183], a[192:195], a[68:71], v[180:183]
    ds_read_b64_tr_b16 a[220:221], v213 offset:43008
    v_mfma_f32_16x16x32_bf16 v[180:183], a[196:199], a[84:87], v[180:183]
    ds_read_b64_tr_b16 a[222:223], v213 offset:43776
    v_mfma_f32_16x16x32_bf16 v[176:179], a[196:199], a[80:83], v[176:179]
    v_mfma_f32_16x16x32_bf16 v[176:179], a[192:195], a[64:67], v[176:179]
    s_waitcnt lgkmcnt(8)
    v_mfma_f32_16x16x32_bf16 v[192:195], a[200:203], a[64:67], v[192:195]
    ds_read_b64_tr_b16 a[224:225], v212 offset:28736
    v_mfma_f32_16x16x32_bf16 v[192:195], a[204:207], a[80:83], v[192:195]
    s_add_u32 m0, s50, 89088
    ds_read_b64_tr_b16 a[226:227], v212 offset:29504
    v_mfma_f32_16x16x32_bf16 v[196:199], a[204:207], a[84:87], v[196:199]
    buffer_load_dwordx4 v210, s[24:27], s48 offen offset:0 lds
    v_mfma_f32_16x16x32_bf16 v[196:199], a[200:203], a[68:71], v[196:199]
    s_mul_i32 s55, s58, 458752
    v_mfma_f32_16x16x32_bf16 v[200:203], a[200:203], a[72:75], v[200:203]
    ds_read_b64_tr_b16 a[228:229], v212 offset:43072
    v_mfma_f32_16x16x32_bf16 v[200:203], a[204:207], a[88:91], v[200:203]
    ds_read_b64_tr_b16 a[230:231], v212 offset:43840
    v_mfma_f32_16x16x32_bf16 v[204:207], a[204:207], a[92:95], v[204:207]
    v_mfma_f32_16x16x32_bf16 v[204:207], a[200:203], a[76:79], v[204:207]
    s_waitcnt vmcnt(34) lgkmcnt(8)
    v_mfma_f32_16x16x32_bf16 v[12:15], a[208:211], a[108:111], v[12:15]
    ds_read_b64_tr_b16 a[192:193], v213 offset:28736
    v_mfma_f32_16x16x32_bf16 v[12:15], a[212:215], a[124:127], v[12:15]
    s_add_u32 m0, s50, 90112
    ds_read_b64_tr_b16 a[194:195], v213 offset:29504
    v_mfma_f32_16x16x32_bf16 v[8:11], a[212:215], a[120:123], v[8:11]
    buffer_load_dwordx4 v242, s[24:27], s48 offen offset:0 lds
    v_mfma_f32_16x16x32_bf16 v[8:11], a[208:211], a[104:107], v[8:11]
    v_mfma_f32_16x16x32_bf16 v[4:7], a[208:211], a[100:103], v[4:7]
    ds_read_b64_tr_b16 a[196:197], v213 offset:43072
    v_mfma_f32_16x16x32_bf16 v[4:7], a[212:215], a[116:119], v[4:7]
    ds_read_b64_tr_b16 a[198:199], v213 offset:43840
    v_mfma_f32_16x16x32_bf16 v[0:3], a[212:215], a[112:115], v[0:3]
    v_mfma_f32_16x16x32_bf16 v[0:3], a[208:211], a[96:99], v[0:3]
    s_waitcnt lgkmcnt(8)
    v_mfma_f32_16x16x32_bf16 v[16:19], a[216:219], a[96:99], v[16:19]
    ds_read_b64_tr_b16 a[200:201], v212 offset:28800
    v_mfma_f32_16x16x32_bf16 v[16:19], a[220:223], a[112:115], v[16:19]
    ds_read_b64_tr_b16 a[202:203], v212 offset:29568
    v_mfma_f32_16x16x32_bf16 v[20:23], a[220:223], a[116:119], v[20:23]
    v_mfma_f32_16x16x32_bf16 v[20:23], a[216:219], a[100:103], v[20:23]
    v_mfma_f32_16x16x32_bf16 v[24:27], a[216:219], a[104:107], v[24:27]
    ds_read_b64_tr_b16 a[204:205], v212 offset:43136
    v_mfma_f32_16x16x32_bf16 v[24:27], a[220:223], a[120:123], v[24:27]
    s_add_u32 m0, s50, 91136
    ds_read_b64_tr_b16 a[206:207], v212 offset:43904
    v_mfma_f32_16x16x32_bf16 v[28:31], a[220:223], a[124:127], v[28:31]
    buffer_load_dwordx4 v243, s[24:27], s48 offen offset:0 lds
    v_mfma_f32_16x16x32_bf16 v[28:31], a[216:219], a[108:111], v[28:31]
    s_waitcnt lgkmcnt(8)
    s_add_u32 s48, s48, s55
    v_mfma_f32_16x16x32_bf16 v[44:47], a[224:227], a[108:111], v[44:47]
    ds_read_b64_tr_b16 a[208:209], v213 offset:28800
    v_mfma_f32_16x16x32_bf16 v[44:47], a[228:231], a[124:127], v[44:47]
    ds_read_b64_tr_b16 a[210:211], v213 offset:29568
    v_mfma_f32_16x16x32_bf16 v[40:43], a[228:231], a[120:123], v[40:43]
    v_mfma_f32_16x16x32_bf16 v[40:43], a[224:227], a[104:107], v[40:43]
    v_mfma_f32_16x16x32_bf16 v[36:39], a[224:227], a[100:103], v[36:39]
    ds_read_b64_tr_b16 a[212:213], v213 offset:43136
    v_mfma_f32_16x16x32_bf16 v[36:39], a[228:231], a[116:119], v[36:39]
    ds_read_b64_tr_b16 a[214:215], v213 offset:43904
    v_mfma_f32_16x16x32_bf16 v[32:35], a[228:231], a[112:115], v[32:35]
    v_mfma_f32_16x16x32_bf16 v[32:35], a[224:227], a[96:99], v[32:35]
    s_waitcnt lgkmcnt(8)
    v_mfma_f32_16x16x32_bf16 v[48:51], a[192:195], a[96:99], v[48:51]
    ds_read_b64_tr_b16 a[216:217], v212 offset:31744
    v_mfma_f32_16x16x32_bf16 v[48:51], a[196:199], a[112:115], v[48:51]
    s_add_u32 m0, s50, 92160
    ds_read_b64_tr_b16 a[218:219], v212 offset:32512
    v_mfma_f32_16x16x32_bf16 v[52:55], a[196:199], a[116:119], v[52:55]
    buffer_load_dwordx4 v211, s[24:27], s49 offen offset:0 lds
    v_mfma_f32_16x16x32_bf16 v[52:55], a[192:195], a[100:103], v[52:55]
    s_add_u32 s49, s49, s55
    v_mfma_f32_16x16x32_bf16 v[56:59], a[192:195], a[104:107], v[56:59]
    ds_read_b64_tr_b16 a[220:221], v212 offset:46080
    v_mfma_f32_16x16x32_bf16 v[56:59], a[196:199], a[120:123], v[56:59]
    ds_read_b64_tr_b16 a[222:223], v212 offset:46848
    v_mfma_f32_16x16x32_bf16 v[60:63], a[196:199], a[124:127], v[60:63]
    v_mfma_f32_16x16x32_bf16 v[60:63], a[192:195], a[108:111], v[60:63]
    s_waitcnt lgkmcnt(8)
    s_cmp_lg_u32 s52, 6
    s_cbranch_scc1 F_pw_20
    s_lshl_b32 s53, s2, 2
    s_add_u32 s53, s53, s40
    s_mul_i32 s54, s53, 7168
    buffer_load_dword a255, v231, s[28:31], s54 offen
    s_lshl_b32 s54, s53, 11
    s_mov_b64 exec, 0xffff
    buffer_load_dword a254, v231, s[32:35], s54 offen
    s_mov_b64 exec, -1
F_pw_20:
    v_mfma_f32_16x16x32_bf16 v[76:79], a[108:111], a[200:203], v[76:79]
    ds_read_b64_tr_b16 a[224:225], v213 offset:31744
    v_mfma_f32_16x16x32_bf16 v[76:79], a[124:127], a[204:207], v[76:79]
    ds_read_b64_tr_b16 a[226:227], v213 offset:32512
    v_mfma_f32_16x16x32_bf16 v[72:75], a[120:123], a[204:207], v[72:75]
    buffer_load_dwordx4 a[0:3], v208, s[36:39], s51 offen offset:0 sc1
    v_mfma_f32_16x16x32_bf16 v[72:75], a[104:107], a[200:203], v[72:75]
    v_mfma_f32_16x16x32_bf16 v[68:71], a[100:103], a[200:203], v[68:71]
    ds_read_b64_tr_b16 a[228:229], v213 offset:46080
    v_mfma_f32_16x16x32_bf16 v[68:71], a[116:119], a[204:207], v[68:71]
    ds_read_b64_tr_b16 a[230:231], v213 offset:46848
    v_mfma_f32_16x16x32_bf16 v[64:67], a[112:115], a[204:207], v[64:67]
    v_mfma_f32_16x16x32_bf16 v[64:67], a[96:99], a[200:203], v[64:67]
    s_waitcnt lgkmcnt(8)
    v_mfma_f32_16x16x32_bf16 v[80:83], a[96:99], a[208:211], v[80:83]
    ds_read_b64_tr_b16 a[192:193], v212 offset:31808
    v_mfma_f32_16x16x32_bf16 v[80:83], a[112:115], a[212:215], v[80:83]
    ds_read_b64_tr_b16 a[194:195], v212 offset:32576
    v_mfma_f32_16x16x32_bf16 v[84:87], a[116:119], a[212:215], v[84:87]
    v_mfma_f32_16x16x32_bf16 v[84:87], a[100:103], a[208:211], v[84:87]
    v_mfma_f32_16x16x32_bf16 v[88:91], a[104:107], a[208:211], v[88:91]
    ds_read_b64_tr_b16 a[196:197], v212 offset:46144
    v_mfma_f32_16x16x32_bf16 v[88:91], a[120:123], a[212:215], v[88:91]
    ds_read_b64_tr_b16 a[198:199], v212 offset:46912
    v_mfma_f32_16x16x32_bf16 v[92:95], a[124:127], a[212:215], v[92:95]
    buffer_load_dwordx4 a[4:7], v208, s[36:39], s51 offen offset:1024 sc1
    v_mfma_f32_16x16x32_bf16 v[92:95], a[108:111], a[208:211], v[92:95]
    s_waitcnt lgkmcnt(8)
    v_mfma_f32_16x16x32_bf16 v[108:111], a[216:219], a[108:111], v[108:111]
    ds_read_b64_tr_b16 a[200:201], v213 offset:31808
    v_mfma_f32_16x16x32_bf16 v[108:111], a[220:223], a[124:127], v[108:111]
    ds_read_b64_tr_b16 a[202:203], v213 offset:32576
    v_mfma_f32_16x16x32_bf16 v[104:107], a[220:223], a[120:123], v[104:107]
    v_mfma_f32_16x16x32_bf16 v[104:107], a[216:219], a[104:107], v[104:107]
    v_mfma_f32_16x16x32_bf16 v[100:103], a[216:219], a[100:103], v[100:103]
    ds_read_b64_tr_b16 a[204:205], v213 offset:46144
    v_mfma_f32_16x16x32_bf16 v[100:103], a[220:223], a[116:119], v[100:103]
    ds_read_b64_tr_b16 a[206:207], v213 offset:46912
    v_mfma_f32_16x16x32_bf16 v[96:99], a[220:223], a[112:115], v[96:99]
    buffer_load_dwordx4 a[8:11], v208, s[36:39], s51 offen offset:2048 sc1
    v_mfma_f32_16x16x32_bf16 v[96:99], a[216:219], a[96:99], v[96:99]
    s_waitcnt lgkmcnt(8)
    v_mfma_f32_16x16x32_bf16 v[112:115], a[224:227], a[96:99], v[112:115]
    ds_read_b64_tr_b16 a[208:209], v212 offset:31872
    v_mfma_f32_16x16x32_bf16 v[112:115], a[228:231], a[112:115], v[112:115]
    ds_read_b64_tr_b16 a[210:211], v212 offset:32640
    v_mfma_f32_16x16x32_bf16 v[116:119], a[228:231], a[116:119], v[116:119]
    v_mfma_f32_16x16x32_bf16 v[116:119], a[224:227], a[100:103], v[116:119]
    v_mfma_f32_16x16x32_bf16 v[120:123], a[224:227], a[104:107], v[120:123]
    ds_read_b64_tr_b16 a[212:213], v212 offset:46208
    v_mfma_f32_16x16x32_bf16 v[120:123], a[228:231], a[120:123], v[120:123]
    ds_read_b64_tr_b16 a[214:215], v212 offset:46976
    v_mfma_f32_16x16x32_bf16 v[124:127], a[228:231], a[124:127], v[124:127]
    v_mfma_f32_16x16x32_bf16 v[124:127], a[224:227], a[108:111], v[124:127]
    s_waitcnt lgkmcnt(8)
    v_mfma_f32_16x16x32_bf16 v[140:143], a[192:195], a[108:111], v[140:143]
    ds_read_b64_tr_b16 a[216:217], v213 offset:31872
    v_mfma_f32_16x16x32_bf16 v[140:143], a[196:199], a[124:127], v[140:143]
    ds_read_b64_tr_b16 a[218:219], v213 offset:32640
    v_mfma_f32_16x16x32_bf16 v[136:139], a[196:199], a[120:123], v[136:139]
    buffer_load_dwordx4 a[12:15], v208, s[36:39], s51 offen offset:3072 sc1
    v_mfma_f32_16x16x32_bf16 v[136:139], a[192:195], a[104:107], v[136:139]
    s_add_u32 s51, s51, 4096
    v_mfma_f32_16x16x32_bf16 v[132:135], a[192:195], a[100:103], v[132:135]
    ds_read_b64_tr_b16 a[220:221], v213 offset:46208
    v_mfma_f32_16x16x32_bf16 v[132:135], a[196:199], a[116:119], v[132:135]
    ds_read_b64_tr_b16 a[222:223], v213 offset:46976
    v_mfma_f32_16x16x32_bf16 v[128:131], a[196:199], a[112:115], v[128:131]
    v_mfma_f32_16x16x32_bf16 v[128:131], a[192:195], a[96:99], v[128:131]
    s_waitcnt lgkmcnt(8)
    v_mfma_f32_16x16x32_bf16 v[144:147], a[200:203], a[96:99], v[144:147]
    ds_read_b64_tr_b16 a[224:225], v214 offset:34816
    v_mfma_f32_16x16x32_bf16 v[144:147], a[204:207], a[112:115], v[144:147]
    ds_read_b64_tr_b16 a[226:227], v214 offset:35072
    v_mfma_f32_16x16x32_bf16 v[148:151], a[204:207], a[116:119], v[148:151]
    buffer_load_dwordx4 a[16:19], v208, s[36:39], s51 offen offset:0 sc1
    v_mfma_f32_16x16x32_bf16 v[148:151], a[200:203], a[100:103], v[148:151]
    v_mfma_f32_16x16x32_bf16 v[152:155], a[200:203], a[104:107], v[152:155]
    ds_read_b64_tr_b16 a[228:229], v214 offset:49152
    v_mfma_f32_16x16x32_bf16 v[152:155], a[204:207], a[120:123], v[152:155]
    ds_read_b64_tr_b16 a[230:231], v214 offset:49408
    v_mfma_f32_16x16x32_bf16 v[156:159], a[204:207], a[124:127], v[156:159]
    v_mfma_f32_16x16x32_bf16 v[156:159], a[200:203], a[108:111], v[156:159]
    s_waitcnt lgkmcnt(8)
    s_waitcnt vmcnt(35)
    s_barrier
    v_mfma_f32_16x16x32_bf16 v[172:175], a[208:211], a[108:111], v[172:175]
    ds_read_b64_tr_b16 a[192:193], v212 offset:0
    v_mfma_f32_16x16x32_bf16 v[172:175], a[212:215], a[124:127], v[172:175]
    ds_read_b64_tr_b16 a[194:195], v212 offset:768
    v_mfma_f32_16x16x32_bf16 v[168:171], a[212:215], a[120:123], v[168:171]
    v_mfma_f32_16x16x32_bf16 v[168:171], a[208:211], a[104:107], v[168:171]
    s_cmp_lg_u32 s52, 7
    s_cbranch_scc1 F_pw_21
    s_lshl_b32 s53, s2, 2
    s_add_u32 s53, s53, s40
    s_mul_i32 s54, s53, 7168
    buffer_load_dword a255, v231, s[28:31], s54 offen
    s_lshl_b32 s54, s53, 11
    s_mov_b64 exec, 0xffff
    buffer_load_dword a254, v231, s[32:35], s54 offen
    s_mov_b64 exec, -1
F_pw_21:
    v_mfma_f32_16x16x32_bf16 v[164:167], a[208:211], a[100:103], v[164:167]
    ds_read_b64_tr_b16 a[196:197], v212 offset:14336
    v_mfma_f32_16x16x32_bf16 v[164:167], a[212:215], a[116:119], v[164:167]
    ds_read_b64_tr_b16 a[198:199], v212 offset:15104
    v_mfma_f32_16x16x32_bf16 v[160:163], a[212:215], a[112:115], v[160:163]
    buffer_load_dwordx4 a[20:23], v208, s[36:39], s51 offen offset:1024 sc1
    v_mfma_f32_16x16x32_bf16 v[160:163], a[208:211], a[96:99], v[160:163]
    s_waitcnt lgkmcnt(8)
    v_mfma_f32_16x16x32_bf16 v[176:179], a[216:219], a[96:99], v[176:179]
    ds_read_b64_tr_b16 a[200:201], v213 offset:0
    v_mfma_f32_16x16x32_bf16 v[176:179], a[220:223], a[112:115], v[176:179]
    ds_read_b64_tr_b16 a[202:203], v213 offset:768
    v_mfma_f32_16x16x32_bf16 v[180:183], a[220:223], a[116:119], v[180:183]
    v_mfma_f32_16x16x32_bf16 v[180:183], a[216:219], a[100:103], v[180:183]
    v_mfma_f32_16x16x32_bf16 v[184:187], a[216:219], a[104:107], v[184:187]
    ds_read_b64_tr_b16 a[204:205], v213 offset:14336
    v_mfma_f32_16x16x32_bf16 v[184:187], a[220:223], a[120:123], v[184:187]
    ds_read_b64_tr_b16 a[206:207], v213 offset:15104
    v_mfma_f32_16x16x32_bf16 v[188:191], a[220:223], a[124:127], v[188:191]
    v_mfma_f32_16x16x32_bf16 v[188:191], a[216:219], a[108:111], v[188:191]
    s_waitcnt lgkmcnt(8)
    v_mfma_f32_16x16x32_bf16 v[204:207], a[224:227], a[108:111], v[204:207]
    ds_read_b64_tr_b16 a[208:209], v212 offset:64
    v_mfma_f32_16x16x32_bf16 v[204:207], a[228:231], a[124:127], v[204:207]
    ds_read_b64_tr_b16 a[210:211], v212 offset:832
    v_mfma_f32_16x16x32_bf16 v[200:203], a[228:231], a[120:123], v[200:203]
    buffer_load_dwordx4 a[24:27], v208, s[36:39], s51 offen offset:2048 sc1
    v_mfma_f32_16x16x32_bf16 v[200:203], a[224:227], a[104:107], v[200:203]
    v_mfma_f32_16x16x32_bf16 v[196:199], a[224:227], a[100:103], v[196:199]
    ds_read_b64_tr_b16 a[212:213], v212 offset:14400
    v_mfma_f32_16x16x32_bf16 v[196:199], a[228:231], a[116:119], v[196:199]
    ds_read_b64_tr_b16 a[214:215], v212 offset:15168
    v_mfma_f32_16x16x32_bf16 v[192:195], a[228:231], a[112:115], v[192:195]
    v_mfma_f32_16x16x32_bf16 v[192:195], a[224:227], a[96:99], v[192:195]
    s_waitcnt vmcnt(29) lgkmcnt(8)
    v_mfma_f32_16x16x32_bf16 v[0:3], a[192:195], a[128:131], v[0:3]
    ds_read_b64_tr_b16 a[216:217], v213 offset:64
    v_mfma_f32_16x16x32_bf16 v[0:3], a[196:199], a[144:147], v[0:3]
    ds_read_b64_tr_b16 a[218:219], v213 offset:832
    v_mfma_f32_16x16x32_bf16 v[4:7], a[196:199], a[148:151], v[4:7]
    buffer_load_dwordx4 a[28:31], v208, s[36:39], s51 offen offset:3072 sc1
    v_mfma_f32_16x16x32_bf16 v[4:7], a[192:195], a[132:135], v[4:7]
    s_add_u32 s51, s51, s62
    v_mfma_f32_16x16x32_bf16 v[8:11], a[192:195], a[136:139], v[8:11]
    ds_read_b64_tr_b16 a[220:221], v213 offset:14400
    v_mfma_f32_16x16x32_bf16 v[8:11], a[196:199], a[152:155], v[8:11]
    ds_read_b64_tr_b16 a[222:223], v213 offset:15168
    v_mfma_f32_16x16x32_bf16 v[12:15], a[196:199], a[156:159], v[12:15]
    v_mfma_f32_16x16x32_bf16 v[12:15], a[192:195], a[140:143], v[12:15]
    s_waitcnt lgkmcnt(8)
    s_barrier
    v_mfma_f32_16x16x32_bf16 v[28:31], a[200:203], a[140:143], v[28:31]
    ds_read_b64_tr_b16 a[224:225], v212 offset:128
    v_mfma_f32_16x16x32_bf16 v[28:31], a[204:207], a[156:159], v[28:31]
    ds_read_b64_tr_b16 a[226:227], v212 offset:896
    v_mfma_f32_16x16x32_bf16 v[24:27], a[204:207], a[152:155], v[24:27]
    v_mfma_f32_16x16x32_bf16 v[24:27], a[200:203], a[136:139], v[24:27]
    v_and_b32 v221, 7, v224
    v_lshlrev_b32 v221, 5, v221
    global_load_dword v227, v221, s[100:101] sc1
    v_mfma_f32_16x16x32_bf16 v[20:23], a[200:203], a[132:135], v[20:23]
    ds_read_b64_tr_b16 a[228:229], v212 offset:14464
    v_mfma_f32_16x16x32_bf16 v[20:23], a[204:207], a[148:151], v[20:23]
    s_add_u32 m0, s50, 57344
    ds_read_b64_tr_b16 a[230:231], v212 offset:15232
    v_mfma_f32_16x16x32_bf16 v[16:19], a[204:207], a[144:147], v[16:19]
    buffer_load_dwordx4 v209, s[20:23], s46 offen offset:0 lds
    v_mfma_f32_16x16x32_bf16 v[16:19], a[200:203], a[128:131], v[16:19]
    s_waitcnt lgkmcnt(8)
    s_mul_i32 s55, s59, 393216
    v_mfma_f32_16x16x32_bf16 v[32:35], a[208:211], a[128:131], v[32:35]
    ds_read_b64_tr_b16 a[192:193], v213 offset:128
    v_mfma_f32_16x16x32_bf16 v[32:35], a[212:215], a[144:147], v[32:35]
    s_add_u32 m0, s50, 58368
    ds_read_b64_tr_b16 a[194:195], v213 offset:896
    v_mfma_f32_16x16x32_bf16 v[36:39], a[212:215], a[148:151], v[36:39]
    buffer_load_dwordx4 v240, s[20:23], s46 offen offset:0 lds
    v_mfma_f32_16x16x32_bf16 v[36:39], a[208:211], a[132:135], v[36:39]
    v_mfma_f32_16x16x32_bf16 v[40:43], a[208:211], a[136:139], v[40:43]
    ds_read_b64_tr_b16 a[196:197], v213 offset:14464
    v_mfma_f32_16x16x32_bf16 v[40:43], a[212:215], a[152:155], v[40:43]
    s_add_u32 m0, s50, 59392
    ds_read_b64_tr_b16 a[198:199], v213 offset:15232
    v_mfma_f32_16x16x32_bf16 v[44:47], a[212:215], a[156:159], v[44:47]
    buffer_load_dwordx4 v241, s[20:23], s46 offen offset:0 lds
    v_mfma_f32_16x16x32_bf16 v[44:47], a[208:211], a[140:143], v[44:47]
    s_waitcnt lgkmcnt(8)
    s_add_u32 s46, s46, s55
    v_mfma_f32_16x16x32_bf16 v[60:63], a[216:219], a[140:143], v[60:63]
    ds_read_b64_tr_b16 a[200:201], v212 offset:3072
    v_mfma_f32_16x16x32_bf16 v[60:63], a[220:223], a[156:159], v[60:63]
    ds_read_b64_tr_b16 a[202:203], v212 offset:3840
    v_mfma_f32_16x16x32_bf16 v[56:59], a[220:223], a[152:155], v[56:59]
    v_mfma_f32_16x16x32_bf16 v[56:59], a[216:219], a[136:139], v[56:59]
    v_mfma_f32_16x16x32_bf16 v[52:55], a[216:219], a[132:135], v[52:55]
    ds_read_b64_tr_b16 a[204:205], v212 offset:17408
    v_mfma_f32_16x16x32_bf16 v[52:55], a[220:223], a[148:151], v[52:55]
    s_add_u32 m0, s50, 60416
    ds_read_b64_tr_b16 a[206:207], v212 offset:18176
    v_mfma_f32_16x16x32_bf16 v[48:51], a[220:223], a[144:147], v[48:51]
    buffer_load_dwordx4 v210, s[24:27], s48 offen offset:0 lds
    v_mfma_f32_16x16x32_bf16 v[48:51], a[216:219], a[128:131], v[48:51]
    s_waitcnt lgkmcnt(8)
    s_mul_i32 s55, s59, 458752
    v_mfma_f32_16x16x32_bf16 v[64:67], a[128:131], a[224:227], v[64:67]
    ds_read_b64_tr_b16 a[208:209], v213 offset:3072
    v_mfma_f32_16x16x32_bf16 v[64:67], a[144:147], a[228:231], v[64:67]
    s_add_u32 m0, s50, 61440
    ds_read_b64_tr_b16 a[210:211], v213 offset:3840
    v_mfma_f32_16x16x32_bf16 v[68:71], a[148:151], a[228:231], v[68:71]
    buffer_load_dwordx4 v242, s[24:27], s48 offen offset:0 lds
    v_mfma_f32_16x16x32_bf16 v[68:71], a[132:135], a[224:227], v[68:71]
    v_mfma_f32_16x16x32_bf16 v[72:75], a[136:139], a[224:227], v[72:75]
    ds_read_b64_tr_b16 a[212:213], v213 offset:17408
    v_mfma_f32_16x16x32_bf16 v[72:75], a[152:155], a[228:231], v[72:75]
    s_add_u32 m0, s50, 62464
    ds_read_b64_tr_b16 a[214:215], v213 offset:18176
    v_mfma_f32_16x16x32_bf16 v[76:79], a[156:159], a[228:231], v[76:79]
    buffer_load_dwordx4 v243, s[24:27], s48 offen offset:0 lds
    v_mfma_f32_16x16x32_bf16 v[76:79], a[140:143], a[224:227], v[76:79]
    s_waitcnt lgkmcnt(8)
    s_add_u32 s48, s48, s55
    v_mfma_f32_16x16x32_bf16 v[92:95], a[140:143], a[192:195], v[92:95]
    ds_read_b64_tr_b16 a[216:217], v212 offset:3136
    v_mfma_f32_16x16x32_bf16 v[92:95], a[156:159], a[196:199], v[92:95]
    s_add_u32 m0, s50, 63488
    ds_read_b64_tr_b16 a[218:219], v212 offset:3904
    v_mfma_f32_16x16x32_bf16 v[88:91], a[152:155], a[196:199], v[88:91]
    buffer_load_dwordx4 v211, s[24:27], s49 offen offset:0 lds
    v_mfma_f32_16x16x32_bf16 v[88:91], a[136:139], a[192:195], v[88:91]
    s_add_u32 s49, s49, s55
    v_mfma_f32_16x16x32_bf16 v[84:87], a[132:135], a[192:195], v[84:87]
    ds_read_b64_tr_b16 a[220:221], v212 offset:17472
    v_mfma_f32_16x16x32_bf16 v[84:87], a[148:151], a[196:199], v[84:87]
    ds_read_b64_tr_b16 a[222:223], v212 offset:18240
    v_mfma_f32_16x16x32_bf16 v[80:83], a[144:147], a[196:199], v[80:83]
    v_mfma_f32_16x16x32_bf16 v[80:83], a[128:131], a[192:195], v[80:83]
    s_waitcnt lgkmcnt(8)
    v_mfma_f32_16x16x32_bf16 v[96:99], a[200:203], a[128:131], v[96:99]
    ds_read_b64_tr_b16 a[224:225], v213 offset:3136
    v_mfma_f32_16x16x32_bf16 v[96:99], a[204:207], a[144:147], v[96:99]
    ds_read_b64_tr_b16 a[226:227], v213 offset:3904
    v_mfma_f32_16x16x32_bf16 v[100:103], a[204:207], a[148:151], v[100:103]
    buffer_load_dwordx4 a[32:35], v208, s[36:39], s51 offen offset:0 sc1
    v_mfma_f32_16x16x32_bf16 v[100:103], a[200:203], a[132:135], v[100:103]
    v_mfma_f32_16x16x32_bf16 v[104:107], a[200:203], a[136:139], v[104:107]
    ds_read_b64_tr_b16 a[228:229], v213 offset:17472
    v_mfma_f32_16x16x32_bf16 v[104:107], a[204:207], a[152:155], v[104:107]
    ds_read_b64_tr_b16 a[230:231], v213 offset:18240
    v_mfma_f32_16x16x32_bf16 v[108:111], a[204:207], a[156:159], v[108:111]
    buffer_load_dwordx4 a[36:39], v208, s[36:39], s51 offen offset:1024 sc1
    v_mfma_f32_16x16x32_bf16 v[108:111], a[200:203], a[140:143], v[108:111]
    s_waitcnt lgkmcnt(8)
    v_mfma_f32_16x16x32_bf16 v[124:127], a[208:211], a[140:143], v[124:127]
    ds_read_b64_tr_b16 a[192:193], v212 offset:3200
    v_mfma_f32_16x16x32_bf16 v[124:127], a[212:215], a[156:159], v[124:127]
    ds_read_b64_tr_b16 a[194:195], v212 offset:3968
    v_mfma_f32_16x16x32_bf16 v[120:123], a[212:215], a[152:155], v[120:123]
    buffer_load_dwordx4 a[40:43], v208, s[36:39], s51 offen offset:2048 sc1
    v_mfma_f32_16x16x32_bf16 v[120:123], a[208:211], a[136:139], v[120:123]
    v_mfma_f32_16x16x32_bf16 v[116:119], a[208:211], a[132:135], v[116:119]
    ds_read_b64_tr_b16 a[196:197], v212 offset:17536
    v_mfma_f32_16x16x32_bf16 v[116:119], a[212:215], a[148:151], v[116:119]
    ds_read_b64_tr_b16 a[198:199], v212 offset:18304
    v_mfma_f32_16x16x32_bf16 v[112:115], a[212:215], a[144:147], v[112:115]
    v_mfma_f32_16x16x32_bf16 v[112:115], a[208:211], a[128:131], v[112:115]
    s_waitcnt lgkmcnt(8)
    v_mfma_f32_16x16x32_bf16 v[128:131], a[216:219], a[128:131], v[128:131]
    ds_read_b64_tr_b16 a[200:201], v213 offset:3200
    v_mfma_f32_16x16x32_bf16 v[128:131], a[220:223], a[144:147], v[128:131]
    ds_read_b64_tr_b16 a[202:203], v213 offset:3968
    v_mfma_f32_16x16x32_bf16 v[132:135], a[220:223], a[148:151], v[132:135]
    buffer_load_dwordx4 a[44:47], v208, s[36:39], s51 offen offset:3072 sc1
    v_mfma_f32_16x16x32_bf16 v[132:135], a[216:219], a[132:135], v[132:135]
    s_add_u32 s51, s51, 4096
    v_mfma_f32_16x16x32_bf16 v[136:139], a[216:219], a[136:139], v[136:139]
    ds_read_b64_tr_b16 a[204:205], v213 offset:17536
    v_mfma_f32_16x16x32_bf16 v[136:139], a[220:223], a[152:155], v[136:139]
    ds_read_b64_tr_b16 a[206:207], v213 offset:18304
    v_mfma_f32_16x16x32_bf16 v[140:143], a[220:223], a[156:159], v[140:143]
    buffer_load_dwordx4 a[48:51], v208, s[36:39], s51 offen offset:0 sc1
    v_mfma_f32_16x16x32_bf16 v[140:143], a[216:219], a[140:143], v[140:143]
    s_waitcnt lgkmcnt(8)
    v_mfma_f32_16x16x32_bf16 v[156:159], a[224:227], a[140:143], v[156:159]
    ds_read_b64_tr_b16 a[208:209], v214 offset:6144
    v_mfma_f32_16x16x32_bf16 v[156:159], a[228:231], a[156:159], v[156:159]
    ds_read_b64_tr_b16 a[210:211], v214 offset:6400
    v_mfma_f32_16x16x32_bf16 v[152:155], a[228:231], a[152:155], v[152:155]
    buffer_load_dwordx4 a[52:55], v208, s[36:39], s51 offen offset:1024 sc1
    v_mfma_f32_16x16x32_bf16 v[152:155], a[224:227], a[136:139], v[152:155]
    v_mfma_f32_16x16x32_bf16 v[148:151], a[224:227], a[132:135], v[148:151]
    ds_read_b64_tr_b16 a[212:213], v214 offset:20480
    v_mfma_f32_16x16x32_bf16 v[148:151], a[228:231], a[148:151], v[148:151]
    ds_read_b64_tr_b16 a[214:215], v214 offset:20736
    v_mfma_f32_16x16x32_bf16 v[144:147], a[228:231], a[144:147], v[144:147]
    buffer_load_dwordx4 a[56:59], v208, s[36:39], s51 offen offset:2048 sc1
    v_mfma_f32_16x16x32_bf16 v[144:147], a[224:227], a[128:131], v[144:147]
    s_waitcnt lgkmcnt(8)
    s_waitcnt vmcnt(38)
    s_barrier
    v_mfma_f32_16x16x32_bf16 v[160:163], a[192:195], a[128:131], v[160:163]
    ds_read_b64_tr_b16 a[216:217], v218 offset:0
    v_mfma_f32_16x16x32_bf16 v[160:163], a[196:199], a[144:147], v[160:163]
    ds_read_b64_tr_b16 a[218:219], v218 offset:768
    v_mfma_f32_16x16x32_bf16 v[164:167], a[196:199], a[148:151], v[164:167]
    v_mfma_f32_16x16x32_bf16 v[164:167], a[192:195], a[132:135], v[164:167]
    v_mfma_f32_16x16x32_bf16 v[168:171], a[192:195], a[136:139], v[168:171]
    ds_read_b64_tr_b16 a[220:221], v218 offset:14336
    v_mfma_f32_16x16x32_bf16 v[168:171], a[196:199], a[152:155], v[168:171]
    ds_read_b64_tr_b16 a[222:223], v218 offset:15104
    v_mfma_f32_16x16x32_bf16 v[172:175], a[196:199], a[156:159], v[172:175]
    buffer_load_dwordx4 a[60:63], v208, s[36:39], s51 offen offset:3072 sc1
    v_mfma_f32_16x16x32_bf16 v[172:175], a[192:195], a[140:143], v[172:175]
    s_waitcnt lgkmcnt(8)
    s_add_u32 s51, s51, s63
    v_mfma_f32_16x16x32_bf16 v[188:191], a[200:203], a[140:143], v[188:191]
    ds_read_b64_tr_b16 a[224:225], v219 offset:0
    v_mfma_f32_16x16x32_bf16 v[188:191], a[204:207], a[156:159], v[188:191]
    s_add_u32 m0, s50, 28672
    ds_read_b64_tr_b16 a[226:227], v219 offset:768
    v_mfma_f32_16x16x32_bf16 v[184:187], a[204:207], a[152:155], v[184:187]
    buffer_load_dwordx4 v209, s[20:23], s46 offen offset:0 lds
    v_mfma_f32_16x16x32_bf16 v[184:187], a[200:203], a[136:139], v[184:187]
    s_mul_i32 s55, s60, 393216
    v_mfma_f32_16x16x32_bf16 v[180:183], a[200:203], a[132:135], v[180:183]
    ds_read_b64_tr_b16 a[228:229], v219 offset:14336
    v_mfma_f32_16x16x32_bf16 v[180:183], a[204:207], a[148:151], v[180:183]
    s_add_u32 m0, s50, 29696
    ds_read_b64_tr_b16 a[230:231], v219 offset:15104
    v_mfma_f32_16x16x32_bf16 v[176:179], a[204:207], a[144:147], v[176:179]
    buffer_load_dwordx4 v240, s[20:23], s46 offen offset:0 lds
    v_mfma_f32_16x16x32_bf16 v[176:179], a[200:203], a[128:131], v[176:179]
    s_waitcnt lgkmcnt(8)
    v_mfma_f32_16x16x32_bf16 v[192:195], a[208:211], a[128:131], v[192:195]
    ds_read_b64_tr_b16 a[192:193], v218 offset:64
    v_mfma_f32_16x16x32_bf16 v[192:195], a[212:215], a[144:147], v[192:195]
    ds_read_b64_tr_b16 a[194:195], v218 offset:832
    v_mfma_f32_16x16x32_bf16 v[196:199], a[212:215], a[148:151], v[196:199]
    v_mfma_f32_16x16x32_bf16 v[196:199], a[208:211], a[132:135], v[196:199]
    v_mfma_f32_16x16x32_bf16 v[200:203], a[208:211], a[136:139], v[200:203]
    ds_read_b64_tr_b16 a[196:197], v218 offset:14400
    v_mfma_f32_16x16x32_bf16 v[200:203], a[212:215], a[152:155], v[200:203]
    s_add_u32 m0, s50, 30720
    ds_read_b64_tr_b16 a[198:199], v218 offset:15168
    v_mfma_f32_16x16x32_bf16 v[204:207], a[212:215], a[156:159], v[204:207]
    buffer_load_dwordx4 v241, s[20:23], s46 offen offset:0 lds
    v_mfma_f32_16x16x32_bf16 v[204:207], a[208:211], a[140:143], v[204:207]
    s_waitcnt vmcnt(34) lgkmcnt(8)
    s_add_u32 s46, s46, s55
    v_mfma_f32_16x16x32_bf16 v[12:15], a[216:219], a[172:175], v[12:15]
    ds_read_b64_tr_b16 a[200:201], v219 offset:64
    v_mfma_f32_16x16x32_bf16 v[12:15], a[220:223], a[188:191], v[12:15]
    s_add_u32 m0, s50, 31744
    ds_read_b64_tr_b16 a[202:203], v219 offset:832
    v_mfma_f32_16x16x32_bf16 v[8:11], a[220:223], a[184:187], v[8:11]
    buffer_load_dwordx4 v210, s[24:27], s48 offen offset:0 lds
    v_mfma_f32_16x16x32_bf16 v[8:11], a[216:219], a[168:171], v[8:11]
    s_mul_i32 s55, s60, 458752
    v_mfma_f32_16x16x32_bf16 v[4:7], a[216:219], a[164:167], v[4:7]
    ds_read_b64_tr_b16 a[204:205], v219 offset:14400
    v_mfma_f32_16x16x32_bf16 v[4:7], a[220:223], a[180:183], v[4:7]
    s_add_u32 m0, s50, 32768
    ds_read_b64_tr_b16 a[206:207], v219 offset:15168
    v_mfma_f32_16x16x32_bf16 v[0:3], a[220:223], a[176:179], v[0:3]
    buffer_load_dwordx4 v242, s[24:27], s48 offen offset:0 lds
    v_mfma_f32_16x16x32_bf16 v[0:3], a[216:219], a[160:163], v[0:3]
    s_waitcnt lgkmcnt(8)
    s_barrier
    v_mfma_f32_16x16x32_bf16 v[16:19], a[224:227], a[160:163], v[16:19]
    ds_read_b64_tr_b16 a[208:209], v218 offset:128
    v_mfma_f32_16x16x32_bf16 v[16:19], a[228:231], a[176:179], v[16:19]
    s_add_u32 m0, s50, 33792
    ds_read_b64_tr_b16 a[210:211], v218 offset:896
    v_mfma_f32_16x16x32_bf16 v[20:23], a[228:231], a[180:183], v[20:23]
    buffer_load_dwordx4 v243, s[24:27], s48 offen offset:0 lds
    v_mfma_f32_16x16x32_bf16 v[20:23], a[224:227], a[164:167], v[20:23]
    s_add_u32 s48, s48, s55
    s_waitcnt vmcnt(21)
    s_mov_b32 s83, 0x40000
F_cn_22:
    v_cmp_le_u32 vcc, 32, v227
    s_cmp_eq_u32 vcc_lo, -1
    s_cbranch_scc1 F_ok_23
    global_load_dword v227, v221, s[100:101] sc1
    s_sub_u32 s83, s83, 1
    s_waitcnt vmcnt(0)
    s_cbranch_scc0 F_cn_22
F_ok_23:
    v_mfma_f32_16x16x32_bf16 v[24:27], a[224:227], a[168:171], v[24:27]
    ds_read_b64_tr_b16 a[212:213], v218 offset:14464
    v_mfma_f32_16x16x32_bf16 v[24:27], a[228:231], a[184:187], v[24:27]
    ds_read_b64_tr_b16 a[214:215], v218 offset:15232
    v_mfma_f32_16x16x32_bf16 v[28:31], a[228:231], a[188:191], v[28:31]
    v_mfma_f32_16x16x32_bf16 v[28:31], a[224:227], a[172:175], v[28:31]
    s_waitcnt lgkmcnt(8)
    v_mfma_f32_16x16x32_bf16 v[44:47], a[192:195], a[172:175], v[44:47]
    ds_read_b64_tr_b16 a[216:217], v219 offset:128
    v_mfma_f32_16x16x32_bf16 v[44:47], a[196:199], a[188:191], v[44:47]
    s_add_u32 m0, s50, 34816
    ds_read_b64_tr_b16 a[218:219], v219 offset:896
    v_mfma_f32_16x16x32_bf16 v[40:43], a[196:199], a[184:187], v[40:43]
    buffer_load_dwordx4 v211, s[24:27], s49 offen offset:0 lds
    v_mfma_f32_16x16x32_bf16 v[40:43], a[192:195], a[168:171], v[40:43]
    s_add_u32 s49, s49, s55
    v_mfma_f32_16x16x32_bf16 v[36:39], a[192:195], a[164:167], v[36:39]
    ds_read_b64_tr_b16 a[220:221], v219 offset:14464
    v_mfma_f32_16x16x32_bf16 v[36:39], a[196:199], a[180:183], v[36:39]
    ds_read_b64_tr_b16 a[222:223], v219 offset:15232
    v_mfma_f32_16x16x32_bf16 v[32:35], a[196:199], a[176:179], v[32:35]
    buffer_load_dwordx4 a[64:67], v208, s[36:39], s51 offen offset:0 sc1
    v_mfma_f32_16x16x32_bf16 v[32:35], a[192:195], a[160:163], v[32:35]
    s_waitcnt lgkmcnt(8)
    v_mfma_f32_16x16x32_bf16 v[48:51], a[200:203], a[160:163], v[48:51]
    ds_read_b64_tr_b16 a[224:225], v218 offset:3072
    v_mfma_f32_16x16x32_bf16 v[48:51], a[204:207], a[176:179], v[48:51]
    ds_read_b64_tr_b16 a[226:227], v218 offset:3840
    v_mfma_f32_16x16x32_bf16 v[52:55], a[204:207], a[180:183], v[52:55]
    buffer_load_dwordx4 a[68:71], v208, s[36:39], s51 offen offset:1024 sc1
    v_mfma_f32_16x16x32_bf16 v[52:55], a[200:203], a[164:167], v[52:55]
    v_mfma_f32_16x16x32_bf16 v[56:59], a[200:203], a[168:171], v[56:59]
    ds_read_b64_tr_b16 a[228:229], v218 offset:17408
    v_mfma_f32_16x16x32_bf16 v[56:59], a[204:207], a[184:187], v[56:59]
    ds_read_b64_tr_b16 a[230:231], v218 offset:18176
    v_mfma_f32_16x16x32_bf16 v[60:63], a[204:207], a[188:191], v[60:63]
    v_mfma_f32_16x16x32_bf16 v[60:63], a[200:203], a[172:175], v[60:63]
    s_waitcnt lgkmcnt(8)
    v_mfma_f32_16x16x32_bf16 v[76:79], a[172:175], a[208:211], v[76:79]
    ds_read_b64_tr_b16 a[192:193], v219 offset:3072
    v_mfma_f32_16x16x32_bf16 v[76:79], a[188:191], a[212:215], v[76:79]
    ds_read_b64_tr_b16 a[194:195], v219 offset:3840
    v_mfma_f32_16x16x32_bf16 v[72:75], a[184:187], a[212:215], v[72:75]
    buffer_load_dwordx4 a[72:75], v208, s[36:39], s51 offen offset:2048 sc1
    v_mfma_f32_16x16x32_bf16 v[72:75], a[168:171], a[208:211], v[72:75]
    v_mfma_f32_16x16x32_bf16 v[68:71], a[164:167], a[208:211], v[68:71]
    ds_read_b64_tr_b16 a[196:197], v219 offset:17408
    v_mfma_f32_16x16x32_bf16 v[68:71], a[180:183], a[212:215], v[68:71]
    ds_read_b64_tr_b16 a[198:199], v219 offset:18176
    v_mfma_f32_16x16x32_bf16 v[64:67], a[176:179], a[212:215], v[64:67]
    buffer_load_dwordx4 a[76:79], v208, s[36:39], s51 offen offset:3072 sc1
    v_mfma_f32_16x16x32_bf16 v[64:67], a[160:163], a[208:211], v[64:67]
    s_waitcnt lgkmcnt(8)
    s_add_u32 s51, s51, 4096
    v_mfma_f32_16x16x32_bf16 v[80:83], a[160:163], a[216:219], v[80:83]
    ds_read_b64_tr_b16 a[200:201], v218 offset:3136
    v_mfma_f32_16x16x32_bf16 v[80:83], a[176:179], a[220:223], v[80:83]
    ds_read_b64_tr_b16 a[202:203], v218 offset:3904
    v_mfma_f32_16x16x32_bf16 v[84:87], a[180:183], a[220:223], v[84:87]
    buffer_load_dwordx4 a[80:83], v208, s[36:39], s51 offen offset:0 sc1
    v_mfma_f32_16x16x32_bf16 v[84:87], a[164:167], a[216:219], v[84:87]
    v_mfma_f32_16x16x32_bf16 v[88:91], a[168:171], a[216:219], v[88:91]
    ds_read_b64_tr_b16 a[204:205], v218 offset:17472
    v_mfma_f32_16x16x32_bf16 v[88:91], a[184:187], a[220:223], v[88:91]
    ds_read_b64_tr_b16 a[206:207], v218 offset:18240
    v_mfma_f32_16x16x32_bf16 v[92:95], a[188:191], a[220:223], v[92:95]
    buffer_load_dwordx4 a[84:87], v208, s[36:39], s51 offen offset:1024 sc1
    v_mfma_f32_16x16x32_bf16 v[92:95], a[172:175], a[216:219], v[92:95]
    s_waitcnt lgkmcnt(8)
    v_mfma_f32_16x16x32_bf16 v[108:111], a[224:227], a[172:175], v[108:111]
    ds_read_b64_tr_b16 a[208:209], v219 offset:3136
    v_mfma_f32_16x16x32_bf16 v[108:111], a[228:231], a[188:191], v[108:111]
    ds_read_b64_tr_b16 a[210:211], v219 offset:3904
    v_mfma_f32_16x16x32_bf16 v[104:107], a[228:231], a[184:187], v[104:107]
    v_mfma_f32_16x16x32_bf16 v[104:107], a[224:227], a[168:171], v[104:107]
    v_mfma_f32_16x16x32_bf16 v[100:103], a[224:227], a[164:167], v[100:103]
    ds_read_b64_tr_b16 a[212:213], v219 offset:17472
    v_mfma_f32_16x16x32_bf16 v[100:103], a[228:231], a[180:183], v[100:103]
    ds_read_b64_tr_b16 a[214:215], v219 offset:18240
    v_mfma_f32_16x16x32_bf16 v[96:99], a[228:231], a[176:179], v[96:99]
    buffer_load_dwordx4 a[88:91], v208, s[36:39], s51 offen offset:2048 sc1
    v_mfma_f32_16x16x32_bf16 v[96:99], a[224:227], a[160:163], v[96:99]
    s_waitcnt lgkmcnt(8)
    v_mfma_f32_16x16x32_bf16 v[112:115], a[192:195], a[160:163], v[112:115]
    ds_read_b64_tr_b16 a[216:217], v218 offset:3200
    v_mfma_f32_16x16x32_bf16 v[112:115], a[196:199], a[176:179], v[112:115]
    ds_read_b64_tr_b16 a[218:219], v218 offset:3968
    v_mfma_f32_16x16x32_bf16 v[116:119], a[196:199], a[180:183], v[116:119]
    buffer_load_dwordx4 a[92:95], v208, s[36:39], s51 offen offset:3072 sc1
    v_mfma_f32_16x16x32_bf16 v[116:119], a[192:195], a[164:167], v[116:119]
    s_add_u32 s51, s51, s64
    v_mfma_f32_16x16x32_bf16 v[120:123], a[192:195], a[168:171], v[120:123]
    ds_read_b64_tr_b16 a[220:221], v218 offset:17536
    v_mfma_f32_16x16x32_bf16 v[120:123], a[196:199], a[184:187], v[120:123]
    s_add_u32 m0, s50, 0
    ds_read_b64_tr_b16 a[222:223], v218 offset:18304
    v_mfma_f32_16x16x32_bf16 v[124:127], a[196:199], a[188:191], v[124:127]
    buffer_load_dwordx4 v209, s[20:23], s46 offen offset:0 lds
    v_mfma_f32_16x16x32_bf16 v[124:127], a[192:195], a[172:175], v[124:127]
    s_waitcnt lgkmcnt(8)
    s_mul_i32 s55, s61, 393216
    v_mfma_f32_16x16x32_bf16 v[140:143], a[200:203], a[172:175], v[140:143]
    ds_read_b64_tr_b16 a[224:225], v219 offset:3200
    v_mfma_f32_16x16x32_bf16 v[140:143], a[204:207], a[188:191], v[140:143]
    ds_read_b64_tr_b16 a[226:227], v219 offset:3968
    v_mfma_f32_16x16x32_bf16 v[136:139], a[204:207], a[184:187], v[136:139]
    v_mfma_f32_16x16x32_bf16 v[136:139], a[200:203], a[168:171], v[136:139]
    v_mfma_f32_16x16x32_bf16 v[132:135], a[200:203], a[164:167], v[132:135]
    ds_read_b64_tr_b16 a[228:229], v219 offset:17536
    v_mfma_f32_16x16x32_bf16 v[132:135], a[204:207], a[180:183], v[132:135]
    s_add_u32 m0, s50, 1024
    ds_read_b64_tr_b16 a[230:231], v219 offset:18304
    v_mfma_f32_16x16x32_bf16 v[128:131], a[204:207], a[176:179], v[128:131]
    buffer_load_dwordx4 v240, s[20:23], s46 offen offset:0 lds
    v_mfma_f32_16x16x32_bf16 v[128:131], a[200:203], a[160:163], v[128:131]
    s_waitcnt lgkmcnt(8)
    v_mfma_f32_16x16x32_bf16 v[144:147], a[208:211], a[160:163], v[144:147]
    ds_read_b64_tr_b16 a[192:193], v220 offset:6144
    v_mfma_f32_16x16x32_bf16 v[144:147], a[212:215], a[176:179], v[144:147]
    s_add_u32 m0, s50, 2048
    ds_read_b64_tr_b16 a[194:195], v220 offset:6400
    v_mfma_f32_16x16x32_bf16 v[148:151], a[212:215], a[180:183], v[148:151]
    buffer_load_dwordx4 v241, s[20:23], s46 offen offset:0 lds
    v_mfma_f32_16x16x32_bf16 v[148:151], a[208:211], a[164:167], v[148:151]
    s_add_u32 s46, s46, s55
    v_mfma_f32_16x16x32_bf16 v[152:155], a[208:211], a[168:171], v[152:155]
    ds_read_b64_tr_b16 a[196:197], v220 offset:20480
    v_mfma_f32_16x16x32_bf16 v[152:155], a[212:215], a[184:187], v[152:155]
    s_add_u32 m0, s50, 3072
    ds_read_b64_tr_b16 a[198:199], v220 offset:20736
    v_mfma_f32_16x16x32_bf16 v[156:159], a[212:215], a[188:191], v[156:159]
    buffer_load_dwordx4 v210, s[24:27], s48 offen offset:0 lds
    v_mfma_f32_16x16x32_bf16 v[156:159], a[208:211], a[172:175], v[156:159]
    s_waitcnt lgkmcnt(8)
    s_mul_i32 s55, s61, 458752
    s_barrier
    v_mfma_f32_16x16x32_bf16 v[172:175], a[216:219], a[172:175], v[172:175]
    ds_read_b64_tr_b16 a[200:201], v215 offset:28736
    v_mfma_f32_16x16x32_bf16 v[172:175], a[220:223], a[188:191], v[172:175]
    s_add_u32 m0, s50, 4096
    ds_read_b64_tr_b16 a[202:203], v215 offset:29504
    v_mfma_f32_16x16x32_bf16 v[168:171], a[220:223], a[184:187], v[168:171]
    buffer_load_dwordx4 v242, s[24:27], s48 offen offset:0 lds
    v_mfma_f32_16x16x32_bf16 v[168:171], a[216:219], a[168:171], v[168:171]
    v_mfma_f32_16x16x32_bf16 v[164:167], a[216:219], a[164:167], v[164:167]
    ds_read_b64_tr_b16 a[204:205], v215 offset:43072
    v_mfma_f32_16x16x32_bf16 v[164:167], a[220:223], a[180:183], v[164:167]
    ds_read_b64_tr_b16 a[206:207], v215 offset:43840
    v_mfma_f32_16x16x32_bf16 v[160:163], a[220:223], a[176:179], v[160:163]
    v_mfma_f32_16x16x32_bf16 v[160:163], a[216:219], a[160:163], v[160:163]
    s_waitcnt lgkmcnt(8)
    v_mfma_f32_16x16x32_bf16 v[176:179], a[224:227], a[160:163], v[176:179]
    ds_read_b64_tr_b16 a[208:209], v216 offset:28736
    v_mfma_f32_16x16x32_bf16 v[176:179], a[228:231], a[176:179], v[176:179]
    s_add_u32 m0, s50, 5120
    ds_read_b64_tr_b16 a[210:211], v216 offset:29504
    v_mfma_f32_16x16x32_bf16 v[180:183], a[228:231], a[180:183], v[180:183]
    buffer_load_dwordx4 v243, s[24:27], s48 offen offset:0 lds
    v_mfma_f32_16x16x32_bf16 v[180:183], a[224:227], a[164:167], v[180:183]
    s_add_u32 s48, s48, s55
    v_mfma_f32_16x16x32_bf16 v[184:187], a[224:227], a[168:171], v[184:187]
    ds_read_b64_tr_b16 a[212:213], v216 offset:43072
    v_mfma_f32_16x16x32_bf16 v[184:187], a[228:231], a[184:187], v[184:187]
    s_add_u32 m0, s50, 6144
    ds_read_b64_tr_b16 a[214:215], v216 offset:43840
    v_mfma_f32_16x16x32_bf16 v[188:191], a[228:231], a[188:191], v[188:191]
    buffer_load_dwordx4 v211, s[24:27], s49 offen offset:0 lds
    v_mfma_f32_16x16x32_bf16 v[188:191], a[224:227], a[172:175], v[188:191]
    s_waitcnt lgkmcnt(8)
    s_add_u32 s49, s49, s55
    v_mfma_f32_16x16x32_bf16 v[204:207], a[192:195], a[172:175], v[204:207]
    ds_read_b64_tr_b16 a[216:217], v215 offset:28800
    v_mfma_f32_16x16x32_bf16 v[204:207], a[196:199], a[188:191], v[204:207]
    ds_read_b64_tr_b16 a[218:219], v215 offset:29568
    v_mfma_f32_16x16x32_bf16 v[200:203], a[196:199], a[184:187], v[200:203]
    buffer_load_dwordx4 a[96:99], v208, s[36:39], s51 offen offset:0 sc1
    v_mfma_f32_16x16x32_bf16 v[200:203], a[192:195], a[168:171], v[200:203]
    v_mfma_f32_16x16x32_bf16 v[196:199], a[192:195], a[164:167], v[196:199]
    ds_read_b64_tr_b16 a[220:221], v215 offset:43136
    v_mfma_f32_16x16x32_bf16 v[196:199], a[196:199], a[180:183], v[196:199]
    ds_read_b64_tr_b16 a[222:223], v215 offset:43904
    v_mfma_f32_16x16x32_bf16 v[192:195], a[196:199], a[176:179], v[192:195]
    v_mfma_f32_16x16x32_bf16 v[192:195], a[192:195], a[160:163], v[192:195]
    s_waitcnt lgkmcnt(8)
    v_mfma_f32_16x16x32_bf16 v[32:35], a[200:203], a[0:3], v[32:35]
    ds_read_b64_tr_b16 a[224:225], v216 offset:28800
    v_mfma_f32_16x16x32_bf16 v[32:35], a[204:207], a[16:19], v[32:35]
    ds_read_b64_tr_b16 a[226:227], v216 offset:29568
    v_mfma_f32_16x16x32_bf16 v[36:39], a[204:207], a[20:23], v[36:39]
    buffer_load_dwordx4 a[100:103], v208, s[36:39], s51 offen offset:1024 sc1
    v_mfma_f32_16x16x32_bf16 v[36:39], a[200:203], a[4:7], v[36:39]
    v_mfma_f32_16x16x32_bf16 v[40:43], a[200:203], a[8:11], v[40:43]
    ds_read_b64_tr_b16 a[228:229], v216 offset:43136
    v_mfma_f32_16x16x32_bf16 v[40:43], a[204:207], a[24:27], v[40:43]
    ds_read_b64_tr_b16 a[230:231], v216 offset:43904
    v_mfma_f32_16x16x32_bf16 v[44:47], a[204:207], a[28:31], v[44:47]
    buffer_load_dwordx4 a[104:107], v208, s[36:39], s51 offen offset:2048 sc1
    v_mfma_f32_16x16x32_bf16 v[44:47], a[200:203], a[12:15], v[44:47]
    s_waitcnt lgkmcnt(8)
    s_waitcnt vmcnt(33)
    s_barrier
    s_barrier
    v_mfma_f32_16x16x32_bf16 v[60:63], a[208:211], a[12:15], v[60:63]
    ds_read_b64_tr_b16 a[192:193], v215 offset:64
    v_mfma_f32_16x16x32_bf16 v[60:63], a[212:215], a[28:31], v[60:63]
    ds_read_b64_tr_b16 a[194:195], v215 offset:832
    v_mfma_f32_16x16x32_bf16 v[56:59], a[212:215], a[24:27], v[56:59]
    buffer_load_dwordx4 a[108:111], v208, s[36:39], s51 offen offset:3072 sc1
    v_mfma_f32_16x16x32_bf16 v[56:59], a[208:211], a[8:11], v[56:59]
    s_add_u32 s51, s51, 4096
    v_mfma_f32_16x16x32_bf16 v[52:55], a[208:211], a[4:7], v[52:55]
    ds_read_b64_tr_b16 a[196:197], v215 offset:14400
    v_mfma_f32_16x16x32_bf16 v[52:55], a[212:215], a[20:23], v[52:55]
    ds_read_b64_tr_b16 a[198:199], v215 offset:15168
    v_mfma_f32_16x16x32_bf16 v[48:51], a[212:215], a[16:19], v[48:51]
    buffer_load_dwordx4 a[112:115], v208, s[36:39], s51 offen offset:0 sc1
    v_mfma_f32_16x16x32_bf16 v[48:51], a[208:211], a[0:3], v[48:51]
    s_waitcnt lgkmcnt(8)
    v_mfma_f32_16x16x32_bf16 v[64:67], a[0:3], a[216:219], v[64:67]
    ds_read_b64_tr_b16 a[200:201], v216 offset:64
    v_mfma_f32_16x16x32_bf16 v[64:67], a[16:19], a[220:223], v[64:67]
    ds_read_b64_tr_b16 a[202:203], v216 offset:832
    v_mfma_f32_16x16x32_bf16 v[68:71], a[20:23], a[220:223], v[68:71]
    v_mfma_f32_16x16x32_bf16 v[68:71], a[4:7], a[216:219], v[68:71]
    v_mfma_f32_16x16x32_bf16 v[72:75], a[8:11], a[216:219], v[72:75]
    ds_read_b64_tr_b16 a[204:205], v216 offset:14400
    v_mfma_f32_16x16x32_bf16 v[72:75], a[24:27], a[220:223], v[72:75]
    ds_read_b64_tr_b16 a[206:207], v216 offset:15168
    v_mfma_f32_16x16x32_bf16 v[76:79], a[28:31], a[220:223], v[76:79]
    buffer_load_dwordx4 a[116:119], v208, s[36:39], s51 offen offset:1024 sc1
    v_mfma_f32_16x16x32_bf16 v[76:79], a[12:15], a[216:219], v[76:79]
    s_waitcnt lgkmcnt(8)
    v_mfma_f32_16x16x32_bf16 v[92:95], a[12:15], a[224:227], v[92:95]
    ds_read_b64_tr_b16 a[208:209], v215 offset:128
    v_mfma_f32_16x16x32_bf16 v[92:95], a[28:31], a[228:231], v[92:95]
    ds_read_b64_tr_b16 a[210:211], v215 offset:896
    v_mfma_f32_16x16x32_bf16 v[88:91], a[24:27], a[228:231], v[88:91]
    buffer_load_dwordx4 a[120:123], v208, s[36:39], s51 offen offset:2048 sc1
    v_mfma_f32_16x16x32_bf16 v[88:91], a[8:11], a[224:227], v[88:91]
    v_mfma_f32_16x16x32_bf16 v[84:87], a[4:7], a[224:227], v[84:87]
    ds_read_b64_tr_b16 a[212:213], v215 offset:14464
    v_mfma_f32_16x16x32_bf16 v[84:87], a[20:23], a[228:231], v[84:87]
    ds_read_b64_tr_b16 a[214:215], v215 offset:15232
    v_mfma_f32_16x16x32_bf16 v[80:83], a[16:19], a[228:231], v[80:83]
    buffer_load_dwordx4 a[124:127], v208, s[36:39], s51 offen offset:3072 sc1
    v_mfma_f32_16x16x32_bf16 v[80:83], a[0:3], a[224:227], v[80:83]
    s_waitcnt vmcnt(30) lgkmcnt(8)
    s_add_u32 s51, s51, s65
    v_mfma_f32_16x16x32_bf16 v[32:35], a[192:195], a[32:35], v[32:35]
    ds_read_b64_tr_b16 a[216:217], v216 offset:128
    v_lshrrev_b32 v252, 4, v224
    v_mfma_f32_16x16x32_bf16 v[32:35], a[196:199], a[48:51], v[32:35]
    ds_read_b64_tr_b16 a[218:219], v216 offset:896
    v_lshlrev_b32 v209, 11, v252
    v_mfma_f32_16x16x32_bf16 v[36:39], a[196:199], a[52:55], v[36:39]
    v_lshlrev_b32 v252, 1, v252
    v_and_b32 v253, 15, v224
    v_mfma_f32_16x16x32_bf16 v[36:39], a[192:195], a[36:39], v[36:39]
    v_xor_b32 v252, v252, v253
    v_lshl_add_u32 v209, v252, 4, v209
    v_mfma_f32_16x16x32_bf16 v[40:43], a[192:195], a[40:43], v[40:43]
    s_and_b32 s54, s40, 1
    ds_read_b64_tr_b16 a[220:221], v216 offset:14464
    s_lshl_b32 s54, s54, 7
    v_mfma_f32_16x16x32_bf16 v[40:43], a[196:199], a[56:59], v[40:43]
    ds_read_b64_tr_b16 a[222:223], v216 offset:15232
    v_xor_b32 v209, s54, v209
    v_mfma_f32_16x16x32_bf16 v[44:47], a[196:199], a[60:63], v[44:47]
    v_add_u32 v210, 31744, v209
    v_lshrrev_b32 v252, 4, v224
    v_mfma_f32_16x16x32_bf16 v[44:47], a[192:195], a[44:47], v[44:47]
    s_waitcnt lgkmcnt(8)
    v_lshlrev_b32 v252, 2, v252
    v_add_u32 v254, 0, v252
    s_waitcnt vmcnt(23)
    s_barrier
    v_mfma_f32_16x16x32_bf16 v[60:63], a[200:203], a[44:47], v[60:63]
    ds_read_b64_tr_b16 a[224:225], v212 offset:28736
    v_cmp_le_u32 s[58:59], v254, v253
    v_mfma_f32_16x16x32_bf16 v[60:63], a[204:207], a[60:63], v[60:63]
    ds_read_b64_tr_b16 a[226:227], v212 offset:29504
    v_add_u32 v254, 1, v252
    v_mfma_f32_16x16x32_bf16 v[56:59], a[204:207], a[56:59], v[56:59]
    v_cmp_le_u32 s[60:61], v254, v253
    v_add_u32 v254, 2, v252
    v_mfma_f32_16x16x32_bf16 v[56:59], a[200:203], a[40:43], v[56:59]
    v_cmp_le_u32 s[62:63], v254, v253
    v_add_u32 v254, 3, v252
    v_mfma_f32_16x16x32_bf16 v[52:55], a[200:203], a[36:39], v[52:55]
    ds_read_b64_tr_b16 a[228:229], v212 offset:43072
    v_cmp_le_u32 s[64:65], v254, v253
    v_mfma_f32_16x16x32_bf16 v[52:55], a[204:207], a[52:55], v[52:55]
    s_lshl_b32 s55, s40, 13
    ds_read_b64_tr_b16 a[230:231], v212 offset:43840
    s_lshl_b32 s54, s45, 8
    v_mfma_f32_16x16x32_bf16 v[48:51], a[204:207], a[48:51], v[48:51]
    s_add_u32 s55, s55, s54
    s_lshl_b32 s47, s44, 19
    s_add_u32 s47, s47, s55
    v_mfma_f32_16x16x32_bf16 v[48:51], a[200:203], a[32:35], v[48:51]
    s_waitcnt lgkmcnt(8)
    s_mul_i32 s79, s44, 1835008
    s_add_u32 s79, s79, s55
    v_mfma_f32_16x16x32_bf16 v[64:67], a[32:35], a[208:211], v[64:67]
    s_mul_i32 s54, s45, 7
    ds_read_b64_tr_b16 a[192:193], v213 offset:28736
    s_add_u32 s54, s54, s43
    v_mfma_f32_16x16x32_bf16 v[64:67], a[48:51], a[212:215], v[64:67]
    s_lshl_b32 s54, s54, 15
    ds_read_b64_tr_b16 a[194:195], v213 offset:29504
    s_add_u32 s46, s79, s54
    v_mfma_f32_16x16x32_bf16 v[68:71], a[52:55], a[212:215], v[68:71]
    s_sub_u32 s51, s80, 114688
    s_mov_b32 s80, s72
    s_add_u32 s78, s72, 12288
    v_mfma_f32_16x16x32_bf16 v[68:71], a[36:39], a[208:211], v[68:71]
    s_mov_b32 s48, s79
    s_cmp_eq_u32 s51, s80
    s_cselect_b32 s51, s78, s51
    v_mfma_f32_16x16x32_bf16 v[72:75], a[40:43], a[208:211], v[72:75]
    ds_read_b64_tr_b16 a[196:197], v213 offset:43072
    v_mfma_f32_16x16x32_bf16 v[72:75], a[56:59], a[212:215], v[72:75]
    ds_read_b64_tr_b16 a[198:199], v213 offset:43840
    v_mfma_f32_16x16x32_bf16 v[76:79], a[60:63], a[212:215], v[76:79]
    v_mfma_f32_16x16x32_bf16 v[76:79], a[44:47], a[208:211], v[76:79]
    s_waitcnt lgkmcnt(8)
    v_mfma_f32_16x16x32_bf16 v[92:95], a[44:47], a[216:219], v[92:95]
    ds_read_b64_tr_b16 a[200:201], v212 offset:28800
    v_mfma_f32_16x16x32_bf16 v[92:95], a[60:63], a[220:223], v[92:95]
    ds_read_b64_tr_b16 a[202:203], v212 offset:29568
    v_mfma_f32_16x16x32_bf16 v[88:91], a[56:59], a[220:223], v[88:91]
    v_mfma_f32_16x16x32_bf16 v[88:91], a[40:43], a[216:219], v[88:91]
    v_mfma_f32_16x16x32_bf16 v[84:87], a[36:39], a[216:219], v[84:87]
    ds_read_b64_tr_b16 a[204:205], v212 offset:43136
    v_mfma_f32_16x16x32_bf16 v[84:87], a[52:55], a[220:223], v[84:87]
    ds_read_b64_tr_b16 a[206:207], v212 offset:43904
    v_mfma_f32_16x16x32_bf16 v[80:83], a[48:51], a[220:223], v[80:83]
    v_mfma_f32_16x16x32_bf16 v[80:83], a[32:35], a[216:219], v[80:83]
    s_waitcnt vmcnt(15) lgkmcnt(8)
    v_mfma_f32_16x16x32_bf16 v[32:35], a[224:227], a[64:67], v[32:35]
    ds_read_b64_tr_b16 a[208:209], v213 offset:28800
    v_mfma_f32_16x16x32_bf16 v[32:35], a[228:231], a[80:83], v[32:35]
    ds_read_b64_tr_b16 a[210:211], v213 offset:29568
    v_mfma_f32_16x16x32_bf16 v[36:39], a[228:231], a[84:87], v[36:39]
    v_mfma_f32_16x16x32_bf16 v[36:39], a[224:227], a[68:71], v[36:39]
    v_mfma_f32_16x16x32_bf16 v[40:43], a[224:227], a[72:75], v[40:43]
    ds_read_b64_tr_b16 a[212:213], v213 offset:43136
    v_mfma_f32_16x16x32_bf16 v[40:43], a[228:231], a[88:91], v[40:43]
    ds_read_b64_tr_b16 a[214:215], v213 offset:43904
    v_mfma_f32_16x16x32_bf16 v[44:47], a[228:231], a[92:95], v[44:47]
    v_mfma_f32_16x16x32_bf16 v[44:47], a[224:227], a[76:79], v[44:47]
    s_waitcnt lgkmcnt(8)
    s_waitcnt vmcnt(8)
    s_barrier
    v_mfma_f32_16x16x32_bf16 v[60:63], a[192:195], a[76:79], v[60:63]
    ds_read_b64_tr_b16 a[216:217], v212 offset:64
    v_mfma_f32_16x16x32_bf16 v[60:63], a[196:199], a[92:95], v[60:63]
    ds_read_b64_tr_b16 a[218:219], v212 offset:832
    v_mfma_f32_16x16x32_bf16 v[56:59], a[196:199], a[88:91], v[56:59]
    v_mfma_f32_16x16x32_bf16 v[56:59], a[192:195], a[72:75], v[56:59]
    v_mfma_f32_16x16x32_bf16 v[52:55], a[192:195], a[68:71], v[52:55]
    ds_read_b64_tr_b16 a[220:221], v212 offset:14400
    v_mfma_f32_16x16x32_bf16 v[52:55], a[196:199], a[84:87], v[52:55]
    ds_read_b64_tr_b16 a[222:223], v212 offset:15168
    v_mfma_f32_16x16x32_bf16 v[48:51], a[196:199], a[80:83], v[48:51]
    v_mfma_f32_16x16x32_bf16 v[48:51], a[192:195], a[64:67], v[48:51]
    s_waitcnt lgkmcnt(8)
    v_mfma_f32_16x16x32_bf16 v[64:67], a[64:67], a[200:203], v[64:67]
    ds_read_b64_tr_b16 a[224:225], v213 offset:64
    v_mfma_f32_16x16x32_bf16 v[64:67], a[80:83], a[204:207], v[64:67]
    ds_read_b64_tr_b16 a[226:227], v213 offset:832
    v_mfma_f32_16x16x32_bf16 v[68:71], a[84:87], a[204:207], v[68:71]
    v_mfma_f32_16x16x32_bf16 v[68:71], a[68:71], a[200:203], v[68:71]
    v_mfma_f32_16x16x32_bf16 v[72:75], a[72:75], a[200:203], v[72:75]
    ds_read_b64_tr_b16 a[228:229], v213 offset:14400
    v_mfma_f32_16x16x32_bf16 v[72:75], a[88:91], a[204:207], v[72:75]
    ds_read_b64_tr_b16 a[230:231], v213 offset:15168
    v_mfma_f32_16x16x32_bf16 v[76:79], a[92:95], a[204:207], v[76:79]
    v_mfma_f32_16x16x32_bf16 v[76:79], a[76:79], a[200:203], v[76:79]
    s_waitcnt lgkmcnt(8)
    v_mfma_f32_16x16x32_bf16 v[92:95], a[76:79], a[208:211], v[92:95]
    ds_read_b64_tr_b16 a[192:193], v212 offset:128
    v_mfma_f32_16x16x32_bf16 v[92:95], a[92:95], a[212:215], v[92:95]
    ds_read_b64_tr_b16 a[194:195], v212 offset:896
    v_mfma_f32_16x16x32_bf16 v[88:91], a[88:91], a[212:215], v[88:91]
    v_mfma_f32_16x16x32_bf16 v[88:91], a[72:75], a[208:211], v[88:91]
    v_mfma_f32_16x16x32_bf16 v[84:87], a[68:71], a[208:211], v[84:87]
    ds_read_b64_tr_b16 a[196:197], v212 offset:14464
    v_mfma_f32_16x16x32_bf16 v[84:87], a[84:87], a[212:215], v[84:87]
    ds_read_b64_tr_b16 a[198:199], v212 offset:15232
    v_mfma_f32_16x16x32_bf16 v[80:83], a[80:83], a[212:215], v[80:83]
    v_mfma_f32_16x16x32_bf16 v[80:83], a[64:67], a[208:211], v[80:83]
    s_waitcnt vmcnt(0) lgkmcnt(8)
    v_mfma_f32_16x16x32_bf16 v[32:35], a[216:219], a[96:99], v[32:35]
    ds_read_b64_tr_b16 a[200:201], v213 offset:128
    v_mfma_f32_16x16x32_bf16 v[32:35], a[220:223], a[112:115], v[32:35]
    ds_read_b64_tr_b16 a[202:203], v213 offset:896
    v_mfma_f32_16x16x32_bf16 v[36:39], a[220:223], a[116:119], v[36:39]
    v_mfma_f32_16x16x32_bf16 v[36:39], a[216:219], a[100:103], v[36:39]
    v_mfma_f32_16x16x32_bf16 v[40:43], a[216:219], a[104:107], v[40:43]
    ds_read_b64_tr_b16 a[204:205], v213 offset:14464
    v_mfma_f32_16x16x32_bf16 v[40:43], a[220:223], a[120:123], v[40:43]
    ds_read_b64_tr_b16 a[206:207], v213 offset:15232
    v_mfma_f32_16x16x32_bf16 v[44:47], a[220:223], a[124:127], v[44:47]
    v_mfma_f32_16x16x32_bf16 v[44:47], a[216:219], a[108:111], v[44:47]
    s_waitcnt lgkmcnt(8)
    v_mfma_f32_16x16x32_bf16 v[60:63], a[224:227], a[108:111], v[60:63]
    ds_read_b64_tr_b16 a[208:209], v215 offset:31744
    v_mfma_f32_16x16x32_bf16 v[60:63], a[228:231], a[124:127], v[60:63]
    ds_read_b64_tr_b16 a[210:211], v215 offset:32512
    v_mfma_f32_16x16x32_bf16 v[56:59], a[228:231], a[120:123], v[56:59]
    v_mfma_f32_16x16x32_bf16 v[56:59], a[224:227], a[104:107], v[56:59]
    v_mfma_f32_16x16x32_bf16 v[52:55], a[224:227], a[100:103], v[52:55]
    ds_read_b64_tr_b16 a[212:213], v215 offset:46080
    v_mfma_f32_16x16x32_bf16 v[52:55], a[228:231], a[116:119], v[52:55]
    ds_read_b64_tr_b16 a[214:215], v215 offset:46848
    v_mfma_f32_16x16x32_bf16 v[48:51], a[228:231], a[112:115], v[48:51]
    v_mfma_f32_16x16x32_bf16 v[48:51], a[224:227], a[96:99], v[48:51]
    s_waitcnt lgkmcnt(8)
    v_mfma_f32_16x16x32_bf16 v[64:67], a[96:99], a[192:195], v[64:67]
    ds_read_b64_tr_b16 a[216:217], v215 offset:3072
    v_mfma_f32_16x16x32_bf16 v[64:67], a[112:115], a[196:199], v[64:67]
    ds_read_b64_tr_b16 a[218:219], v215 offset:3840
    v_mfma_f32_16x16x32_bf16 v[68:71], a[116:119], a[196:199], v[68:71]
    v_mfma_f32_16x16x32_bf16 v[68:71], a[100:103], a[192:195], v[68:71]
    v_mfma_f32_16x16x32_bf16 v[72:75], a[104:107], a[192:195], v[72:75]
    ds_read_b64_tr_b16 a[220:221], v215 offset:17408
    v_mfma_f32_16x16x32_bf16 v[72:75], a[120:123], a[196:199], v[72:75]
    ds_read_b64_tr_b16 a[222:223], v215 offset:18176
    v_mfma_f32_16x16x32_bf16 v[76:79], a[124:127], a[196:199], v[76:79]
    v_mfma_f32_16x16x32_bf16 v[76:79], a[108:111], a[192:195], v[76:79]
    s_waitcnt lgkmcnt(8)
    v_mfma_f32_16x16x32_bf16 v[92:95], a[108:111], a[200:203], v[92:95]
    ds_read_b64_tr_b16 a[224:225], v216 offset:31744
    v_mfma_f32_16x16x32_bf16 v[92:95], a[124:127], a[204:207], v[92:95]
    ds_read_b64_tr_b16 a[226:227], v216 offset:32512
    v_mfma_f32_16x16x32_bf16 v[88:91], a[120:123], a[204:207], v[88:91]
    v_mfma_f32_16x16x32_bf16 v[88:91], a[104:107], a[200:203], v[88:91]
    v_mfma_f32_16x16x32_bf16 v[84:87], a[100:103], a[200:203], v[84:87]
    ds_read_b64_tr_b16 a[228:229], v216 offset:46080
    v_mfma_f32_16x16x32_bf16 v[84:87], a[116:119], a[204:207], v[84:87]
    ds_read_b64_tr_b16 a[230:231], v216 offset:46848
    v_mfma_f32_16x16x32_bf16 v[80:83], a[112:115], a[204:207], v[80:83]
    v_mfma_f32_16x16x32_bf16 v[80:83], a[96:99], a[200:203], v[80:83]
    s_waitcnt lgkmcnt(4)
    s_getpc_b64 s[20:21]
F_pc_24:
    s_and_b32 s21, s21, 0xffff
    s_mov_b32 s22, CODE_END - F_pc_24
    s_lshr_b32 s53, s2, 3
    s_lshl_b32 s53, s53, 2
    s_add_u32 s53, s53, s40
    s_lshl_b32 s53, s53, 9
    s_mov_b64 exec, 0xf
    buffer_load_dword a255, v231, s[20:23], s53 offen
    s_mov_b64 exec, -1
    v_mfma_f32_16x16x32_bf16 v[96:99], a[208:211], a[0:3], v[96:99]
    ds_read_b64_tr_b16 a[192:193], v216 offset:3072
    v_mfma_f32_16x16x32_bf16 v[96:99], a[212:215], a[16:19], v[96:99]
    ds_read_b64_tr_b16 a[194:195], v216 offset:3840
    v_mfma_f32_16x16x32_bf16 v[96:99], a[216:219], a[32:35], v[96:99]
    v_mfma_f32_16x16x32_bf16 v[96:99], a[220:223], a[48:51], v[96:99]
    v_mfma_f32_16x16x32_bf16 v[100:103], a[220:223], a[52:55], v[100:103]
    ds_read_b64_tr_b16 a[196:197], v216 offset:17408
    v_mfma_f32_16x16x32_bf16 v[100:103], a[216:219], a[36:39], v[100:103]
    ds_read_b64_tr_b16 a[198:199], v216 offset:18176
    v_cvt_pk_bf16_f32 v32, v32, v33
    v_mfma_f32_16x16x32_bf16 v[100:103], a[212:215], a[20:23], v[100:103]
    v_cvt_pk_bf16_f32 v33, v34, v35
    v_cvt_pk_bf16_f32 v34, v48, v49
    v_mfma_f32_16x16x32_bf16 v[100:103], a[208:211], a[4:7], v[100:103]
    v_cvt_pk_bf16_f32 v35, v50, v51
    v_mfma_f32_16x16x32_bf16 v[104:107], a[208:211], a[8:11], v[104:107]
    ds_read_b64_tr_b16 a[200:201], v215 offset:31808
    v_mfma_f32_16x16x32_bf16 v[104:107], a[212:215], a[24:27], v[104:107]
    ds_read_b64_tr_b16 a[202:203], v215 offset:32576
    v_mfma_f32_16x16x32_bf16 v[104:107], a[216:219], a[40:43], v[104:107]
    buffer_store_dwordx4 v[32:35], v208, s[36:39], s66 offen offset:0 sc1
    v_mfma_f32_16x16x32_bf16 v[104:107], a[220:223], a[56:59], v[104:107]
    v_cvt_pk_bf16_f32 v36, v36, v37
    v_cvt_pk_bf16_f32 v37, v38, v39
    v_mfma_f32_16x16x32_bf16 v[108:111], a[220:223], a[60:63], v[108:111]
    ds_read_b64_tr_b16 a[204:205], v215 offset:46144
    v_cvt_pk_bf16_f32 v38, v52, v53
    v_mfma_f32_16x16x32_bf16 v[108:111], a[216:219], a[44:47], v[108:111]
    ds_read_b64_tr_b16 a[206:207], v215 offset:46912
    v_cvt_pk_bf16_f32 v39, v54, v55
    v_mfma_f32_16x16x32_bf16 v[108:111], a[212:215], a[28:31], v[108:111]
    buffer_store_dwordx4 v[36:39], v208, s[36:39], s66 offen offset:1024 sc1
    v_mfma_f32_16x16x32_bf16 v[108:111], a[208:211], a[12:15], v[108:111]
    s_waitcnt lgkmcnt(4)
    v_cvt_pk_bf16_f32 v40, v40, v41
    v_cvt_pk_bf16_f32 v41, v42, v43
    v_mfma_f32_16x16x32_bf16 v[124:127], a[224:227], a[12:15], v[124:127]
    ds_read_b64_tr_b16 a[208:209], v215 offset:3136
    v_cvt_pk_bf16_f32 v42, v56, v57
    v_mfma_f32_16x16x32_bf16 v[124:127], a[228:231], a[28:31], v[124:127]
    ds_read_b64_tr_b16 a[210:211], v215 offset:3904
    v_cvt_pk_bf16_f32 v43, v58, v59
    v_mfma_f32_16x16x32_bf16 v[124:127], a[192:195], a[44:47], v[124:127]
    buffer_store_dwordx4 v[40:43], v208, s[36:39], s66 offen offset:2048 sc1
    v_mfma_f32_16x16x32_bf16 v[124:127], a[196:199], a[60:63], v[124:127]
    v_cvt_pk_bf16_f32 v44, v44, v45
    v_cvt_pk_bf16_f32 v45, v46, v47
    v_mfma_f32_16x16x32_bf16 v[120:123], a[196:199], a[56:59], v[120:123]
    ds_read_b64_tr_b16 a[212:213], v215 offset:17472
    v_cvt_pk_bf16_f32 v46, v60, v61
    v_mfma_f32_16x16x32_bf16 v[120:123], a[192:195], a[40:43], v[120:123]
    ds_read_b64_tr_b16 a[214:215], v215 offset:18240
    v_cvt_pk_bf16_f32 v47, v62, v63
    v_mfma_f32_16x16x32_bf16 v[120:123], a[228:231], a[24:27], v[120:123]
    buffer_store_dwordx4 v[44:47], v208, s[36:39], s66 offen offset:3072 sc1
    v_mfma_f32_16x16x32_bf16 v[120:123], a[224:227], a[8:11], v[120:123]
    v_cvt_pk_bf16_f32 v64, v64, v65
    v_cvt_pk_bf16_f32 v65, v66, v67
    v_mfma_f32_16x16x32_bf16 v[116:119], a[224:227], a[4:7], v[116:119]
    ds_read_b64_tr_b16 a[216:217], v216 offset:31808
    v_cvt_pk_bf16_f32 v66, v68, v69
    v_mfma_f32_16x16x32_bf16 v[116:119], a[228:231], a[20:23], v[116:119]
    ds_read_b64_tr_b16 a[218:219], v216 offset:32576
    v_cvt_pk_bf16_f32 v67, v70, v71
    v_mfma_f32_16x16x32_bf16 v[116:119], a[192:195], a[36:39], v[116:119]
    buffer_store_dwordx4 v[64:67], v208, s[36:39], s67 offen offset:0 sc1
    v_mfma_f32_16x16x32_bf16 v[116:119], a[196:199], a[52:55], v[116:119]
    v_cvt_pk_bf16_f32 v80, v80, v81
    v_cvt_pk_bf16_f32 v81, v82, v83
    v_mfma_f32_16x16x32_bf16 v[112:115], a[196:199], a[48:51], v[112:115]
    ds_read_b64_tr_b16 a[220:221], v216 offset:46144
    v_cvt_pk_bf16_f32 v82, v84, v85
    v_mfma_f32_16x16x32_bf16 v[112:115], a[192:195], a[32:35], v[112:115]
    ds_read_b64_tr_b16 a[222:223], v216 offset:46912
    v_cvt_pk_bf16_f32 v83, v86, v87
    v_mfma_f32_16x16x32_bf16 v[112:115], a[228:231], a[16:19], v[112:115]
    buffer_store_dwordx4 v[80:83], v208, s[36:39], s67 offen offset:1024 sc1
    v_mfma_f32_16x16x32_bf16 v[112:115], a[224:227], a[0:3], v[112:115]
    s_waitcnt lgkmcnt(4)
    v_cvt_pk_bf16_f32 v72, v72, v73
    v_cvt_pk_bf16_f32 v73, v74, v75
    v_mfma_f32_16x16x32_bf16 v[128:131], a[200:203], a[0:3], v[128:131]
    ds_read_b64_tr_b16 a[224:225], v216 offset:3136
    v_cvt_pk_bf16_f32 v74, v76, v77
    v_mfma_f32_16x16x32_bf16 v[128:131], a[204:207], a[16:19], v[128:131]
    ds_read_b64_tr_b16 a[226:227], v216 offset:3904
    v_cvt_pk_bf16_f32 v75, v78, v79
    v_mfma_f32_16x16x32_bf16 v[128:131], a[208:211], a[32:35], v[128:131]
    buffer_store_dwordx4 v[72:75], v208, s[36:39], s67 offen offset:2048 sc1
    v_mfma_f32_16x16x32_bf16 v[128:131], a[212:215], a[48:51], v[128:131]
    v_cvt_pk_bf16_f32 v88, v88, v89
    v_cvt_pk_bf16_f32 v89, v90, v91
    v_mfma_f32_16x16x32_bf16 v[132:135], a[212:215], a[52:55], v[132:135]
    ds_read_b64_tr_b16 a[228:229], v216 offset:17472
    v_cvt_pk_bf16_f32 v90, v92, v93
    v_mfma_f32_16x16x32_bf16 v[132:135], a[208:211], a[36:39], v[132:135]
    ds_read_b64_tr_b16 a[230:231], v216 offset:18240
    v_cvt_pk_bf16_f32 v91, v94, v95
    v_mfma_f32_16x16x32_bf16 v[132:135], a[204:207], a[20:23], v[132:135]
    buffer_store_dwordx4 v[88:91], v208, s[36:39], s67 offen offset:3072 sc1
    v_mfma_f32_16x16x32_bf16 v[132:135], a[200:203], a[4:7], v[132:135]
    ds_write_b128 v228, v[32:35] offset:16384
    v_mfma_f32_16x16x32_bf16 v[136:139], a[200:203], a[8:11], v[136:139]
    ds_read_b64_tr_b16 a[192:193], v212 offset:31744
    v_mfma_f32_16x16x32_bf16 v[136:139], a[204:207], a[24:27], v[136:139]
    ds_read_b64_tr_b16 a[194:195], v212 offset:32512
    v_mfma_f32_16x16x32_bf16 v[136:139], a[208:211], a[40:43], v[136:139]
    ds_write_b128 v228, v[36:39] offset:17408
    v_mfma_f32_16x16x32_bf16 v[136:139], a[212:215], a[56:59], v[136:139]
    v_mfma_f32_16x16x32_bf16 v[140:143], a[212:215], a[60:63], v[140:143]
    ds_read_b64_tr_b16 a[196:197], v212 offset:46080
    v_mfma_f32_16x16x32_bf16 v[140:143], a[208:211], a[44:47], v[140:143]
    ds_read_b64_tr_b16 a[198:199], v212 offset:46848
    v_mfma_f32_16x16x32_bf16 v[140:143], a[204:207], a[28:31], v[140:143]
    ds_write_b128 v228, v[40:43] offset:18432
    v_mfma_f32_16x16x32_bf16 v[140:143], a[200:203], a[12:15], v[140:143]
    s_waitcnt lgkmcnt(7)
    v_mfma_f32_16x16x32_bf16 v[156:159], a[216:219], a[12:15], v[156:159]
    ds_read_b64_tr_b16 a[200:201], v212 offset:3072
    v_mfma_f32_16x16x32_bf16 v[156:159], a[220:223], a[28:31], v[156:159]
    ds_read_b64_tr_b16 a[202:203], v212 offset:3840
    v_mfma_f32_16x16x32_bf16 v[156:159], a[224:227], a[44:47], v[156:159]
    ds_write_b128 v228, v[44:47] offset:19456
    v_mfma_f32_16x16x32_bf16 v[156:159], a[228:231], a[60:63], v[156:159]
    v_mfma_f32_16x16x32_bf16 v[152:155], a[228:231], a[56:59], v[152:155]
    ds_read_b64_tr_b16 a[204:205], v212 offset:17408
    v_mfma_f32_16x16x32_bf16 v[152:155], a[224:227], a[40:43], v[152:155]
    ds_read_b64_tr_b16 a[206:207], v212 offset:18176
    v_mfma_f32_16x16x32_bf16 v[152:155], a[220:223], a[24:27], v[152:155]
    ds_write_b128 v228, v[64:67] offset:49152
    v_mfma_f32_16x16x32_bf16 v[152:155], a[216:219], a[8:11], v[152:155]
    v_mfma_f32_16x16x32_bf16 v[148:151], a[216:219], a[4:7], v[148:151]
    ds_read_b64_tr_b16 a[208:209], v213 offset:31744
    v_mfma_f32_16x16x32_bf16 v[148:151], a[220:223], a[20:23], v[148:151]
    ds_read_b64_tr_b16 a[210:211], v213 offset:32512
    v_mfma_f32_16x16x32_bf16 v[148:151], a[224:227], a[36:39], v[148:151]
    ds_write_b128 v228, v[80:83] offset:50176
    v_mfma_f32_16x16x32_bf16 v[148:151], a[228:231], a[52:55], v[148:151]
    v_mfma_f32_16x16x32_bf16 v[144:147], a[228:231], a[48:51], v[144:147]
    ds_read_b64_tr_b16 a[212:213], v213 offset:46080
    v_mfma_f32_16x16x32_bf16 v[144:147], a[224:227], a[32:35], v[144:147]
    ds_read_b64_tr_b16 a[214:215], v213 offset:46848
    v_mfma_f32_16x16x32_bf16 v[144:147], a[220:223], a[16:19], v[144:147]
    ds_write_b128 v228, v[72:75] offset:51200
    v_mfma_f32_16x16x32_bf16 v[144:147], a[216:219], a[0:3], v[144:147]
    s_waitcnt lgkmcnt(7)
    v_mfma_f32_16x16x32_bf16 v[96:99], a[192:195], a[64:67], v[96:99]
    ds_read_b64_tr_b16 a[216:217], v213 offset:3072
    v_mfma_f32_16x16x32_bf16 v[96:99], a[196:199], a[80:83], v[96:99]
    ds_read_b64_tr_b16 a[218:219], v213 offset:3840
    v_mfma_f32_16x16x32_bf16 v[96:99], a[200:203], a[96:99], v[96:99]
    ds_write_b128 v228, v[88:91] offset:52224
    v_mfma_f32_16x16x32_bf16 v[96:99], a[204:207], a[112:115], v[96:99]
    v_mfma_f32_16x16x32_bf16 v[100:103], a[204:207], a[116:119], v[100:103]
    s_lshl_b32 s54, s41, 2
    ds_read_b64_tr_b16 a[220:221], v213 offset:17408
    s_add_u32 s54, s54, s40
    v_mfma_f32_16x16x32_bf16 v[100:103], a[200:203], a[100:103], v[100:103]
    s_cmp_lt_u32 s54, 4
    s_cselect_b32 s55, 0xf149f2ca, 0
    ds_read_b64_tr_b16 a[222:223], v213 offset:18176
    v_mov_b32 v232, s55
    v_mfma_f32_16x16x32_bf16 v[100:103], a[196:199], a[84:87], v[100:103]
    v_mov_b32 v233, s55
    v_mov_b32 v234, s55
    v_mfma_f32_16x16x32_bf16 v[100:103], a[192:195], a[68:71], v[100:103]
    v_mov_b32 v235, s55
    s_cmp_lt_u32 s54, 3
    s_cselect_b32 s55, 0xf149f2ca, 0
    v_mfma_f32_16x16x32_bf16 v[104:107], a[192:195], a[72:75], v[104:107]
    ds_read_b64_tr_b16 a[224:225], v212 offset:31808
    v_mov_b32 v236, s55
    v_mfma_f32_16x16x32_bf16 v[104:107], a[196:199], a[88:91], v[104:107]
    ds_read_b64_tr_b16 a[226:227], v212 offset:32576
    v_mov_b32 v237, s55
    v_mfma_f32_16x16x32_bf16 v[104:107], a[200:203], a[104:107], v[104:107]
    v_mov_b32 v238, s55
    v_mov_b32 v239, s55
    v_mfma_f32_16x16x32_bf16 v[104:107], a[204:207], a[120:123], v[104:107]
    s_cmp_lt_u32 s54, 2
    s_cselect_b32 s55, 0xf149f2ca, 0
    v_mov_b32 v240, s55
    v_mov_b32 v241, s55
    v_mfma_f32_16x16x32_bf16 v[108:111], a[204:207], a[124:127], v[108:111]
    ds_read_b64_tr_b16 a[228:229], v212 offset:46144
    v_mov_b32 v242, s55
    v_mfma_f32_16x16x32_bf16 v[108:111], a[200:203], a[108:111], v[108:111]
    ds_read_b64_tr_b16 a[230:231], v212 offset:46912
    v_mov_b32 v243, s55
    v_mfma_f32_16x16x32_bf16 v[108:111], a[196:199], a[92:95], v[108:111]
    s_cmp_lt_u32 s54, 1
    s_cselect_b32 s55, 0xf149f2ca, 0
    v_mov_b32 v244, s55
    v_mov_b32 v245, s55
    v_mfma_f32_16x16x32_bf16 v[108:111], a[192:195], a[76:79], v[108:111]
    s_waitcnt lgkmcnt(4)
    v_mov_b32 v246, s55
    v_mov_b32 v247, s55
    v_mfma_f32_16x16x32_bf16 v[124:127], a[208:211], a[76:79], v[124:127]
    ds_read_b64_tr_b16 a[192:193], v212 offset:3136
    v_mov_b32 v248, 0x3f803f80
    v_mfma_f32_16x16x32_bf16 v[124:127], a[212:215], a[92:95], v[124:127]
    ds_read_b64_tr_b16 a[194:195], v212 offset:3904
    v_mov_b32 v249, 0x3f803f80
    v_mfma_f32_16x16x32_bf16 v[124:127], a[216:219], a[108:111], v[124:127]
    v_mov_b32 v250, 0x3f803f80
    v_mov_b32 v251, 0x3f803f80
    v_mfma_f32_16x16x32_bf16 v[124:127], a[220:223], a[124:127], v[124:127]
    v_lshrrev_b32 v252, 2, v224
    v_and_b32 v254, 7, v252
    v_mfma_f32_16x16x32_bf16 v[120:123], a[220:223], a[120:123], v[120:123]
    ds_read_b64_tr_b16 a[196:197], v212 offset:17472
    v_and_b32 v252, 3, v252
    v_mfma_f32_16x16x32_bf16 v[120:123], a[216:219], a[104:107], v[120:123]
    ds_read_b64_tr_b16 a[198:199], v212 offset:18240
    v_lshlrev_b32 v252, 8, v252
    v_mfma_f32_16x16x32_bf16 v[120:123], a[212:215], a[88:91], v[120:123]
    v_lshrrev_b32 v253, 4, v224
    v_mul_u32_u24 v253, 7168, v253
    v_mfma_f32_16x16x32_bf16 v[120:123], a[208:211], a[72:75], v[120:123]
    v_add_u32 v252, v252, v253
    v_and_b32 v253, 3, v224
    v_mfma_f32_16x16x32_bf16 v[116:119], a[208:211], a[68:71], v[116:119]
    ds_read_b64_tr_b16 a[200:201], v213 offset:31808
    v_lshl_add_u32 v252, v253, 3, v252
    v_mfma_f32_16x16x32_bf16 v[116:119], a[212:215], a[84:87], v[116:119]
    ds_read_b64_tr_b16 a[202:203], v213 offset:32576
    v_lshl_add_u32 v231, v254, 5, v252
    v_mfma_f32_16x16x32_bf16 v[116:119], a[216:219], a[100:103], v[116:119]
    s_lshl_b32 s54, s44, 6
    s_xor_b32 s54, s54, 192
    v_xor_b32 v231, s54, v231
    v_mfma_f32_16x16x32_bf16 v[116:119], a[220:223], a[116:119], v[116:119]
    v_mov_b32 v252, 0xffff
    v_mov_b32 v253, 0xffff0000
    v_mfma_f32_16x16x32_bf16 v[112:115], a[220:223], a[112:115], v[112:115]
    ds_read_b64_tr_b16 a[204:205], v213 offset:46144
    v_cndmask_b32 v254, 0, v252, s[58:59]
    v_mfma_f32_16x16x32_bf16 v[112:115], a[216:219], a[96:99], v[112:115]
    ds_read_b64_tr_b16 a[206:207], v213 offset:46912
    v_cndmask_b32 v255, 0, v252, s[62:63]
    v_mfma_f32_16x16x32_bf16 v[112:115], a[212:215], a[80:83], v[112:115]
    v_cndmask_b32 v252, 0, v253, s[60:61]
    v_cndmask_b32 v253, 0, v253, s[64:65]
    v_mfma_f32_16x16x32_bf16 v[112:115], a[208:211], a[64:67], v[112:115]
    s_waitcnt lgkmcnt(4)
    v_or_b32 v254, v254, v252
    v_or_b32 v255, v255, v253
    v_mfma_f32_16x16x32_bf16 v[128:131], a[224:227], a[64:67], v[128:131]
    ds_read_b64_tr_b16 a[208:209], v213 offset:3136
    v_lshlrev_b32 v211, 3, v224
    v_mfma_f32_16x16x32_bf16 v[128:131], a[228:231], a[80:83], v[128:131]
    ds_read_b64_tr_b16 a[210:211], v213 offset:3904
    v_mfma_f32_16x16x32_bf16 v[128:131], a[192:195], a[96:99], v[128:131]
    v_mfma_f32_16x16x32_bf16 v[128:131], a[196:199], a[112:115], v[128:131]
    v_mfma_f32_16x16x32_bf16 v[132:135], a[196:199], a[116:119], v[132:135]
    ds_read_b64_tr_b16 a[212:213], v213 offset:17472
    v_mfma_f32_16x16x32_bf16 v[132:135], a[192:195], a[100:103], v[132:135]
    ds_read_b64_tr_b16 a[214:215], v213 offset:18240
    v_mfma_f32_16x16x32_bf16 v[132:135], a[228:231], a[84:87], v[132:135]
    v_mfma_f32_16x16x32_bf16 v[132:135], a[224:227], a[68:71], v[132:135]
    v_mfma_f32_16x16x32_bf16 v[136:139], a[224:227], a[72:75], v[136:139]
    ds_read_b64_tr_b16 a[216:217], v215 offset:31872
    v_mfma_f32_16x16x32_bf16 v[136:139], a[228:231], a[88:91], v[136:139]
    ds_read_b64_tr_b16 a[218:219], v215 offset:32640
    v_mfma_f32_16x16x32_bf16 v[136:139], a[192:195], a[104:107], v[136:139]
    v_mfma_f32_16x16x32_bf16 v[136:139], a[196:199], a[120:123], v[136:139]
    v_mfma_f32_16x16x32_bf16 v[140:143], a[196:199], a[124:127], v[140:143]
    ds_read_b64_tr_b16 a[220:221], v215 offset:46208
    v_mfma_f32_16x16x32_bf16 v[140:143], a[192:195], a[108:111], v[140:143]
    ds_read_b64_tr_b16 a[222:223], v215 offset:46976
    v_mfma_f32_16x16x32_bf16 v[140:143], a[228:231], a[92:95], v[140:143]
    v_mfma_f32_16x16x32_bf16 v[140:143], a[224:227], a[76:79], v[140:143]
    s_waitcnt lgkmcnt(4)
    s_waitcnt vmcnt(0)
    buffer_store_dword v226, v225, s[36:39], s70 offen sc1
    v_mfma_f32_16x16x32_bf16 v[156:159], a[200:203], a[76:79], v[156:159]
    ds_read_b64_tr_b16 a[224:225], v215 offset:3200
    v_mfma_f32_16x16x32_bf16 v[156:159], a[204:207], a[92:95], v[156:159]
    ds_read_b64_tr_b16 a[226:227], v215 offset:3968
    v_mfma_f32_16x16x32_bf16 v[156:159], a[208:211], a[108:111], v[156:159]
    v_mfma_f32_16x16x32_bf16 v[156:159], a[212:215], a[124:127], v[156:159]
    v_mfma_f32_16x16x32_bf16 v[152:155], a[212:215], a[120:123], v[152:155]
    ds_read_b64_tr_b16 a[228:229], v215 offset:17536
    v_mfma_f32_16x16x32_bf16 v[152:155], a[208:211], a[104:107], v[152:155]
    ds_read_b64_tr_b16 a[230:231], v215 offset:18304
    v_mfma_f32_16x16x32_bf16 v[152:155], a[204:207], a[88:91], v[152:155]
    v_mfma_f32_16x16x32_bf16 v[152:155], a[200:203], a[72:75], v[152:155]
    v_mfma_f32_16x16x32_bf16 v[148:151], a[200:203], a[68:71], v[148:151]
    ds_read_b64_tr_b16 a[192:193], v216 offset:31872
    v_mfma_f32_16x16x32_bf16 v[148:151], a[204:207], a[84:87], v[148:151]
    ds_read_b64_tr_b16 a[194:195], v216 offset:32640
    v_mfma_f32_16x16x32_bf16 v[148:151], a[208:211], a[100:103], v[148:151]
    v_mfma_f32_16x16x32_bf16 v[148:151], a[212:215], a[116:119], v[148:151]
    v_mfma_f32_16x16x32_bf16 v[144:147], a[212:215], a[112:115], v[144:147]
    ds_read_b64_tr_b16 a[196:197], v216 offset:46208
    v_mfma_f32_16x16x32_bf16 v[144:147], a[208:211], a[96:99], v[144:147]
    ds_read_b64_tr_b16 a[198:199], v216 offset:46976
    v_mfma_f32_16x16x32_bf16 v[144:147], a[204:207], a[80:83], v[144:147]
    v_mfma_f32_16x16x32_bf16 v[144:147], a[200:203], a[64:67], v[144:147]
    s_waitcnt lgkmcnt(4)
    v_mfma_f32_16x16x32_bf16 v[160:163], a[216:219], a[0:3], v[160:163]
    ds_read_b64_tr_b16 a[200:201], v216 offset:3200
    v_mfma_f32_16x16x32_bf16 v[160:163], a[220:223], a[16:19], v[160:163]
    ds_read_b64_tr_b16 a[202:203], v216 offset:3968
    v_mfma_f32_16x16x32_bf16 v[160:163], a[224:227], a[32:35], v[160:163]
    v_mfma_f32_16x16x32_bf16 v[160:163], a[228:231], a[48:51], v[160:163]
    v_mfma_f32_16x16x32_bf16 v[164:167], a[228:231], a[52:55], v[164:167]
    ds_read_b64_tr_b16 a[204:205], v216 offset:17536
    v_mfma_f32_16x16x32_bf16 v[164:167], a[224:227], a[36:39], v[164:167]
    ds_read_b64_tr_b16 a[206:207], v216 offset:18304
    v_cvt_pk_bf16_f32 v96, v96, v97
    v_mfma_f32_16x16x32_bf16 v[164:167], a[220:223], a[20:23], v[164:167]
    v_cvt_pk_bf16_f32 v97, v98, v99
    v_pk_max_i16 v96, v96, 0
    v_mfma_f32_16x16x32_bf16 v[164:167], a[216:219], a[4:7], v[164:167]
    v_pk_max_i16 v97, v97, 0
    v_cvt_pk_bf16_f32 v98, v112, v113
    v_mfma_f32_16x16x32_bf16 v[168:171], a[216:219], a[8:11], v[168:171]
    ds_read_b64_tr_b16 a[208:209], v217 offset:34816
    v_cvt_pk_bf16_f32 v99, v114, v115
    v_mfma_f32_16x16x32_bf16 v[168:171], a[220:223], a[24:27], v[168:171]
    ds_read_b64_tr_b16 a[210:211], v217 offset:35072
    v_pk_max_i16 v98, v98, 0
    v_mfma_f32_16x16x32_bf16 v[168:171], a[224:227], a[40:43], v[168:171]
    v_pk_max_i16 v99, v99, 0
    v_mfma_f32_16x16x32_bf16 v[168:171], a[228:231], a[56:59], v[168:171]
    buffer_store_dwordx4 v[96:99], v208, s[36:39], s72 offen offset:0 sc1
    v_mfma_f32_16x16x32_bf16 v[172:175], a[228:231], a[60:63], v[172:175]
    ds_read_b64_tr_b16 a[212:213], v217 offset:49152
    v_mfma_f32_16x16x32_bf16 v[172:175], a[224:227], a[44:47], v[172:175]
    ds_read_b64_tr_b16 a[214:215], v217 offset:49408
    v_mfma_f32_16x16x32_bf16 v[172:175], a[220:223], a[28:31], v[172:175]
    v_mfma_f32_16x16x32_bf16 v[172:175], a[216:219], a[12:15], v[172:175]
    s_waitcnt lgkmcnt(4)
    v_mfma_f32_16x16x32_bf16 v[188:191], a[192:195], a[12:15], v[188:191]
    ds_read_b64_tr_b16 a[216:217], v217 offset:6144
    v_mfma_f32_16x16x32_bf16 v[188:191], a[196:199], a[28:31], v[188:191]
    ds_read_b64_tr_b16 a[218:219], v217 offset:6400
    v_mfma_f32_16x16x32_bf16 v[188:191], a[200:203], a[44:47], v[188:191]
    v_mfma_f32_16x16x32_bf16 v[188:191], a[204:207], a[60:63], v[188:191]
    v_mfma_f32_16x16x32_bf16 v[184:187], a[204:207], a[56:59], v[184:187]
    ds_read_b64_tr_b16 a[220:221], v217 offset:20480
    v_cvt_pk_bf16_f32 v100, v100, v101
    v_mfma_f32_16x16x32_bf16 v[184:187], a[200:203], a[40:43], v[184:187]
    ds_read_b64_tr_b16 a[222:223], v217 offset:20736
    v_cvt_pk_bf16_f32 v101, v102, v103
    v_mfma_f32_16x16x32_bf16 v[184:187], a[196:199], a[24:27], v[184:187]
    v_pk_max_i16 v100, v100, 0
    v_pk_max_i16 v101, v101, 0
    v_mfma_f32_16x16x32_bf16 v[184:187], a[192:195], a[8:11], v[184:187]
    v_cvt_pk_bf16_f32 v102, v116, v117
    v_cvt_pk_bf16_f32 v103, v118, v119
    v_mfma_f32_16x16x32_bf16 v[180:183], a[192:195], a[4:7], v[180:183]
    ds_read_b64_tr_b16 a[224:225], v215 offset:28672
    v_pk_max_i16 v102, v102, 0
    v_mfma_f32_16x16x32_bf16 v[180:183], a[196:199], a[20:23], v[180:183]
    ds_read_b64_tr_b16 a[226:227], v215 offset:29440
    v_pk_max_i16 v103, v103, 0
    v_mfma_f32_16x16x32_bf16 v[180:183], a[200:203], a[36:39], v[180:183]
    buffer_store_dwordx4 v[100:103], v208, s[36:39], s72 offen offset:1024 sc1
    v_mfma_f32_16x16x32_bf16 v[180:183], a[204:207], a[52:55], v[180:183]
    v_mfma_f32_16x16x32_bf16 v[176:179], a[204:207], a[48:51], v[176:179]
    ds_read_b64_tr_b16 a[228:229], v215 offset:43008
    v_mfma_f32_16x16x32_bf16 v[176:179], a[200:203], a[32:35], v[176:179]
    ds_read_b64_tr_b16 a[230:231], v215 offset:43776
    v_mfma_f32_16x16x32_bf16 v[176:179], a[196:199], a[16:19], v[176:179]
    v_mfma_f32_16x16x32_bf16 v[176:179], a[192:195], a[0:3], v[176:179]
    s_waitcnt lgkmcnt(4)
    v_mfma_f32_16x16x32_bf16 v[192:195], a[208:211], a[0:3], v[192:195]
    ds_read_b64_tr_b16 a[192:193], v215 offset:0
    v_mfma_f32_16x16x32_bf16 v[192:195], a[212:215], a[16:19], v[192:195]
    ds_read_b64_tr_b16 a[194:195], v215 offset:768
    v_mfma_f32_16x16x32_bf16 v[192:195], a[216:219], a[32:35], v[192:195]
    v_mfma_f32_16x16x32_bf16 v[192:195], a[220:223], a[48:51], v[192:195]
    v_cvt_pk_bf16_f32 v104, v104, v105
    v_cvt_pk_bf16_f32 v105, v106, v107
    v_mfma_f32_16x16x32_bf16 v[196:199], a[220:223], a[52:55], v[196:199]
    ds_read_b64_tr_b16 a[196:197], v215 offset:14336
    v_pk_max_i16 v104, v104, 0
    v_mfma_f32_16x16x32_bf16 v[196:199], a[216:219], a[36:39], v[196:199]
    ds_read_b64_tr_b16 a[198:199], v215 offset:15104
    v_pk_max_i16 v105, v105, 0
    v_mfma_f32_16x16x32_bf16 v[196:199], a[212:215], a[20:23], v[196:199]
    v_cvt_pk_bf16_f32 v106, v120, v121
    v_cvt_pk_bf16_f32 v107, v122, v123
    v_mfma_f32_16x16x32_bf16 v[196:199], a[208:211], a[4:7], v[196:199]
    v_pk_max_i16 v106, v106, 0
    v_pk_max_i16 v107, v107, 0
    buffer_load_dword v227, v230, s[36:39], s71 offen sc1
    v_mfma_f32_16x16x32_bf16 v[200:203], a[208:211], a[8:11], v[200:203]
    ds_read_b64_tr_b16 a[200:201], v216 offset:28672
    v_mfma_f32_16x16x32_bf16 v[200:203], a[212:215], a[24:27], v[200:203]
    ds_read_b64_tr_b16 a[202:203], v216 offset:29440
    v_mfma_f32_16x16x32_bf16 v[200:203], a[216:219], a[40:43], v[200:203]
    buffer_store_dwordx4 v[104:107], v208, s[36:39], s72 offen offset:2048 sc1
    v_mfma_f32_16x16x32_bf16 v[200:203], a[220:223], a[56:59], v[200:203]
    v_mfma_f32_16x16x32_bf16 v[204:207], a[220:223], a[60:63], v[204:207]
    ds_read_b64_tr_b16 a[204:205], v216 offset:43008
    v_mfma_f32_16x16x32_bf16 v[204:207], a[216:219], a[44:47], v[204:207]
    ds_read_b64_tr_b16 a[206:207], v216 offset:43776
    v_mfma_f32_16x16x32_bf16 v[204:207], a[212:215], a[28:31], v[204:207]
    v_mfma_f32_16x16x32_bf16 v[204:207], a[208:211], a[12:15], v[204:207]
    s_waitcnt lgkmcnt(4)
    v_mfma_f32_16x16x32_bf16 v[12:15], a[224:227], a[12:15], v[12:15]
    ds_read_b64_tr_b16 a[208:209], v216 offset:0
    v_mfma_f32_16x16x32_bf16 v[12:15], a[228:231], a[28:31], v[12:15]
    ds_read_b64_tr_b16 a[210:211], v216 offset:768
    v_mfma_f32_16x16x32_bf16 v[12:15], a[192:195], a[44:47], v[12:15]
    v_mfma_f32_16x16x32_bf16 v[12:15], a[196:199], a[60:63], v[12:15]
    v_cvt_pk_bf16_f32 v108, v108, v109
    v_cvt_pk_bf16_f32 v109, v110, v111
    v_mfma_f32_16x16x32_bf16 v[8:11], a[196:199], a[56:59], v[8:11]
    ds_read_b64_tr_b16 a[212:213], v216 offset:14336
    v_pk_max_i16 v108, v108, 0
    v_mfma_f32_16x16x32_bf16 v[8:11], a[192:195], a[40:43], v[8:11]
    ds_read_b64_tr_b16 a[214:215], v216 offset:15104
    v_pk_max_i16 v109, v109, 0
    v_mfma_f32_16x16x32_bf16 v[8:11], a[228:231], a[24:27], v[8:11]
    v_cvt_pk_bf16_f32 v110, v124, v125
    v_cvt_pk_bf16_f32 v111, v126, v127
    v_mfma_f32_16x16x32_bf16 v[8:11], a[224:227], a[8:11], v[8:11]
    v_pk_max_i16 v110, v110, 0
    v_pk_max_i16 v111, v111, 0
    v_mfma_f32_16x16x32_bf16 v[4:7], a[224:227], a[4:7], v[4:7]
    ds_read_b64_tr_b16 a[216:217], v212 offset:31872
    v_mfma_f32_16x16x32_bf16 v[4:7], a[228:231], a[20:23], v[4:7]
    ds_read_b64_tr_b16 a[218:219], v212 offset:32640
    v_mfma_f32_16x16x32_bf16 v[4:7], a[192:195], a[36:39], v[4:7]
    buffer_store_dwordx4 v[108:111], v208, s[36:39], s72 offen offset:3072 sc1
    v_mfma_f32_16x16x32_bf16 v[4:7], a[196:199], a[52:55], v[4:7]
    v_mfma_f32_16x16x32_bf16 v[0:3], a[196:199], a[48:51], v[0:3]
    ds_read_b64_tr_b16 a[220:221], v212 offset:46208
    v_mfma_f32_16x16x32_bf16 v[0:3], a[192:195], a[32:35], v[0:3]
    ds_read_b64_tr_b16 a[222:223], v212 offset:46976
    v_mfma_f32_16x16x32_bf16 v[0:3], a[228:231], a[16:19], v[0:3]
    v_mfma_f32_16x16x32_bf16 v[0:3], a[224:227], a[0:3], v[0:3]
    s_waitcnt lgkmcnt(4)
    v_mfma_f32_16x16x32_bf16 v[16:19], a[200:203], a[0:3], v[16:19]
    ds_read_b64_tr_b16 a[224:225], v212 offset:3200
    v_mfma_f32_16x16x32_bf16 v[16:19], a[204:207], a[16:19], v[16:19]
    ds_read_b64_tr_b16 a[226:227], v212 offset:3968
    v_mfma_f32_16x16x32_bf16 v[16:19], a[208:211], a[32:35], v[16:19]
    v_mfma_f32_16x16x32_bf16 v[16:19], a[212:215], a[48:51], v[16:19]
    v_cvt_pk_bf16_f32 v128, v128, v129
    v_cvt_pk_bf16_f32 v129, v130, v131
    v_mfma_f32_16x16x32_bf16 v[20:23], a[212:215], a[52:55], v[20:23]
    ds_read_b64_tr_b16 a[228:229], v212 offset:17536
    v_pk_max_i16 v128, v128, 0
    v_mfma_f32_16x16x32_bf16 v[20:23], a[208:211], a[36:39], v[20:23]
    ds_read_b64_tr_b16 a[230:231], v212 offset:18304
    v_pk_max_i16 v129, v129, 0
    v_mfma_f32_16x16x32_bf16 v[20:23], a[204:207], a[20:23], v[20:23]
    v_cvt_pk_bf16_f32 v130, v144, v145
    v_cvt_pk_bf16_f32 v131, v146, v147
    v_mfma_f32_16x16x32_bf16 v[20:23], a[200:203], a[4:7], v[20:23]
    v_pk_max_i16 v130, v130, 0
    v_pk_max_i16 v131, v131, 0
    s_waitcnt vmcnt(2)
    s_cmp_eq_u32 s41, 0
    s_cbranch_scc1 F_ok_26
    s_mov_b32 s83, 0x40000
F_sp_25:
    v_cmp_ne_u32 vcc, 0, v227
    s_and_b32 s53, vcc_lo, 0x8
    s_cmp_eq_u32 s53, 0x8
    s_cbranch_scc1 F_ok_26
    buffer_load_dword v227, v230, s[36:39], s71 offen sc1
    s_sub_u32 s83, s83, 1
    s_waitcnt vmcnt(0)
    s_cbranch_scc0 F_sp_25
F_ok_26:
    v_mfma_f32_16x16x32_bf16 v[24:27], a[200:203], a[8:11], v[24:27]
    ds_read_b64_tr_b16 a[192:193], v213 offset:31872
    v_mfma_f32_16x16x32_bf16 v[24:27], a[204:207], a[24:27], v[24:27]
    ds_read_b64_tr_b16 a[194:195], v213 offset:32640
    v_mfma_f32_16x16x32_bf16 v[24:27], a[208:211], a[40:43], v[24:27]
    buffer_load_dwordx4 v[48:51], v208, s[36:39], s68 offen offset:0 sc1
    v_mfma_f32_16x16x32_bf16 v[24:27], a[212:215], a[56:59], v[24:27]
    buffer_load_dwordx4 v[52:55], v208, s[36:39], s68 offen offset:1024 sc1
    s_barrier
    v_mfma_f32_16x16x32_bf16 v[28:31], a[212:215], a[60:63], v[28:31]
    ds_read_b64_tr_b16 a[196:197], v213 offset:46208
    v_mfma_f32_16x16x32_bf16 v[28:31], a[208:211], a[44:47], v[28:31]
    ds_read_b64_tr_b16 a[198:199], v213 offset:46976
    v_mfma_f32_16x16x32_bf16 v[28:31], a[204:207], a[28:31], v[28:31]
    buffer_load_dwordx4 v[56:59], v208, s[36:39], s68 offen offset:2048 sc1
    v_mfma_f32_16x16x32_bf16 v[28:31], a[200:203], a[12:15], v[28:31]
    s_waitcnt lgkmcnt(4)
    buffer_load_dwordx4 v[60:63], v208, s[36:39], s68 offen offset:3072 sc1
    v_mfma_f32_16x16x32_bf16 v[172:175], a[216:219], a[76:79], v[172:175]
    ds_read_b64_tr_b16 a[200:201], v213 offset:3200
    v_mfma_f32_16x16x32_bf16 v[172:175], a[220:223], a[92:95], v[172:175]
    ds_read_b64_tr_b16 a[202:203], v213 offset:3968
    v_mfma_f32_16x16x32_bf16 v[172:175], a[224:227], a[108:111], v[172:175]
    buffer_load_dwordx4 v[68:71], v208, s[36:39], s69 offen offset:0 sc1
    v_mfma_f32_16x16x32_bf16 v[172:175], a[228:231], a[124:127], v[172:175]
    buffer_load_dwordx4 v[84:87], v208, s[36:39], s69 offen offset:1024 sc1
    v_mfma_f32_16x16x32_bf16 v[168:171], a[228:231], a[120:123], v[168:171]
    ds_read_b64_tr_b16 a[204:205], v213 offset:17536
    v_mfma_f32_16x16x32_bf16 v[168:171], a[224:227], a[104:107], v[168:171]
    ds_read_b64_tr_b16 a[206:207], v213 offset:18304
    v_mfma_f32_16x16x32_bf16 v[168:171], a[220:223], a[88:91], v[168:171]
    buffer_load_dwordx4 v[76:79], v208, s[36:39], s69 offen offset:2048 sc1
    v_mfma_f32_16x16x32_bf16 v[168:171], a[216:219], a[72:75], v[168:171]
    buffer_load_dwordx4 v[92:95], v208, s[36:39], s69 offen offset:3072 sc1
    v_mfma_f32_16x16x32_bf16 v[164:167], a[216:219], a[68:71], v[164:167]
    ds_read_b64_tr_b16 a[208:209], v214 offset:34816
    v_mfma_f32_16x16x32_bf16 v[164:167], a[220:223], a[84:87], v[164:167]
    ds_read_b64_tr_b16 a[210:211], v214 offset:35072
    v_mfma_f32_16x16x32_bf16 v[164:167], a[224:227], a[100:103], v[164:167]
    buffer_store_dwordx4 v[128:131], v208, s[36:39], s73 offen offset:0 sc1
    v_mfma_f32_16x16x32_bf16 v[164:167], a[228:231], a[116:119], v[164:167]
    v_mfma_f32_16x16x32_bf16 v[160:163], a[228:231], a[112:115], v[160:163]
    ds_read_b64_tr_b16 a[212:213], v214 offset:49152
    v_mfma_f32_16x16x32_bf16 v[160:163], a[224:227], a[96:99], v[160:163]
    ds_read_b64_tr_b16 a[214:215], v214 offset:49408
    v_mfma_f32_16x16x32_bf16 v[160:163], a[220:223], a[80:83], v[160:163]
    v_mfma_f32_16x16x32_bf16 v[160:163], a[216:219], a[64:67], v[160:163]
    s_waitcnt lgkmcnt(4)
    v_mfma_f32_16x16x32_bf16 v[176:179], a[192:195], a[64:67], v[176:179]
    ds_read_b64_tr_b16 a[216:217], v214 offset:6144
    v_mfma_f32_16x16x32_bf16 v[176:179], a[196:199], a[80:83], v[176:179]
    ds_read_b64_tr_b16 a[218:219], v214 offset:6400
    v_mfma_f32_16x16x32_bf16 v[176:179], a[200:203], a[96:99], v[176:179]
    v_mfma_f32_16x16x32_bf16 v[176:179], a[204:207], a[112:115], v[176:179]
    v_cvt_pk_bf16_f32 v132, v132, v133
    v_cvt_pk_bf16_f32 v133, v134, v135
    v_mfma_f32_16x16x32_bf16 v[180:183], a[204:207], a[116:119], v[180:183]
    ds_read_b64_tr_b16 a[220:221], v214 offset:20480
    v_pk_max_i16 v132, v132, 0
    v_mfma_f32_16x16x32_bf16 v[180:183], a[200:203], a[100:103], v[180:183]
    ds_read_b64_tr_b16 a[222:223], v214 offset:20736
    v_pk_max_i16 v133, v133, 0
    v_mfma_f32_16x16x32_bf16 v[180:183], a[196:199], a[84:87], v[180:183]
    v_cvt_pk_bf16_f32 v134, v148, v149
    v_cvt_pk_bf16_f32 v135, v150, v151
    v_mfma_f32_16x16x32_bf16 v[180:183], a[192:195], a[68:71], v[180:183]
    v_pk_max_i16 v134, v134, 0
    v_pk_max_i16 v135, v135, 0
    v_mfma_f32_16x16x32_bf16 v[184:187], a[192:195], a[72:75], v[184:187]
    ds_read_b64_tr_b16 a[224:225], v212 offset:28672
    v_mfma_f32_16x16x32_bf16 v[184:187], a[196:199], a[88:91], v[184:187]
    ds_read_b64_tr_b16 a[226:227], v212 offset:29440
    v_mfma_f32_16x16x32_bf16 v[184:187], a[200:203], a[104:107], v[184:187]
    buffer_store_dwordx4 v[132:135], v208, s[36:39], s73 offen offset:1024 sc1
    v_mfma_f32_16x16x32_bf16 v[184:187], a[204:207], a[120:123], v[184:187]
    v_mfma_f32_16x16x32_bf16 v[188:191], a[204:207], a[124:127], v[188:191]
    ds_read_b64_tr_b16 a[228:229], v212 offset:43008
    v_mfma_f32_16x16x32_bf16 v[188:191], a[200:203], a[108:111], v[188:191]
    ds_read_b64_tr_b16 a[230:231], v212 offset:43776
    v_mfma_f32_16x16x32_bf16 v[188:191], a[196:199], a[92:95], v[188:191]
    v_mfma_f32_16x16x32_bf16 v[188:191], a[192:195], a[76:79], v[188:191]
    s_waitcnt lgkmcnt(4)
    v_mfma_f32_16x16x32_bf16 v[204:207], a[208:211], a[76:79], v[204:207]
    ds_read_b64_tr_b16 a[192:193], v212 offset:0
    v_mfma_f32_16x16x32_bf16 v[204:207], a[212:215], a[92:95], v[204:207]
    ds_read_b64_tr_b16 a[194:195], v212 offset:768
    v_mfma_f32_16x16x32_bf16 v[204:207], a[216:219], a[108:111], v[204:207]
    v_mfma_f32_16x16x32_bf16 v[204:207], a[220:223], a[124:127], v[204:207]
    v_cvt_pk_bf16_f32 v136, v136, v137
    v_cvt_pk_bf16_f32 v137, v138, v139
    v_mfma_f32_16x16x32_bf16 v[200:203], a[220:223], a[120:123], v[200:203]
    ds_read_b64_tr_b16 a[196:197], v212 offset:14336
    v_pk_max_i16 v136, v136, 0
    v_mfma_f32_16x16x32_bf16 v[200:203], a[216:219], a[104:107], v[200:203]
    ds_read_b64_tr_b16 a[198:199], v212 offset:15104
    v_pk_max_i16 v137, v137, 0
    v_mfma_f32_16x16x32_bf16 v[200:203], a[212:215], a[88:91], v[200:203]
    v_cvt_pk_bf16_f32 v138, v152, v153
    v_cvt_pk_bf16_f32 v139, v154, v155
    v_mfma_f32_16x16x32_bf16 v[200:203], a[208:211], a[72:75], v[200:203]
    v_pk_max_i16 v138, v138, 0
    v_pk_max_i16 v139, v139, 0
    v_mfma_f32_16x16x32_bf16 v[196:199], a[208:211], a[68:71], v[196:199]
    ds_read_b64_tr_b16 a[200:201], v213 offset:28672
    v_mfma_f32_16x16x32_bf16 v[196:199], a[212:215], a[84:87], v[196:199]
    ds_read_b64_tr_b16 a[202:203], v213 offset:29440
    v_mfma_f32_16x16x32_bf16 v[196:199], a[216:219], a[100:103], v[196:199]
    buffer_store_dwordx4 v[136:139], v208, s[36:39], s73 offen offset:2048 sc1
    v_mfma_f32_16x16x32_bf16 v[196:199], a[220:223], a[116:119], v[196:199]
    v_mfma_f32_16x16x32_bf16 v[192:195], a[220:223], a[112:115], v[192:195]
    ds_read_b64_tr_b16 a[204:205], v213 offset:43008
    v_mfma_f32_16x16x32_bf16 v[192:195], a[216:219], a[96:99], v[192:195]
    ds_read_b64_tr_b16 a[206:207], v213 offset:43776
    v_mfma_f32_16x16x32_bf16 v[192:195], a[212:215], a[80:83], v[192:195]
    v_mfma_f32_16x16x32_bf16 v[192:195], a[208:211], a[64:67], v[192:195]
    s_waitcnt lgkmcnt(4)
    v_mfma_f32_16x16x32_bf16 v[0:3], a[224:227], a[64:67], v[0:3]
    ds_read_b64_tr_b16 a[208:209], v213 offset:0
    v_mfma_f32_16x16x32_bf16 v[0:3], a[228:231], a[80:83], v[0:3]
    ds_read_b64_tr_b16 a[210:211], v213 offset:768
    v_mfma_f32_16x16x32_bf16 v[0:3], a[192:195], a[96:99], v[0:3]
    v_mfma_f32_16x16x32_bf16 v[0:3], a[196:199], a[112:115], v[0:3]
    v_cvt_pk_bf16_f32 v140, v140, v141
    v_cvt_pk_bf16_f32 v141, v142, v143
    v_mfma_f32_16x16x32_bf16 v[4:7], a[196:199], a[116:119], v[4:7]
    ds_read_b64_tr_b16 a[212:213], v213 offset:14336
    v_mfma_f32_16x16x32_bf16 v[4:7], a[192:195], a[100:103], v[4:7]
    ds_read_b64_tr_b16 a[214:215], v213 offset:15104
    v_mfma_f32_16x16x32_bf16 v[4:7], a[228:231], a[84:87], v[4:7]
    s_waitcnt vmcnt(10)
    ds_write_b128 v228, v[48:51] offset:0
    v_mfma_f32_16x16x32_bf16 v[4:7], a[224:227], a[68:71], v[4:7]
    v_mfma_f32_16x16x32_bf16 v[8:11], a[224:227], a[72:75], v[8:11]
    s_waitcnt vmcnt(9)
    ds_write_b128 v228, v[52:55] offset:1024
    v_mfma_f32_16x16x32_bf16 v[8:11], a[228:231], a[88:91], v[8:11]
    v_mfma_f32_16x16x32_bf16 v[8:11], a[192:195], a[104:107], v[8:11]
    s_waitcnt vmcnt(8)
    ds_write_b128 v228, v[56:59] offset:2048
    v_mfma_f32_16x16x32_bf16 v[8:11], a[196:199], a[120:123], v[8:11]
    v_mfma_f32_16x16x32_bf16 v[12:15], a[196:199], a[124:127], v[12:15]
    s_waitcnt vmcnt(7)
    ds_write_b128 v228, v[60:63] offset:3072
    v_mfma_f32_16x16x32_bf16 v[12:15], a[192:195], a[108:111], v[12:15]
    v_mfma_f32_16x16x32_bf16 v[12:15], a[228:231], a[92:95], v[12:15]
    s_waitcnt vmcnt(6)
    ds_write_b128 v228, v[68:71] offset:32768
    v_mfma_f32_16x16x32_bf16 v[12:15], a[224:227], a[76:79], v[12:15]
    s_waitcnt lgkmcnt(5)
    v_mfma_f32_16x16x32_bf16 v[28:31], a[200:203], a[76:79], v[28:31]
    s_waitcnt vmcnt(5)
    ds_write_b128 v228, v[84:87] offset:33792
    v_mfma_f32_16x16x32_bf16 v[28:31], a[204:207], a[92:95], v[28:31]
    v_mfma_f32_16x16x32_bf16 v[28:31], a[208:211], a[108:111], v[28:31]
    s_waitcnt vmcnt(4)
    ds_write_b128 v228, v[76:79] offset:34816
    v_mfma_f32_16x16x32_bf16 v[28:31], a[212:215], a[124:127], v[28:31]
    v_mfma_f32_16x16x32_bf16 v[24:27], a[212:215], a[120:123], v[24:27]
    s_waitcnt vmcnt(3)
    ds_write_b128 v228, v[92:95] offset:35840
    v_mfma_f32_16x16x32_bf16 v[24:27], a[208:211], a[104:107], v[24:27]
    v_mfma_f32_16x16x32_bf16 v[24:27], a[204:207], a[88:91], v[24:27]
    v_pk_max_i16 v140, v140, 0
    v_pk_max_i16 v141, v141, 0
    v_mfma_f32_16x16x32_bf16 v[24:27], a[200:203], a[72:75], v[24:27]
    v_cvt_pk_bf16_f32 v142, v156, v157
    v_cvt_pk_bf16_f32 v143, v158, v159
    v_mfma_f32_16x16x32_bf16 v[20:23], a[200:203], a[68:71], v[20:23]
    v_pk_max_i16 v142, v142, 0
    v_pk_max_i16 v143, v143, 0
    v_mfma_f32_16x16x32_bf16 v[20:23], a[204:207], a[84:87], v[20:23]
    buffer_store_dwordx4 v[140:143], v208, s[36:39], s73 offen offset:3072 sc1
    v_mfma_f32_16x16x32_bf16 v[20:23], a[208:211], a[100:103], v[20:23]
    v_mfma_f32_16x16x32_bf16 v[20:23], a[212:215], a[116:119], v[20:23]
    v_mfma_f32_16x16x32_bf16 v[16:19], a[212:215], a[112:115], v[16:19]
    v_mfma_f32_16x16x32_bf16 v[16:19], a[208:211], a[96:99], v[16:19]
    v_mfma_f32_16x16x32_bf16 v[16:19], a[204:207], a[80:83], v[16:19]
    v_mfma_f32_16x16x32_bf16 v[16:19], a[200:203], a[64:67], v[16:19]
    s_waitcnt lgkmcnt(0)
    s_barrier
    ds_read_b128 a[0:3], v228 offset:0
    v_cvt_pk_bf16_f32 v160, v160, v161
    ds_read_b128 a[4:7], v228 offset:1024
    v_cvt_pk_bf16_f32 v161, v162, v163
    ds_read_b128 a[8:11], v228 offset:2048
    v_pk_max_i16 v160, v160, 0
    ds_read_b128 a[12:15], v228 offset:3072
    v_pk_max_i16 v161, v161, 0
    ds_read_b128 a[16:19], v228 offset:4096
    v_cvt_pk_bf16_f32 v162, v176, v177
    ds_read_b128 a[20:23], v228 offset:5120
    v_cvt_pk_bf16_f32 v163, v178, v179
    ds_read_b128 a[24:27], v228 offset:6144
    v_pk_max_i16 v162, v162, 0
    ds_read_b128 a[28:31], v228 offset:7168
    v_pk_max_i16 v163, v163, 0
    ds_read_b128 a[32:35], v228 offset:8192
    v_cvt_pk_bf16_f32 v164, v164, v165
    ds_read_b128 a[36:39], v228 offset:9216
    v_cvt_pk_bf16_f32 v165, v166, v167
    ds_read_b128 a[40:43], v228 offset:10240
    v_pk_max_i16 v164, v164, 0
    ds_read_b128 a[44:47], v228 offset:11264
    v_pk_max_i16 v165, v165, 0
    ds_read_b128 a[48:51], v228 offset:12288
    v_cvt_pk_bf16_f32 v166, v180, v181
    ds_read_b128 a[52:55], v228 offset:13312
    v_cvt_pk_bf16_f32 v167, v182, v183
    ds_read_b128 a[56:59], v228 offset:14336
    v_pk_max_i16 v166, v166, 0
    ds_read_b128 a[60:63], v228 offset:15360
    v_pk_max_i16 v167, v167, 0
    ds_read_b128 a[64:67], v228 offset:16384
    v_cvt_pk_bf16_f32 v168, v168, v169
    ds_read_b128 a[68:71], v228 offset:17408
    v_cvt_pk_bf16_f32 v169, v170, v171
    ds_read_b128 a[72:75], v228 offset:18432
    v_pk_max_i16 v168, v168, 0
    ds_read_b128 a[76:79], v228 offset:19456
    v_pk_max_i16 v169, v169, 0
    v_pk_mul_f32 v[0:1], v[0:1], s[76:77] op_sel_hi:[1,0]
    v_pk_mul_f32 v[2:3], v[2:3], s[76:77] op_sel_hi:[1,0]
    v_pk_mul_f32 v[16:17], v[16:17], s[76:77] op_sel_hi:[1,0]
    v_pk_mul_f32 v[18:19], v[18:19], s[76:77] op_sel_hi:[1,0]
    v_cvt_pk_bf16_f32 v0, v0, v1
    v_cvt_pk_bf16_f32 v1, v2, v3
    v_cvt_pk_bf16_f32 v2, v16, v17
    v_cvt_pk_bf16_f32 v3, v18, v19
    v_pk_mul_f32 v[4:5], v[4:5], s[76:77] op_sel_hi:[1,0]
    v_pk_mul_f32 v[6:7], v[6:7], s[76:77] op_sel_hi:[1,0]
    v_pk_mul_f32 v[20:21], v[20:21], s[76:77] op_sel_hi:[1,0]
    v_pk_mul_f32 v[22:23], v[22:23], s[76:77] op_sel_hi:[1,0]
    v_pk_mul_f32 v[8:9], v[8:9], s[76:77] op_sel_hi:[1,0]
    v_pk_mul_f32 v[10:11], v[10:11], s[76:77] op_sel_hi:[1,0]
    v_pk_mul_f32 v[24:25], v[24:25], s[76:77] op_sel_hi:[1,0]
    v_pk_mul_f32 v[26:27], v[26:27], s[76:77] op_sel_hi:[1,0]
    v_pk_mul_f32 v[12:13], v[12:13], s[76:77] op_sel_hi:[1,0]
    v_pk_mul_f32 v[14:15], v[14:15], s[76:77] op_sel_hi:[1,0]
    v_pk_mul_f32 v[28:29], v[28:29], s[76:77] op_sel_hi:[1,0]
    v_pk_mul_f32 v[30:31], v[30:31], s[76:77] op_sel_hi:[1,0]
    buffer_store_dwordx4 v[160:163], v208, s[36:39], s74 offen offset:0 sc1
    s_waitcnt lgkmcnt(15)
    v_mfma_f32_16x16x32_bf16 v[32:35], a[0:3], v[0:3], v[232:235]
    ds_read_b128 a[80:83], v228 offset:32768
    v_cvt_pk_bf16_f32 v170, v184, v185
    v_mfma_f32_16x16x32_bf16 v[36:39], a[4:7], v[0:3], v[232:235]
    ds_read_b128 a[84:87], v228 offset:33792
    v_cvt_pk_bf16_f32 v171, v186, v187
    v_mfma_f32_16x16x32_bf16 v[40:43], a[8:11], v[0:3], v[232:235]
    ds_read_b128 a[88:91], v228 offset:34816
    v_pk_max_i16 v170, v170, 0
    v_mfma_f32_16x16x32_bf16 v[44:47], a[12:15], v[0:3], v[232:235]
    ds_read_b128 a[92:95], v228 offset:35840
    v_pk_max_i16 v171, v171, 0
    v_mfma_f32_16x16x32_bf16 v[48:51], a[16:19], v[0:3], v[236:239]
    ds_read_b128 a[96:99], v228 offset:36864
    v_cvt_pk_bf16_f32 v172, v172, v173
    s_waitcnt lgkmcnt(15)
    v_mfma_f32_16x16x32_bf16 v[52:55], a[20:23], v[0:3], v[236:239]
    ds_read_b128 a[100:103], v228 offset:37888
    v_cvt_pk_bf16_f32 v173, v174, v175
    v_mfma_f32_16x16x32_bf16 v[56:59], a[24:27], v[0:3], v[236:239]
    ds_read_b128 a[104:107], v228 offset:38912
    v_pk_max_i16 v172, v172, 0
    v_mfma_f32_16x16x32_bf16 v[60:63], a[28:31], v[0:3], v[236:239]
    ds_read_b128 a[108:111], v228 offset:39936
    v_pk_max_i16 v173, v173, 0
    v_mfma_f32_16x16x32_bf16 v[64:67], a[32:35], v[0:3], v[240:243]
    ds_read_b128 a[112:115], v228 offset:40960
    v_cvt_pk_bf16_f32 v174, v188, v189
    v_mfma_f32_16x16x32_bf16 v[68:71], a[36:39], v[0:3], v[240:243]
    ds_read_b128 a[116:119], v228 offset:41984
    v_cvt_pk_bf16_f32 v175, v190, v191
    s_waitcnt lgkmcnt(15)
    v_mfma_f32_16x16x32_bf16 v[72:75], a[40:43], v[0:3], v[240:243]
    ds_read_b128 a[120:123], v228 offset:43008
    v_pk_max_i16 v174, v174, 0
    v_mfma_f32_16x16x32_bf16 v[76:79], a[44:47], v[0:3], v[240:243]
    ds_read_b128 a[124:127], v228 offset:44032
    v_pk_max_i16 v175, v175, 0
    v_mfma_f32_16x16x32_bf16 v[80:83], a[48:51], v[0:3], v[244:247]
    ds_read_b128 a[128:131], v228 offset:45056
    v_cvt_pk_bf16_f32 v4, v4, v5
    v_mfma_f32_16x16x32_bf16 v[84:87], a[52:55], v[0:3], v[244:247]
    ds_read_b128 a[132:135], v228 offset:46080
    v_cvt_pk_bf16_f32 v5, v6, v7
    v_mfma_f32_16x16x32_bf16 v[88:91], a[56:59], v[0:3], v[244:247]
    ds_read_b128 a[136:139], v228 offset:47104
    v_cvt_pk_bf16_f32 v6, v20, v21
    s_waitcnt lgkmcnt(15)
    v_mfma_f32_16x16x32_bf16 v[92:95], a[60:63], v[0:3], v[244:247]
    ds_read_b128 a[140:143], v228 offset:48128
    v_cvt_pk_bf16_f32 v7, v22, v23
    v_mfma_f32_16x16x32_bf16 v[112:115], a[64:67], v[0:3], 0
    ds_read_b128 a[144:147], v228 offset:49152
    v_cvt_pk_bf16_f32 v8, v8, v9
    ds_read_b128 a[148:151], v228 offset:50176
    v_cvt_pk_bf16_f32 v9, v10, v11
    ds_read_b128 a[152:155], v228 offset:51200
    v_cvt_pk_bf16_f32 v10, v24, v25
    ds_read_b128 a[156:159], v228 offset:52224
    v_cvt_pk_bf16_f32 v11, v26, v27
    buffer_store_dwordx4 v[164:167], v208, s[36:39], s74 offen offset:1024 sc1
    v_cvt_pk_bf16_f32 v12, v12, v13
    v_cvt_pk_bf16_f32 v13, v14, v15
    v_cvt_pk_bf16_f32 v14, v28, v29
    v_cvt_pk_bf16_f32 v15, v30, v31
    v_cvt_pk_bf16_f32 v192, v192, v193
    v_cvt_pk_bf16_f32 v193, v194, v195
    v_pk_max_i16 v192, v192, 0
    v_pk_max_i16 v193, v193, 0
    v_cvt_pk_bf16_f32 v194, v196, v197
    v_cvt_pk_bf16_f32 v195, v198, v199
    v_pk_max_i16 v194, v194, 0
    v_pk_max_i16 v195, v195, 0
    v_cvt_pk_bf16_f32 v200, v200, v201
    v_cvt_pk_bf16_f32 v201, v202, v203
    v_pk_max_i16 v200, v200, 0
    v_pk_max_i16 v201, v201, 0
    v_cvt_pk_bf16_f32 v202, v204, v205
    v_cvt_pk_bf16_f32 v203, v206, v207
    v_pk_max_i16 v202, v202, 0
    v_pk_max_i16 v203, v203, 0
    v_cndmask_b32 v32, v32, v112, s[58:59]
    v_cndmask_b32 v33, v33, v113, s[60:61]
    v_cndmask_b32 v34, v34, v114, s[62:63]
    v_cndmask_b32 v35, v35, v115, s[64:65]
    v_max3_f32 v252, v36, v37, v38
    v_max3_f32 v253, v39, v40, v41
    v_max3_f32 v252, v252, v42, v43
    v_max3_f32 v253, v253, v44, v45
    v_max3_f32 v252, v252, v46, v47
    v_max3_f32 v253, v253, v48, v49
    v_max3_f32 v252, v252, v50, v51
    v_max3_f32 v253, v253, v52, v53
    v_max3_f32 v252, v252, v54, v55
    v_max3_f32 v253, v253, v56, v57
    v_max3_f32 v252, v252, v58, v59
    v_max3_f32 v253, v253, v60, v61
    v_max3_f32 v252, v252, v62, v63
    v_max3_f32 v253, v253, v64, v65
    v_max3_f32 v252, v252, v66, v67
    v_max3_f32 v253, v253, v68, v69
    v_max3_f32 v252, v252, v70, v71
    v_max3_f32 v253, v253, v72, v73
    v_max3_f32 v252, v252, v74, v75
    v_max3_f32 v253, v253, v76, v77
    v_max3_f32 v252, v252, v78, v79
    v_max3_f32 v253, v253, v80, v81
    v_max3_f32 v252, v252, v82, v83
    v_max3_f32 v253, v253, v84, v85
    v_max3_f32 v252, v252, v86, v87
    v_max3_f32 v253, v253, v88, v89
    s_waitcnt lgkmcnt(0)
    s_barrier
    v_max3_f32 v252, v252, v90, v91
    v_max3_f32 v253, v253, v92, v93
    v_max3_f32 v252, v252, v94, v95
    v_max3_f32 v253, v253, v32, v33
    v_max3_f32 v252, v252, v34, v35
    v_max_f32 v252, v252, v253
    v_mov_b32 v253, v252
    s_nop 1
    v_permlane16_swap_b32 v252, v253
    v_max_f32 v252, v252, v253
    v_mov_b32 v253, v252
    v_mov_b32 v114, 0
    v_mov_b32 v115, 0
    v_permlane32_swap_b32 v252, v253
    v_max_f32 v252, v252, v253
    v_pk_add_f32 v[32:33], v[32:33], v[252:253] op_sel_hi:[1,0] neg_lo:[0,1] neg_hi:[0,1]
    v_pk_add_f32 v[34:35], v[34:35], v[252:253] op_sel_hi:[1,0] neg_lo:[0,1] neg_hi:[0,1]
    v_exp_f32 v32, v32
    v_mfma_f32_16x16x32_bf16 v[116:119], a[4:7], v[4:7], v[232:235]
    s_add_u32 m0, s50, 1024
    v_exp_f32 v33, v33
    v_exp_f32 v34, v34
    v_exp_f32 v35, v35
    buffer_store_dwordx4 v[168:171], v208, s[36:39], s74 offen offset:2048 sc1
    v_pk_add_f32 v[36:37], v[36:37], v[252:253] op_sel_hi:[1,0] neg_lo:[0,1] neg_hi:[0,1]
    v_pk_add_f32 v[38:39], v[38:39], v[252:253] op_sel_hi:[1,0] neg_lo:[0,1] neg_hi:[0,1]
    v_mfma_f32_16x16x32_bf16 v[120:123], a[8:11], v[4:7], v[232:235]
    v_exp_f32 v36, v36
    v_mfma_f32_16x16x32_bf16 v[124:127], a[12:15], v[4:7], v[232:235]
    v_exp_f32 v37, v37
    v_exp_f32 v38, v38
    v_exp_f32 v39, v39
    buffer_load_dwordx4 v209, s[28:31], s46 offen lds
    v_cvt_pk_bf16_f32 v32, v32, v33
    v_cvt_pk_bf16_f32 v33, v34, v35
    v_and_b32 v112, v254, v32
    v_and_b32 v113, v255, v33
    v_xor_b32 v32, v32, v112
    v_xor_b32 v33, v33, v113
    v_pk_add_f32 v[40:41], v[40:41], v[252:253] op_sel_hi:[1,0] neg_lo:[0,1] neg_hi:[0,1]
    v_pk_add_f32 v[42:43], v[42:43], v[252:253] op_sel_hi:[1,0] neg_lo:[0,1] neg_hi:[0,1]
    v_mfma_f32_16x16x32_bf16 v[144:147], a[16:19], v[4:7], v[236:239]
    v_exp_f32 v40, v40
    v_mfma_f32_16x16x32_bf16 v[148:151], a[20:23], v[4:7], v[236:239]
    v_exp_f32 v41, v41
    v_exp_f32 v42, v42
    v_exp_f32 v43, v43
    v_pk_add_f32 v[44:45], v[44:45], v[252:253] op_sel_hi:[1,0] neg_lo:[0,1] neg_hi:[0,1]
    v_pk_add_f32 v[46:47], v[46:47], v[252:253] op_sel_hi:[1,0] neg_lo:[0,1] neg_hi:[0,1]
    v_mfma_f32_16x16x32_bf16 v[152:155], a[24:27], v[4:7], v[236:239]
    v_exp_f32 v44, v44
    v_mfma_f32_16x16x32_bf16 v[156:159], a[28:31], v[4:7], v[236:239]
    v_exp_f32 v45, v45
    v_exp_f32 v46, v46
    v_exp_f32 v47, v47
    buffer_store_dwordx4 v[172:175], v208, s[36:39], s74 offen offset:3072 sc1
    v_cvt_pk_bf16_f32 v34, v36, v37
    v_cvt_pk_bf16_f32 v35, v38, v39
    v_pk_add_f32 v[48:49], v[48:49], v[252:253] op_sel_hi:[1,0] neg_lo:[0,1] neg_hi:[0,1]
    v_pk_add_f32 v[50:51], v[50:51], v[252:253] op_sel_hi:[1,0] neg_lo:[0,1] neg_hi:[0,1]
    v_mfma_f32_16x16x32_bf16 v[212:215], a[32:35], v[4:7], v[240:243]
    v_exp_f32 v48, v48
    v_mfma_f32_16x16x32_bf16 v[216:219], a[36:39], v[4:7], v[240:243]
    v_exp_f32 v49, v49
    v_exp_f32 v50, v50
    v_exp_f32 v51, v51
    buffer_load_dwordx4 v210, s[28:31], s46 offen offset:1024 lds
    v_pk_add_f32 v[52:53], v[52:53], v[252:253] op_sel_hi:[1,0] neg_lo:[0,1] neg_hi:[0,1]
    v_pk_add_f32 v[54:55], v[54:55], v[252:253] op_sel_hi:[1,0] neg_lo:[0,1] neg_hi:[0,1]
    v_mfma_f32_16x16x32_bf16 v[220:223], a[40:43], v[4:7], v[240:243]
    s_add_u32 s46, s46, 65536
    v_exp_f32 v52, v52
    v_mfma_f32_16x16x32_bf16 v[176:179], a[44:47], v[4:7], v[240:243]
    s_add_u32 m0, s50, 29696
    v_exp_f32 v53, v53
    v_exp_f32 v54, v54
    v_exp_f32 v55, v55
    v_cvt_pk_bf16_f32 v40, v40, v41
    v_cvt_pk_bf16_f32 v41, v42, v43
    v_cvt_pk_bf16_f32 v42, v44, v45
    v_cvt_pk_bf16_f32 v43, v46, v47
    v_pk_add_f32 v[56:57], v[56:57], v[252:253] op_sel_hi:[1,0] neg_lo:[0,1] neg_hi:[0,1]
    v_pk_add_f32 v[58:59], v[58:59], v[252:253] op_sel_hi:[1,0] neg_lo:[0,1] neg_hi:[0,1]
    v_mfma_f32_16x16x32_bf16 v[180:183], a[48:51], v[4:7], v[244:247]
    v_exp_f32 v56, v56
    v_mfma_f32_16x16x32_bf16 v[184:187], a[52:55], v[4:7], v[244:247]
    v_exp_f32 v57, v57
    v_exp_f32 v58, v58
    v_exp_f32 v59, v59
    buffer_load_dwordx4 v209, s[28:31], s46 offen lds
    v_pk_add_f32 v[60:61], v[60:61], v[252:253] op_sel_hi:[1,0] neg_lo:[0,1] neg_hi:[0,1]
    v_pk_add_f32 v[62:63], v[62:63], v[252:253] op_sel_hi:[1,0] neg_lo:[0,1] neg_hi:[0,1]
    v_mfma_f32_16x16x32_bf16 v[188:191], a[56:59], v[4:7], v[244:247]
    v_exp_f32 v60, v60
    v_mfma_f32_16x16x32_bf16 v[16:19], a[60:63], v[4:7], v[244:247]
    v_exp_f32 v61, v61
    v_exp_f32 v62, v62
    v_exp_f32 v63, v63
    v_cvt_pk_bf16_f32 v48, v48, v49
    v_cvt_pk_bf16_f32 v49, v50, v51
    v_cvt_pk_bf16_f32 v50, v52, v53
    v_cvt_pk_bf16_f32 v51, v54, v55
    v_pk_add_f32 v[64:65], v[64:65], v[252:253] op_sel_hi:[1,0] neg_lo:[0,1] neg_hi:[0,1]
    v_pk_add_f32 v[66:67], v[66:67], v[252:253] op_sel_hi:[1,0] neg_lo:[0,1] neg_hi:[0,1]
    v_mfma_f32_16x16x32_bf16 v[20:23], a[64:67], v[4:7], 0
    v_exp_f32 v64, v64
    v_mfma_f32_16x16x32_bf16 v[24:27], a[68:71], v[4:7], 0
    v_exp_f32 v65, v65
    v_exp_f32 v66, v66
    v_exp_f32 v67, v67
    buffer_load_dwordx4 v210, s[28:31], s46 offen offset:1024 lds
    v_pk_add_f32 v[68:69], v[68:69], v[252:253] op_sel_hi:[1,0] neg_lo:[0,1] neg_hi:[0,1]
    v_pk_add_f32 v[70:71], v[70:71], v[252:253] op_sel_hi:[1,0] neg_lo:[0,1] neg_hi:[0,1]
    v_exp_f32 v68, v68
    v_exp_f32 v69, v69
    v_exp_f32 v70, v70
    v_exp_f32 v71, v71
    v_cvt_pk_bf16_f32 v56, v56, v57
    v_cvt_pk_bf16_f32 v57, v58, v59
    v_cvt_pk_bf16_f32 v58, v60, v61
    v_cvt_pk_bf16_f32 v59, v62, v63
    v_pk_add_f32 v[72:73], v[72:73], v[252:253] op_sel_hi:[1,0] neg_lo:[0,1] neg_hi:[0,1]
    v_pk_add_f32 v[74:75], v[74:75], v[252:253] op_sel_hi:[1,0] neg_lo:[0,1] neg_hi:[0,1]
    v_exp_f32 v72, v72
    v_exp_f32 v73, v73
    v_exp_f32 v74, v74
    v_exp_f32 v75, v75
    v_pk_add_f32 v[76:77], v[76:77], v[252:253] op_sel_hi:[1,0] neg_lo:[0,1] neg_hi:[0,1]
    v_pk_add_f32 v[78:79], v[78:79], v[252:253] op_sel_hi:[1,0] neg_lo:[0,1] neg_hi:[0,1]
    v_exp_f32 v76, v76
    v_exp_f32 v77, v77
    v_exp_f32 v78, v78
    v_exp_f32 v79, v79
    v_cvt_pk_bf16_f32 v64, v64, v65
    v_cvt_pk_bf16_f32 v65, v66, v67
    v_cvt_pk_bf16_f32 v66, v68, v69
    v_cvt_pk_bf16_f32 v67, v70, v71
    v_pk_add_f32 v[80:81], v[80:81], v[252:253] op_sel_hi:[1,0] neg_lo:[0,1] neg_hi:[0,1]
    v_pk_add_f32 v[82:83], v[82:83], v[252:253] op_sel_hi:[1,0] neg_lo:[0,1] neg_hi:[0,1]
    v_exp_f32 v80, v80
    v_exp_f32 v81, v81
    v_exp_f32 v82, v82
    v_exp_f32 v83, v83
    v_pk_add_f32 v[84:85], v[84:85], v[252:253] op_sel_hi:[1,0] neg_lo:[0,1] neg_hi:[0,1]
    v_pk_add_f32 v[86:87], v[86:87], v[252:253] op_sel_hi:[1,0] neg_lo:[0,1] neg_hi:[0,1]
    v_exp_f32 v84, v84
    v_exp_f32 v85, v85
    v_exp_f32 v86, v86
    v_exp_f32 v87, v87
    v_cvt_pk_bf16_f32 v72, v72, v73
    v_cvt_pk_bf16_f32 v73, v74, v75
    v_cvt_pk_bf16_f32 v74, v76, v77
    v_cvt_pk_bf16_f32 v75, v78, v79
    v_pk_add_f32 v[88:89], v[88:89], v[252:253] op_sel_hi:[1,0] neg_lo:[0,1] neg_hi:[0,1]
    v_pk_add_f32 v[90:91], v[90:91], v[252:253] op_sel_hi:[1,0] neg_lo:[0,1] neg_hi:[0,1]
    v_exp_f32 v88, v88
    v_exp_f32 v89, v89
    v_exp_f32 v90, v90
    v_exp_f32 v91, v91
    v_pk_add_f32 v[92:93], v[92:93], v[252:253] op_sel_hi:[1,0] neg_lo:[0,1] neg_hi:[0,1]
    v_pk_add_f32 v[94:95], v[94:95], v[252:253] op_sel_hi:[1,0] neg_lo:[0,1] neg_hi:[0,1]
    v_exp_f32 v92, v92
    v_exp_f32 v93, v93
    v_exp_f32 v94, v94
    v_exp_f32 v95, v95
    v_cvt_pk_bf16_f32 v80, v80, v81
    v_cvt_pk_bf16_f32 v81, v82, v83
    v_cvt_pk_bf16_f32 v82, v84, v85
    v_cvt_pk_bf16_f32 v83, v86, v87
    v_cvt_pk_bf16_f32 v88, v88, v89
    v_cvt_pk_bf16_f32 v89, v90, v91
    v_cvt_pk_bf16_f32 v90, v92, v93
    v_cvt_pk_bf16_f32 v91, v94, v95
    v_cndmask_b32 v24, v116, v24, s[58:59]
    v_cndmask_b32 v25, v117, v25, s[60:61]
    v_mfma_f32_16x16x32_bf16 v[28:31], a[80:83], v[32:35], 0
    s_add_u32 s46, s46, 65536
    v_cndmask_b32 v26, v118, v26, s[62:63]
    v_cndmask_b32 v27, v119, v27, s[64:65]
    v_mfma_f32_16x16x32_bf16 v[36:39], a[84:87], v[32:35], 0
    s_add_u32 m0, s50, 58368
    v_max3_f32 v252, v120, v121, v122
    v_max3_f32 v253, v123, v124, v125
    v_mfma_f32_16x16x32_bf16 v[44:47], v[248:251], v[32:35], 0
    v_max3_f32 v252, v252, v126, v127
    v_max3_f32 v253, v253, v144, v145
    v_mfma_f32_16x16x32_bf16 v[28:31], a[88:91], v[40:43], v[28:31]
    v_max3_f32 v252, v252, v146, v147
    v_max3_f32 v253, v253, v148, v149
    v_mfma_f32_16x16x32_bf16 v[36:39], a[92:95], v[40:43], v[36:39]
    v_max3_f32 v252, v252, v150, v151
    v_max3_f32 v253, v253, v152, v153
    v_mfma_f32_16x16x32_bf16 v[44:47], v[248:251], v[40:43], v[44:47]
    v_max3_f32 v252, v252, v154, v155
    v_max3_f32 v253, v253, v156, v157
    v_mfma_f32_16x16x32_bf16 v[28:31], a[96:99], v[48:51], v[28:31]
    v_max3_f32 v252, v252, v158, v159
    v_max3_f32 v253, v253, v212, v213
    v_mfma_f32_16x16x32_bf16 v[36:39], a[100:103], v[48:51], v[36:39]
    v_max3_f32 v252, v252, v214, v215
    v_max3_f32 v253, v253, v216, v217
    v_mfma_f32_16x16x32_bf16 v[44:47], v[248:251], v[48:51], v[44:47]
    v_max3_f32 v252, v252, v218, v219
    v_max3_f32 v253, v253, v220, v221
    v_mfma_f32_16x16x32_bf16 v[28:31], a[104:107], v[56:59], v[28:31]
    v_max3_f32 v252, v252, v222, v223
    v_max3_f32 v253, v253, v176, v177
    v_mfma_f32_16x16x32_bf16 v[36:39], a[108:111], v[56:59], v[36:39]
    v_max3_f32 v252, v252, v178, v179
    v_max3_f32 v253, v253, v180, v181
    v_mfma_f32_16x16x32_bf16 v[44:47], v[248:251], v[56:59], v[44:47]
    v_max3_f32 v252, v252, v182, v183
    v_max3_f32 v253, v253, v184, v185
    v_mfma_f32_16x16x32_bf16 v[28:31], a[112:115], v[64:67], v[28:31]
    v_max3_f32 v252, v252, v186, v187
    v_max3_f32 v253, v253, v188, v189
    v_mfma_f32_16x16x32_bf16 v[36:39], a[116:119], v[64:67], v[36:39]
    v_max3_f32 v252, v252, v190, v191
    v_max3_f32 v253, v253, v16, v17
    v_mfma_f32_16x16x32_bf16 v[44:47], v[248:251], v[64:67], v[44:47]
    v_max3_f32 v252, v252, v18, v19
    v_max3_f32 v253, v253, v20, v21
    v_mfma_f32_16x16x32_bf16 v[28:31], a[120:123], v[72:75], v[28:31]
    v_max3_f32 v252, v252, v22, v23
    v_max3_f32 v253, v253, v24, v25
    v_mfma_f32_16x16x32_bf16 v[36:39], a[124:127], v[72:75], v[36:39]
    v_max3_f32 v252, v252, v26, v27
    v_max_f32 v252, v252, v253
    v_mov_b32 v253, v252
    v_mfma_f32_16x16x32_bf16 v[44:47], v[248:251], v[72:75], v[44:47]
    s_nop 0
    v_permlane16_swap_b32 v252, v253
    v_max_f32 v252, v252, v253
    v_mov_b32 v253, v252
    v_mov_b32 v116, 0
    v_mov_b32 v117, 0
    v_permlane32_swap_b32 v252, v253
    v_max_f32 v252, v252, v253
    v_pk_add_f32 v[24:25], v[24:25], v[252:253] op_sel_hi:[1,0] neg_lo:[0,1] neg_hi:[0,1]
    v_pk_add_f32 v[26:27], v[26:27], v[252:253] op_sel_hi:[1,0] neg_lo:[0,1] neg_hi:[0,1]
    v_mfma_f32_16x16x32_bf16 v[28:31], a[128:131], v[80:83], v[28:31]
    v_exp_f32 v24, v24
    v_mfma_f32_16x16x32_bf16 v[36:39], a[132:135], v[80:83], v[36:39]
    v_exp_f32 v25, v25
    v_exp_f32 v26, v26
    v_exp_f32 v27, v27
    buffer_load_dwordx4 v209, s[28:31], s46 offen lds
    v_pk_add_f32 v[120:121], v[120:121], v[252:253] op_sel_hi:[1,0] neg_lo:[0,1] neg_hi:[0,1]
    v_pk_add_f32 v[122:123], v[122:123], v[252:253] op_sel_hi:[1,0] neg_lo:[0,1] neg_hi:[0,1]
    v_mfma_f32_16x16x32_bf16 v[44:47], v[248:251], v[80:83], v[44:47]
    v_exp_f32 v120, v120
    v_mfma_f32_16x16x32_bf16 v[28:31], a[136:139], v[88:91], v[28:31]
    v_exp_f32 v121, v121
    v_exp_f32 v122, v122
    v_exp_f32 v123, v123
    v_cvt_pk_bf16_f32 v27, v26, v27
    v_cvt_pk_bf16_f32 v26, v24, v25
    v_bfi_b32 v118, v254, 0, v26
    v_bfi_b32 v119, v255, 0, v27
    v_xor_b32 v26, v26, v118
    v_xor_b32 v27, v27, v119
    v_pk_add_f32 v[124:125], v[124:125], v[252:253] op_sel_hi:[1,0] neg_lo:[0,1] neg_hi:[0,1]
    v_pk_add_f32 v[126:127], v[126:127], v[252:253] op_sel_hi:[1,0] neg_lo:[0,1] neg_hi:[0,1]
    v_mfma_f32_16x16x32_bf16 v[36:39], a[140:143], v[88:91], v[36:39]
    v_exp_f32 v124, v124
    v_mfma_f32_16x16x32_bf16 v[44:47], v[248:251], v[88:91], v[44:47]
    v_exp_f32 v125, v125
    v_exp_f32 v126, v126
    v_exp_f32 v127, v127
    buffer_load_dwordx4 v210, s[28:31], s46 offen offset:1024 lds
    v_pk_add_f32 v[144:145], v[144:145], v[252:253] op_sel_hi:[1,0] neg_lo:[0,1] neg_hi:[0,1]
    v_pk_add_f32 v[146:147], v[146:147], v[252:253] op_sel_hi:[1,0] neg_lo:[0,1] neg_hi:[0,1]
    v_mfma_f32_16x16x32_bf16 v[28:31], a[144:147], v[112:115], v[28:31]
    s_cmp_le_u32 s45, 0
    s_cselect_b32 s79, 262144, 0
    v_exp_f32 v144, v144
    v_mfma_f32_16x16x32_bf16 v[36:39], a[148:151], v[112:115], v[36:39]
    s_add_u32 s46, s48, s79
    v_exp_f32 v145, v145
    v_exp_f32 v146, v146
    v_exp_f32 v147, v147
    v_pk_add_f32 v[148:149], v[148:149], v[252:253] op_sel_hi:[1,0] neg_lo:[0,1] neg_hi:[0,1]
    v_pk_add_f32 v[150:151], v[150:151], v[252:253] op_sel_hi:[1,0] neg_lo:[0,1] neg_hi:[0,1]
    v_mfma_f32_16x16x32_bf16 v[44:47], v[248:251], v[112:115], v[44:47]
    s_add_u32 m0, s50, 3072
    v_exp_f32 v148, v148
    v_mfma_f32_16x16x32_bf16 v[52:55], a[8:11], v[8:11], v[232:235]
    v_exp_f32 v149, v149
    v_exp_f32 v150, v150
    v_exp_f32 v151, v151
    v_cvt_pk_bf16_f32 v120, v120, v121
    v_cvt_pk_bf16_f32 v121, v122, v123
    v_cvt_pk_bf16_f32 v122, v124, v125
    v_cvt_pk_bf16_f32 v123, v126, v127
    v_pk_add_f32 v[152:153], v[152:153], v[252:253] op_sel_hi:[1,0] neg_lo:[0,1] neg_hi:[0,1]
    v_pk_add_f32 v[154:155], v[154:155], v[252:253] op_sel_hi:[1,0] neg_lo:[0,1] neg_hi:[0,1]
    v_mfma_f32_16x16x32_bf16 v[60:63], a[12:15], v[8:11], v[232:235]
    v_exp_f32 v152, v152
    v_mfma_f32_16x16x32_bf16 v[68:71], a[16:19], v[8:11], v[236:239]
    v_exp_f32 v153, v153
    v_exp_f32 v154, v154
    v_exp_f32 v155, v155
    v_rcp_f32 v44, v44
    s_nop 0
    v_mul_f32 v28, v28, v44
    v_mul_f32 v29, v29, v44
    v_mul_f32 v30, v30, v44
    v_mul_f32 v31, v31, v44
    v_mul_f32 v36, v36, v44
    v_mul_f32 v37, v37, v44
    v_mul_f32 v38, v38, v44
    v_mul_f32 v39, v39, v44
    v_cvt_pk_bf16_f32 v28, v28, v29
    v_cvt_pk_bf16_f32 v29, v30, v31
    v_cvt_pk_bf16_f32 v30, v36, v37
    v_cvt_pk_bf16_f32 v31, v38, v39
    buffer_store_dwordx4 v[28:31], v208, s[36:39], s77 offen offset:0 sc1
    v_pk_add_f32 v[156:157], v[156:157], v[252:253] op_sel_hi:[1,0] neg_lo:[0,1] neg_hi:[0,1]
    v_pk_add_f32 v[158:159], v[158:159], v[252:253] op_sel_hi:[1,0] neg_lo:[0,1] neg_hi:[0,1]
    v_mfma_f32_16x16x32_bf16 v[76:79], a[20:23], v[8:11], v[236:239]
    v_exp_f32 v156, v156
    v_mfma_f32_16x16x32_bf16 v[84:87], a[24:27], v[8:11], v[236:239]
    v_exp_f32 v157, v157
    v_exp_f32 v158, v158
    v_exp_f32 v159, v159
    buffer_load_dwordx4 v209, s[28:31], s46 offen lds
    v_cvt_pk_bf16_f32 v144, v144, v145
    v_cvt_pk_bf16_f32 v145, v146, v147
    v_cvt_pk_bf16_f32 v146, v148, v149
    v_cvt_pk_bf16_f32 v147, v150, v151
    v_pk_add_f32 v[212:213], v[212:213], v[252:253] op_sel_hi:[1,0] neg_lo:[0,1] neg_hi:[0,1]
    v_pk_add_f32 v[214:215], v[214:215], v[252:253] op_sel_hi:[1,0] neg_lo:[0,1] neg_hi:[0,1]
    v_mfma_f32_16x16x32_bf16 v[92:95], a[28:31], v[8:11], v[236:239]
    v_exp_f32 v212, v212
    v_mfma_f32_16x16x32_bf16 v[32:35], a[32:35], v[8:11], v[240:243]
    v_exp_f32 v213, v213
    v_exp_f32 v214, v214
    v_exp_f32 v215, v215
    v_pk_add_f32 v[216:217], v[216:217], v[252:253] op_sel_hi:[1,0] neg_lo:[0,1] neg_hi:[0,1]
    v_pk_add_f32 v[218:219], v[218:219], v[252:253] op_sel_hi:[1,0] neg_lo:[0,1] neg_hi:[0,1]
    v_mfma_f32_16x16x32_bf16 v[40:43], a[36:39], v[8:11], v[240:243]
    v_exp_f32 v216, v216
    v_mfma_f32_16x16x32_bf16 v[48:51], a[40:43], v[8:11], v[240:243]
    v_exp_f32 v217, v217
    v_exp_f32 v218, v218
    v_exp_f32 v219, v219
    buffer_load_dwordx4 v210, s[28:31], s46 offen offset:1024 lds
    v_cvt_pk_bf16_f32 v152, v152, v153
    v_cvt_pk_bf16_f32 v153, v154, v155
    v_cvt_pk_bf16_f32 v154, v156, v157
    v_cvt_pk_bf16_f32 v155, v158, v159
    v_pk_add_f32 v[220:221], v[220:221], v[252:253] op_sel_hi:[1,0] neg_lo:[0,1] neg_hi:[0,1]
    v_pk_add_f32 v[222:223], v[222:223], v[252:253] op_sel_hi:[1,0] neg_lo:[0,1] neg_hi:[0,1]
    v_mfma_f32_16x16x32_bf16 v[56:59], a[44:47], v[8:11], v[240:243]
    s_add_u32 s46, s46, 65536
    v_exp_f32 v220, v220
    v_mfma_f32_16x16x32_bf16 v[64:67], a[48:51], v[8:11], v[244:247]
    s_add_u32 m0, s50, 31744
    v_exp_f32 v221, v221
    v_exp_f32 v222, v222
    v_exp_f32 v223, v223
    s_waitcnt vmcnt(8)
    buffer_store_dword v226, v229, s[36:39], 0 offen offset:32 sc1
    v_pk_add_f32 v[176:177], v[176:177], v[252:253] op_sel_hi:[1,0] neg_lo:[0,1] neg_hi:[0,1]
    v_pk_add_f32 v[178:179], v[178:179], v[252:253] op_sel_hi:[1,0] neg_lo:[0,1] neg_hi:[0,1]
    v_mfma_f32_16x16x32_bf16 v[72:75], a[52:55], v[8:11], v[244:247]
    v_exp_f32 v176, v176
    v_mfma_f32_16x16x32_bf16 v[80:83], a[56:59], v[8:11], v[244:247]
    v_exp_f32 v177, v177
    v_exp_f32 v178, v178
    v_exp_f32 v179, v179
    buffer_load_dwordx4 v209, s[28:31], s46 offen lds
    v_cvt_pk_bf16_f32 v212, v212, v213
    v_cvt_pk_bf16_f32 v213, v214, v215
    v_cvt_pk_bf16_f32 v214, v216, v217
    v_cvt_pk_bf16_f32 v215, v218, v219
    v_pk_add_f32 v[180:181], v[180:181], v[252:253] op_sel_hi:[1,0] neg_lo:[0,1] neg_hi:[0,1]
    v_pk_add_f32 v[182:183], v[182:183], v[252:253] op_sel_hi:[1,0] neg_lo:[0,1] neg_hi:[0,1]
    v_mfma_f32_16x16x32_bf16 v[88:91], a[60:63], v[8:11], v[244:247]
    v_exp_f32 v180, v180
    v_mfma_f32_16x16x32_bf16 v[112:115], a[64:67], v[8:11], 0
    v_exp_f32 v181, v181
    v_exp_f32 v182, v182
    v_exp_f32 v183, v183
    v_pk_add_f32 v[184:185], v[184:185], v[252:253] op_sel_hi:[1,0] neg_lo:[0,1] neg_hi:[0,1]
    v_pk_add_f32 v[186:187], v[186:187], v[252:253] op_sel_hi:[1,0] neg_lo:[0,1] neg_hi:[0,1]
    v_mfma_f32_16x16x32_bf16 v[124:127], a[68:71], v[8:11], 0
    v_exp_f32 v184, v184
    v_mfma_f32_16x16x32_bf16 v[36:39], a[72:75], v[8:11], 0
    v_exp_f32 v185, v185
    v_exp_f32 v186, v186
    v_exp_f32 v187, v187
    buffer_load_dwordx4 v210, s[28:31], s46 offen offset:1024 lds
    v_cvt_pk_bf16_f32 v220, v220, v221
    v_cvt_pk_bf16_f32 v221, v222, v223
    v_cvt_pk_bf16_f32 v222, v176, v177
    v_cvt_pk_bf16_f32 v223, v178, v179
    v_pk_add_f32 v[188:189], v[188:189], v[252:253] op_sel_hi:[1,0] neg_lo:[0,1] neg_hi:[0,1]
    v_pk_add_f32 v[190:191], v[190:191], v[252:253] op_sel_hi:[1,0] neg_lo:[0,1] neg_hi:[0,1]
    v_exp_f32 v188, v188
    v_exp_f32 v189, v189
    v_exp_f32 v190, v190
    v_exp_f32 v191, v191
    v_pk_add_f32 v[16:17], v[16:17], v[252:253] op_sel_hi:[1,0] neg_lo:[0,1] neg_hi:[0,1]
    v_pk_add_f32 v[18:19], v[18:19], v[252:253] op_sel_hi:[1,0] neg_lo:[0,1] neg_hi:[0,1]
    v_exp_f32 v16, v16
    v_exp_f32 v17, v17
    v_exp_f32 v18, v18
    v_exp_f32 v19, v19
    v_cvt_pk_bf16_f32 v180, v180, v181
    v_cvt_pk_bf16_f32 v181, v182, v183
    v_cvt_pk_bf16_f32 v182, v184, v185
    v_cvt_pk_bf16_f32 v183, v186, v187
    v_pk_add_f32 v[20:21], v[20:21], v[252:253] op_sel_hi:[1,0] neg_lo:[0,1] neg_hi:[0,1]
    v_pk_add_f32 v[22:23], v[22:23], v[252:253] op_sel_hi:[1,0] neg_lo:[0,1] neg_hi:[0,1]
    v_exp_f32 v20, v20
    v_exp_f32 v21, v21
    v_exp_f32 v22, v22
    v_exp_f32 v23, v23
    v_cvt_pk_bf16_f32 v188, v188, v189
    v_cvt_pk_bf16_f32 v189, v190, v191
    v_cvt_pk_bf16_f32 v190, v16, v17
    v_cvt_pk_bf16_f32 v191, v18, v19
    v_cvt_pk_bf16_f32 v24, v20, v21
    v_cvt_pk_bf16_f32 v25, v22, v23
    v_cndmask_b32 v52, v52, v36, s[58:59]
    v_cndmask_b32 v53, v53, v37, s[60:61]
    v_mfma_f32_16x16x32_bf16 v[44:47], a[80:83], v[116:119], 0
    s_add_u32 s46, s46, 65536
    v_cndmask_b32 v54, v54, v38, s[62:63]
    v_cndmask_b32 v55, v55, v39, s[64:65]
    v_mfma_f32_16x16x32_bf16 v[148:151], a[84:87], v[116:119], 0
    s_add_u32 m0, s50, 60416
    v_max3_f32 v252, v60, v61, v62
    v_max3_f32 v253, v63, v68, v69
    v_mfma_f32_16x16x32_bf16 v[156:159], v[248:251], v[116:119], 0
    v_max3_f32 v252, v252, v70, v71
    v_max3_f32 v253, v253, v76, v77
    v_mfma_f32_16x16x32_bf16 v[44:47], a[88:91], v[120:123], v[44:47]
    v_max3_f32 v252, v252, v78, v79
    v_max3_f32 v253, v253, v84, v85
    v_mfma_f32_16x16x32_bf16 v[148:151], a[92:95], v[120:123], v[148:151]
    v_max3_f32 v252, v252, v86, v87
    v_max3_f32 v253, v253, v92, v93
    v_mfma_f32_16x16x32_bf16 v[156:159], v[248:251], v[120:123], v[156:159]
    v_max3_f32 v252, v252, v94, v95
    v_max3_f32 v253, v253, v32, v33
    v_mfma_f32_16x16x32_bf16 v[44:47], a[96:99], v[144:147], v[44:47]
    v_max3_f32 v252, v252, v34, v35
    v_max3_f32 v253, v253, v40, v41
    v_mfma_f32_16x16x32_bf16 v[148:151], a[100:103], v[144:147], v[148:151]
    v_max3_f32 v252, v252, v42, v43
    v_max3_f32 v253, v253, v48, v49
    v_mfma_f32_16x16x32_bf16 v[156:159], v[248:251], v[144:147], v[156:159]
    v_max3_f32 v252, v252, v50, v51
    v_max3_f32 v253, v253, v56, v57
    v_mfma_f32_16x16x32_bf16 v[44:47], a[104:107], v[152:155], v[44:47]
    v_max3_f32 v252, v252, v58, v59
    v_max3_f32 v253, v253, v64, v65
    v_mfma_f32_16x16x32_bf16 v[148:151], a[108:111], v[152:155], v[148:151]
    v_max3_f32 v252, v252, v66, v67
    v_max3_f32 v253, v253, v72, v73
    v_mfma_f32_16x16x32_bf16 v[156:159], v[248:251], v[152:155], v[156:159]
    v_max3_f32 v252, v252, v74, v75
    v_max3_f32 v253, v253, v80, v81
    v_mfma_f32_16x16x32_bf16 v[44:47], a[112:115], v[212:215], v[44:47]
    v_max3_f32 v252, v252, v82, v83
    v_max3_f32 v253, v253, v88, v89
    v_mfma_f32_16x16x32_bf16 v[148:151], a[116:119], v[212:215], v[148:151]
    v_max3_f32 v252, v252, v90, v91
    v_max3_f32 v253, v253, v112, v113
    v_mfma_f32_16x16x32_bf16 v[156:159], v[248:251], v[212:215], v[156:159]
    v_max3_f32 v252, v252, v114, v115
    v_max3_f32 v253, v253, v124, v125
    v_mfma_f32_16x16x32_bf16 v[44:47], a[120:123], v[220:223], v[44:47]
    v_max3_f32 v252, v252, v126, v127
    v_max3_f32 v253, v253, v52, v53
    v_mfma_f32_16x16x32_bf16 v[148:151], a[124:127], v[220:223], v[148:151]
    v_max3_f32 v252, v252, v54, v55
    v_max_f32 v252, v252, v253
    v_mov_b32 v253, v252
    v_mfma_f32_16x16x32_bf16 v[156:159], v[248:251], v[220:223], v[156:159]
    s_nop 0
    v_permlane16_swap_b32 v252, v253
    v_max_f32 v252, v252, v253
    v_mov_b32 v253, v252
    v_mov_b32 v38, 0
    v_mov_b32 v39, 0
    v_permlane32_swap_b32 v252, v253
    v_max_f32 v252, v252, v253
    v_pk_add_f32 v[52:53], v[52:53], v[252:253] op_sel_hi:[1,0] neg_lo:[0,1] neg_hi:[0,1]
    v_pk_add_f32 v[54:55], v[54:55], v[252:253] op_sel_hi:[1,0] neg_lo:[0,1] neg_hi:[0,1]
    v_mfma_f32_16x16x32_bf16 v[44:47], a[128:131], v[180:183], v[44:47]
    v_exp_f32 v52, v52
    v_mfma_f32_16x16x32_bf16 v[148:151], a[132:135], v[180:183], v[148:151]
    v_exp_f32 v53, v53
    v_exp_f32 v54, v54
    v_exp_f32 v55, v55
    buffer_load_dwordx4 v209, s[28:31], s46 offen lds
    v_pk_add_f32 v[60:61], v[60:61], v[252:253] op_sel_hi:[1,0] neg_lo:[0,1] neg_hi:[0,1]
    v_pk_add_f32 v[62:63], v[62:63], v[252:253] op_sel_hi:[1,0] neg_lo:[0,1] neg_hi:[0,1]
    v_mfma_f32_16x16x32_bf16 v[156:159], v[248:251], v[180:183], v[156:159]
    v_exp_f32 v60, v60
    v_mfma_f32_16x16x32_bf16 v[44:47], a[136:139], v[188:191], v[44:47]
    v_exp_f32 v61, v61
    v_exp_f32 v62, v62
    v_exp_f32 v63, v63
    v_cvt_pk_bf16_f32 v52, v52, v53
    v_cvt_pk_bf16_f32 v53, v54, v55
    v_and_b32 v36, v254, v52
    v_and_b32 v37, v255, v53
    v_xor_b32 v52, v52, v36
    v_xor_b32 v53, v53, v37
    v_pk_add_f32 v[68:69], v[68:69], v[252:253] op_sel_hi:[1,0] neg_lo:[0,1] neg_hi:[0,1]
    v_pk_add_f32 v[70:71], v[70:71], v[252:253] op_sel_hi:[1,0] neg_lo:[0,1] neg_hi:[0,1]
    v_mfma_f32_16x16x32_bf16 v[148:151], a[140:143], v[188:191], v[148:151]
    v_exp_f32 v68, v68
    v_mfma_f32_16x16x32_bf16 v[156:159], v[248:251], v[188:191], v[156:159]
    v_exp_f32 v69, v69
    v_exp_f32 v70, v70
    v_exp_f32 v71, v71
    buffer_load_dwordx4 v210, s[28:31], s46 offen offset:1024 lds
    v_pk_add_f32 v[76:77], v[76:77], v[252:253] op_sel_hi:[1,0] neg_lo:[0,1] neg_hi:[0,1]
    v_pk_add_f32 v[78:79], v[78:79], v[252:253] op_sel_hi:[1,0] neg_lo:[0,1] neg_hi:[0,1]
    v_mfma_f32_16x16x32_bf16 v[44:47], a[144:147], v[24:27], v[44:47]
    s_cmp_le_u32 s45, 1
    s_cselect_b32 s79, 196608, 0
    v_exp_f32 v76, v76
    v_mfma_f32_16x16x32_bf16 v[148:151], a[148:151], v[24:27], v[148:151]
    s_add_u32 s46, s48, s79
    v_exp_f32 v77, v77
    v_exp_f32 v78, v78
    v_exp_f32 v79, v79
    v_cvt_pk_bf16_f32 v54, v60, v61
    v_cvt_pk_bf16_f32 v55, v62, v63
    v_pk_add_f32 v[84:85], v[84:85], v[252:253] op_sel_hi:[1,0] neg_lo:[0,1] neg_hi:[0,1]
    v_pk_add_f32 v[86:87], v[86:87], v[252:253] op_sel_hi:[1,0] neg_lo:[0,1] neg_hi:[0,1]
    v_mfma_f32_16x16x32_bf16 v[156:159], v[248:251], v[24:27], v[156:159]
    s_add_u32 s46, s46, 262144
    v_exp_f32 v84, v84
    v_mfma_f32_16x16x32_bf16 v[216:219], a[12:15], v[12:15], v[232:235]
    s_add_u32 m0, s50, 5120
    v_exp_f32 v85, v85
    v_exp_f32 v86, v86
    v_exp_f32 v87, v87
    v_pk_add_f32 v[92:93], v[92:93], v[252:253] op_sel_hi:[1,0] neg_lo:[0,1] neg_hi:[0,1]
    v_pk_add_f32 v[94:95], v[94:95], v[252:253] op_sel_hi:[1,0] neg_lo:[0,1] neg_hi:[0,1]
    v_mfma_f32_16x16x32_bf16 v[176:179], a[16:19], v[12:15], v[236:239]
    v_exp_f32 v92, v92
    v_mfma_f32_16x16x32_bf16 v[184:187], a[20:23], v[12:15], v[236:239]
    v_exp_f32 v93, v93
    v_exp_f32 v94, v94
    v_exp_f32 v95, v95
    v_rcp_f32 v156, v156
    s_nop 0
    v_mul_f32 v44, v44, v156
    v_mul_f32 v45, v45, v156
    v_mul_f32 v46, v46, v156
    v_mul_f32 v47, v47, v156
    v_mul_f32 v148, v148, v156
    v_mul_f32 v149, v149, v156
    v_mul_f32 v150, v150, v156
    v_mul_f32 v151, v151, v156
    v_cvt_pk_bf16_f32 v44, v44, v45
    v_cvt_pk_bf16_f32 v45, v46, v47
    v_cvt_pk_bf16_f32 v46, v148, v149
    v_cvt_pk_bf16_f32 v47, v150, v151
    buffer_store_dwordx4 v[44:47], v208, s[36:39], s77 offen offset:1024 sc1
    v_cvt_pk_bf16_f32 v68, v68, v69
    v_cvt_pk_bf16_f32 v69, v70, v71
    v_cvt_pk_bf16_f32 v70, v76, v77
    v_cvt_pk_bf16_f32 v71, v78, v79
    v_pk_add_f32 v[32:33], v[32:33], v[252:253] op_sel_hi:[1,0] neg_lo:[0,1] neg_hi:[0,1]
    v_pk_add_f32 v[34:35], v[34:35], v[252:253] op_sel_hi:[1,0] neg_lo:[0,1] neg_hi:[0,1]
    v_mfma_f32_16x16x32_bf16 v[16:19], a[24:27], v[12:15], v[236:239]
    v_exp_f32 v32, v32
    v_mfma_f32_16x16x32_bf16 v[20:23], a[28:31], v[12:15], v[236:239]
    v_exp_f32 v33, v33
    v_exp_f32 v34, v34
    v_exp_f32 v35, v35
    buffer_load_dwordx4 v209, s[28:31], s46 offen lds
    v_pk_add_f32 v[40:41], v[40:41], v[252:253] op_sel_hi:[1,0] neg_lo:[0,1] neg_hi:[0,1]
    v_pk_add_f32 v[42:43], v[42:43], v[252:253] op_sel_hi:[1,0] neg_lo:[0,1] neg_hi:[0,1]
    v_mfma_f32_16x16x32_bf16 v[28:31], a[32:35], v[12:15], v[240:243]
    v_exp_f32 v40, v40
    v_mfma_f32_16x16x32_bf16 v[116:119], a[36:39], v[12:15], v[240:243]
    v_exp_f32 v41, v41
    v_exp_f32 v42, v42
    v_exp_f32 v43, v43
    v_cvt_pk_bf16_f32 v84, v84, v85
    v_cvt_pk_bf16_f32 v85, v86, v87
    v_cvt_pk_bf16_f32 v86, v92, v93
    v_cvt_pk_bf16_f32 v87, v94, v95
    v_pk_add_f32 v[48:49], v[48:49], v[252:253] op_sel_hi:[1,0] neg_lo:[0,1] neg_hi:[0,1]
    v_pk_add_f32 v[50:51], v[50:51], v[252:253] op_sel_hi:[1,0] neg_lo:[0,1] neg_hi:[0,1]
    v_mfma_f32_16x16x32_bf16 v[120:123], a[40:43], v[12:15], v[240:243]
    v_exp_f32 v48, v48
    v_mfma_f32_16x16x32_bf16 v[144:147], a[44:47], v[12:15], v[240:243]
    v_exp_f32 v49, v49
    v_exp_f32 v50, v50
    v_exp_f32 v51, v51
    buffer_load_dwordx4 v210, s[28:31], s46 offen offset:1024 lds
    v_pk_add_f32 v[56:57], v[56:57], v[252:253] op_sel_hi:[1,0] neg_lo:[0,1] neg_hi:[0,1]
    v_pk_add_f32 v[58:59], v[58:59], v[252:253] op_sel_hi:[1,0] neg_lo:[0,1] neg_hi:[0,1]
    v_mfma_f32_16x16x32_bf16 v[152:155], a[48:51], v[12:15], v[244:247]
    s_add_u32 s46, s46, 65536
    v_exp_f32 v56, v56
    v_mfma_f32_16x16x32_bf16 v[212:215], a[52:55], v[12:15], v[244:247]
    s_add_u32 m0, s50, 33792
    v_exp_f32 v57, v57
    v_exp_f32 v58, v58
    v_exp_f32 v59, v59
    buffer_store_dwordx4 v[192:195], v208, s[36:39], s75 offen offset:0 sc1
    buffer_store_dwordx4 v[200:203], v208, s[36:39], s75 offen offset:1024 sc1
    v_cvt_pk_bf16_f32 v32, v32, v33
    v_cvt_pk_bf16_f32 v33, v34, v35
    v_cvt_pk_bf16_f32 v34, v40, v41
    v_cvt_pk_bf16_f32 v35, v42, v43
    v_pk_add_f32 v[64:65], v[64:65], v[252:253] op_sel_hi:[1,0] neg_lo:[0,1] neg_hi:[0,1]
    v_pk_add_f32 v[66:67], v[66:67], v[252:253] op_sel_hi:[1,0] neg_lo:[0,1] neg_hi:[0,1]
    v_mfma_f32_16x16x32_bf16 v[220:223], a[56:59], v[12:15], v[244:247]
    v_exp_f32 v64, v64
    v_mfma_f32_16x16x32_bf16 v[180:183], a[60:63], v[12:15], v[244:247]
    v_exp_f32 v65, v65
    v_exp_f32 v66, v66
    v_exp_f32 v67, v67
    buffer_load_dwordx4 v209, s[28:31], s46 offen lds
    v_pk_add_f32 v[72:73], v[72:73], v[252:253] op_sel_hi:[1,0] neg_lo:[0,1] neg_hi:[0,1]
    v_pk_add_f32 v[74:75], v[74:75], v[252:253] op_sel_hi:[1,0] neg_lo:[0,1] neg_hi:[0,1]
    v_mfma_f32_16x16x32_bf16 v[188:191], a[64:67], v[12:15], 0
    v_exp_f32 v72, v72
    v_mfma_f32_16x16x32_bf16 v[60:63], a[68:71], v[12:15], 0
    v_exp_f32 v73, v73
    v_exp_f32 v74, v74
    v_exp_f32 v75, v75
    v_cvt_pk_bf16_f32 v48, v48, v49
    v_cvt_pk_bf16_f32 v49, v50, v51
    v_cvt_pk_bf16_f32 v50, v56, v57
    v_cvt_pk_bf16_f32 v51, v58, v59
    v_pk_add_f32 v[80:81], v[80:81], v[252:253] op_sel_hi:[1,0] neg_lo:[0,1] neg_hi:[0,1]
    v_pk_add_f32 v[82:83], v[82:83], v[252:253] op_sel_hi:[1,0] neg_lo:[0,1] neg_hi:[0,1]
    v_mfma_f32_16x16x32_bf16 v[24:27], a[72:75], v[12:15], 0
    v_exp_f32 v80, v80
    v_mfma_f32_16x16x32_bf16 v[148:151], a[76:79], v[12:15], 0
    v_exp_f32 v81, v81
    v_exp_f32 v82, v82
    v_exp_f32 v83, v83
    buffer_load_dwordx4 v210, s[28:31], s46 offen offset:1024 lds
    v_pk_add_f32 v[88:89], v[88:89], v[252:253] op_sel_hi:[1,0] neg_lo:[0,1] neg_hi:[0,1]
    v_pk_add_f32 v[90:91], v[90:91], v[252:253] op_sel_hi:[1,0] neg_lo:[0,1] neg_hi:[0,1]
    v_exp_f32 v88, v88
    v_exp_f32 v89, v89
    v_exp_f32 v90, v90
    v_exp_f32 v91, v91
    v_cvt_pk_bf16_f32 v64, v64, v65
    v_cvt_pk_bf16_f32 v65, v66, v67
    v_cvt_pk_bf16_f32 v66, v72, v73
    v_cvt_pk_bf16_f32 v67, v74, v75
    v_pk_add_f32 v[112:113], v[112:113], v[252:253] op_sel_hi:[1,0] neg_lo:[0,1] neg_hi:[0,1]
    v_pk_add_f32 v[114:115], v[114:115], v[252:253] op_sel_hi:[1,0] neg_lo:[0,1] neg_hi:[0,1]
    v_exp_f32 v112, v112
    v_exp_f32 v113, v113
    v_exp_f32 v114, v114
    v_exp_f32 v115, v115
    v_pk_add_f32 v[124:125], v[124:125], v[252:253] op_sel_hi:[1,0] neg_lo:[0,1] neg_hi:[0,1]
    v_pk_add_f32 v[126:127], v[126:127], v[252:253] op_sel_hi:[1,0] neg_lo:[0,1] neg_hi:[0,1]
    v_exp_f32 v124, v124
    v_exp_f32 v125, v125
    v_exp_f32 v126, v126
    v_exp_f32 v127, v127
    v_cvt_pk_bf16_f32 v80, v80, v81
    v_cvt_pk_bf16_f32 v81, v82, v83
    v_cvt_pk_bf16_f32 v82, v88, v89
    v_cvt_pk_bf16_f32 v83, v90, v91
    v_cvt_pk_bf16_f32 v112, v112, v113
    v_cvt_pk_bf16_f32 v113, v114, v115
    v_cvt_pk_bf16_f32 v114, v124, v125
    v_cvt_pk_bf16_f32 v115, v126, v127
    v_cndmask_b32 v148, v216, v148, s[58:59]
    v_cndmask_b32 v149, v217, v149, s[60:61]
    v_mfma_f32_16x16x32_bf16 v[156:159], a[88:91], v[52:55], 0
    s_add_u32 s46, s46, 65536
    v_cndmask_b32 v150, v218, v150, s[62:63]
    v_cndmask_b32 v151, v219, v151, s[64:65]
    v_mfma_f32_16x16x32_bf16 v[76:79], a[92:95], v[52:55], 0
    s_add_u32 m0, s50, 62464
    v_max3_f32 v252, v176, v177, v178
    v_max3_f32 v253, v179, v184, v185
    v_mfma_f32_16x16x32_bf16 v[92:95], v[248:251], v[52:55], 0
    v_max3_f32 v252, v252, v186, v187
    v_max3_f32 v253, v253, v16, v17
    v_mfma_f32_16x16x32_bf16 v[156:159], a[96:99], v[68:71], v[156:159]
    v_max3_f32 v252, v252, v18, v19
    v_max3_f32 v253, v253, v20, v21
    v_mfma_f32_16x16x32_bf16 v[76:79], a[100:103], v[68:71], v[76:79]
    v_max3_f32 v252, v252, v22, v23
    v_max3_f32 v253, v253, v28, v29
    v_mfma_f32_16x16x32_bf16 v[92:95], v[248:251], v[68:71], v[92:95]
    v_max3_f32 v252, v252, v30, v31
    v_max3_f32 v253, v253, v116, v117
    v_mfma_f32_16x16x32_bf16 v[156:159], a[104:107], v[84:87], v[156:159]
    v_max3_f32 v252, v252, v118, v119
    v_max3_f32 v253, v253, v120, v121
    v_mfma_f32_16x16x32_bf16 v[76:79], a[108:111], v[84:87], v[76:79]
    v_max3_f32 v252, v252, v122, v123
    v_max3_f32 v253, v253, v144, v145
    v_mfma_f32_16x16x32_bf16 v[92:95], v[248:251], v[84:87], v[92:95]
    v_max3_f32 v252, v252, v146, v147
    v_max3_f32 v253, v253, v152, v153
    v_mfma_f32_16x16x32_bf16 v[156:159], a[112:115], v[32:35], v[156:159]
    v_max3_f32 v252, v252, v154, v155
    v_max3_f32 v253, v253, v212, v213
    v_mfma_f32_16x16x32_bf16 v[76:79], a[116:119], v[32:35], v[76:79]
    v_max3_f32 v252, v252, v214, v215
    v_max3_f32 v253, v253, v220, v221
    v_mfma_f32_16x16x32_bf16 v[92:95], v[248:251], v[32:35], v[92:95]
    v_max3_f32 v252, v252, v222, v223
    v_max3_f32 v253, v253, v180, v181
    v_mfma_f32_16x16x32_bf16 v[156:159], a[120:123], v[48:51], v[156:159]
    v_max3_f32 v252, v252, v182, v183
    v_max3_f32 v253, v253, v188, v189
    v_mfma_f32_16x16x32_bf16 v[76:79], a[124:127], v[48:51], v[76:79]
    v_max3_f32 v252, v252, v190, v191
    v_max3_f32 v253, v253, v60, v61
    v_mfma_f32_16x16x32_bf16 v[92:95], v[248:251], v[48:51], v[92:95]
    v_max3_f32 v252, v252, v62, v63
    v_max3_f32 v253, v253, v24, v25
    v_mfma_f32_16x16x32_bf16 v[156:159], a[128:131], v[64:67], v[156:159]
    v_max3_f32 v252, v252, v26, v27
    v_max3_f32 v253, v253, v148, v149
    v_mfma_f32_16x16x32_bf16 v[76:79], a[132:135], v[64:67], v[76:79]
    v_max3_f32 v252, v252, v150, v151
    v_max_f32 v252, v252, v253
    v_mov_b32 v253, v252
    v_mfma_f32_16x16x32_bf16 v[92:95], v[248:251], v[64:67], v[92:95]
    s_nop 0
    v_permlane16_swap_b32 v252, v253
    v_max_f32 v252, v252, v253
    v_mov_b32 v253, v252
    v_mov_b32 v216, 0
    v_mov_b32 v217, 0
    v_permlane32_swap_b32 v252, v253
    v_max_f32 v252, v252, v253
    v_pk_add_f32 v[148:149], v[148:149], v[252:253] op_sel_hi:[1,0] neg_lo:[0,1] neg_hi:[0,1]
    v_pk_add_f32 v[150:151], v[150:151], v[252:253] op_sel_hi:[1,0] neg_lo:[0,1] neg_hi:[0,1]
    v_mfma_f32_16x16x32_bf16 v[156:159], a[136:139], v[80:83], v[156:159]
    v_exp_f32 v148, v148
    v_mfma_f32_16x16x32_bf16 v[76:79], a[140:143], v[80:83], v[76:79]
    v_exp_f32 v149, v149
    v_exp_f32 v150, v150
    v_exp_f32 v151, v151
    s_getpc_b64 s[20:21]
F_pc_27:
    s_and_b32 s21, s21, 0xffff
    s_mov_b32 s22, CODE_END - F_pc_27
    s_lshr_b32 s53, s2, 3
    s_lshl_b32 s53, s53, 2
    s_add_u32 s53, s53, s40
    s_lshl_b32 s53, s53, 9
    s_mov_b64 exec, 0x1010101
    buffer_load_dword a255, v208, s[20:23], s53 offen
    s_mov_b64 exec, -1
    buffer_load_dword v227, v230, s[36:39], s71 offen sc1
    v_pk_add_f32 v[176:177], v[176:177], v[252:253] op_sel_hi:[1,0] neg_lo:[0,1] neg_hi:[0,1]
    v_pk_add_f32 v[178:179], v[178:179], v[252:253] op_sel_hi:[1,0] neg_lo:[0,1] neg_hi:[0,1]
    v_mfma_f32_16x16x32_bf16 v[92:95], v[248:251], v[80:83], v[92:95]
    v_exp_f32 v176, v176
    v_mfma_f32_16x16x32_bf16 v[156:159], a[144:147], v[112:115], v[156:159]
    v_exp_f32 v177, v177
    v_exp_f32 v178, v178
    v_exp_f32 v179, v179
    buffer_load_dwordx4 v209, s[28:31], s46 offen lds
    v_cvt_pk_bf16_f32 v151, v150, v151
    v_cvt_pk_bf16_f32 v150, v148, v149
    v_bfi_b32 v218, v254, 0, v150
    v_bfi_b32 v219, v255, 0, v151
    v_xor_b32 v150, v150, v218
    v_xor_b32 v151, v151, v219
    v_pk_add_f32 v[184:185], v[184:185], v[252:253] op_sel_hi:[1,0] neg_lo:[0,1] neg_hi:[0,1]
    v_pk_add_f32 v[186:187], v[186:187], v[252:253] op_sel_hi:[1,0] neg_lo:[0,1] neg_hi:[0,1]
    v_mfma_f32_16x16x32_bf16 v[76:79], a[148:151], v[112:115], v[76:79]
    v_exp_f32 v184, v184
    v_mfma_f32_16x16x32_bf16 v[92:95], v[248:251], v[112:115], v[92:95]
    v_exp_f32 v185, v185
    v_exp_f32 v186, v186
    v_exp_f32 v187, v187
    v_pk_add_f32 v[16:17], v[16:17], v[252:253] op_sel_hi:[1,0] neg_lo:[0,1] neg_hi:[0,1]
    v_pk_add_f32 v[18:19], v[18:19], v[252:253] op_sel_hi:[1,0] neg_lo:[0,1] neg_hi:[0,1]
    v_mfma_f32_16x16x32_bf16 v[156:159], a[152:155], v[36:39], v[156:159]
    v_exp_f32 v16, v16
    v_mfma_f32_16x16x32_bf16 v[76:79], a[156:159], v[36:39], v[76:79]
    v_exp_f32 v17, v17
    v_exp_f32 v18, v18
    v_exp_f32 v19, v19
    buffer_load_dwordx4 v210, s[28:31], s46 offen offset:1024 lds
    v_pk_add_f32 v[20:21], v[20:21], v[252:253] op_sel_hi:[1,0] neg_lo:[0,1] neg_hi:[0,1]
    v_pk_add_f32 v[22:23], v[22:23], v[252:253] op_sel_hi:[1,0] neg_lo:[0,1] neg_hi:[0,1]
    v_mfma_f32_16x16x32_bf16 v[92:95], v[248:251], v[36:39], v[92:95]
    s_cmp_le_u32 s45, 2
    s_cselect_b32 s79, 262144, 0
    v_exp_f32 v20, v20
    v_mfma_f32_16x16x32_bf16 v[40:43], a[88:91], v[216:219], 0
    s_add_u32 s46, s48, s79
    v_exp_f32 v21, v21
    v_exp_f32 v22, v22
    v_exp_f32 v23, v23
    v_cvt_pk_bf16_f32 v176, v176, v177
    v_cvt_pk_bf16_f32 v177, v178, v179
    v_cvt_pk_bf16_f32 v178, v184, v185
    v_cvt_pk_bf16_f32 v179, v186, v187
    v_pk_add_f32 v[28:29], v[28:29], v[252:253] op_sel_hi:[1,0] neg_lo:[0,1] neg_hi:[0,1]
    v_pk_add_f32 v[30:31], v[30:31], v[252:253] op_sel_hi:[1,0] neg_lo:[0,1] neg_hi:[0,1]
    v_mfma_f32_16x16x32_bf16 v[56:59], a[92:95], v[216:219], 0
    s_add_u32 s46, s46, 458752
    v_exp_f32 v28, v28
    v_mfma_f32_16x16x32_bf16 v[72:75], v[248:251], v[216:219], 0
    s_add_u32 m0, s50, 87040
    v_exp_f32 v29, v29
    v_exp_f32 v30, v30
    v_exp_f32 v31, v31
    v_rcp_f32 v92, v92
    s_nop 0
    v_mul_f32 v156, v156, v92
    v_mul_f32 v157, v157, v92
    v_mul_f32 v158, v158, v92
    v_mul_f32 v159, v159, v92
    v_mul_f32 v76, v76, v92
    v_mul_f32 v77, v77, v92
    v_mul_f32 v78, v78, v92
    v_mul_f32 v79, v79, v92
    v_cvt_pk_bf16_f32 v156, v156, v157
    v_cvt_pk_bf16_f32 v157, v158, v159
    v_cvt_pk_bf16_f32 v158, v76, v77
    v_cvt_pk_bf16_f32 v159, v78, v79
    buffer_store_dwordx4 v[156:159], v208, s[36:39], s77 offen offset:2048 sc1
    v_pk_add_f32 v[116:117], v[116:117], v[252:253] op_sel_hi:[1,0] neg_lo:[0,1] neg_hi:[0,1]
    v_pk_add_f32 v[118:119], v[118:119], v[252:253] op_sel_hi:[1,0] neg_lo:[0,1] neg_hi:[0,1]
    v_mfma_f32_16x16x32_bf16 v[40:43], a[96:99], v[176:179], v[40:43]
    v_exp_f32 v116, v116
    v_mfma_f32_16x16x32_bf16 v[56:59], a[100:103], v[176:179], v[56:59]
    v_exp_f32 v117, v117
    v_exp_f32 v118, v118
    v_exp_f32 v119, v119
    buffer_load_dwordx4 v209, s[28:31], s46 offen lds
    v_cvt_pk_bf16_f32 v16, v16, v17
    v_cvt_pk_bf16_f32 v17, v18, v19
    v_cvt_pk_bf16_f32 v18, v20, v21
    v_cvt_pk_bf16_f32 v19, v22, v23
    v_pk_add_f32 v[120:121], v[120:121], v[252:253] op_sel_hi:[1,0] neg_lo:[0,1] neg_hi:[0,1]
    v_pk_add_f32 v[122:123], v[122:123], v[252:253] op_sel_hi:[1,0] neg_lo:[0,1] neg_hi:[0,1]
    v_mfma_f32_16x16x32_bf16 v[72:75], v[248:251], v[176:179], v[72:75]
    v_exp_f32 v120, v120
    v_mfma_f32_16x16x32_bf16 v[40:43], a[104:107], v[16:19], v[40:43]
    v_exp_f32 v121, v121
    v_exp_f32 v122, v122
    v_exp_f32 v123, v123
    v_pk_add_f32 v[144:145], v[144:145], v[252:253] op_sel_hi:[1,0] neg_lo:[0,1] neg_hi:[0,1]
    v_pk_add_f32 v[146:147], v[146:147], v[252:253] op_sel_hi:[1,0] neg_lo:[0,1] neg_hi:[0,1]
    v_mfma_f32_16x16x32_bf16 v[56:59], a[108:111], v[16:19], v[56:59]
    v_exp_f32 v144, v144
    v_mfma_f32_16x16x32_bf16 v[72:75], v[248:251], v[16:19], v[72:75]
    v_exp_f32 v145, v145
    v_exp_f32 v146, v146
    v_exp_f32 v147, v147
    s_waitcnt vmcnt(4)
    s_mov_b32 s83, 0x40000
F_sp_28:
    v_cmp_ne_u32 vcc, 0, v227
    s_and_b32 s53, vcc_lo, 0xff00
    s_cmp_eq_u32 s53, 0xff00
    s_cbranch_scc1 F_ok_29
    buffer_load_dword v227, v230, s[36:39], s71 offen sc1
    s_sub_u32 s83, s83, 1
    s_waitcnt vmcnt(0)
    s_cbranch_scc0 F_sp_28
F_ok_29:
    v_cvt_pk_bf16_f32 v28, v28, v29
    v_cvt_pk_bf16_f32 v29, v30, v31
    v_cvt_pk_bf16_f32 v30, v116, v117
    v_cvt_pk_bf16_f32 v31, v118, v119
    v_pk_add_f32 v[152:153], v[152:153], v[252:253] op_sel_hi:[1,0] neg_lo:[0,1] neg_hi:[0,1]
    v_pk_add_f32 v[154:155], v[154:155], v[252:253] op_sel_hi:[1,0] neg_lo:[0,1] neg_hi:[0,1]
    v_mfma_f32_16x16x32_bf16 v[40:43], a[112:115], v[28:31], v[40:43]
    v_exp_f32 v152, v152
    v_mfma_f32_16x16x32_bf16 v[56:59], a[116:119], v[28:31], v[56:59]
    v_exp_f32 v153, v153
    v_exp_f32 v154, v154
    v_exp_f32 v155, v155
    buffer_load_dwordx4 a[160:163], v208, s[36:39], s51 offen offset:0 sc1
    v_pk_add_f32 v[212:213], v[212:213], v[252:253] op_sel_hi:[1,0] neg_lo:[0,1] neg_hi:[0,1]
    v_pk_add_f32 v[214:215], v[214:215], v[252:253] op_sel_hi:[1,0] neg_lo:[0,1] neg_hi:[0,1]
    v_mfma_f32_16x16x32_bf16 v[72:75], v[248:251], v[28:31], v[72:75]
    v_exp_f32 v212, v212
    v_exp_f32 v213, v213
    v_exp_f32 v214, v214
    v_exp_f32 v215, v215
    buffer_load_dwordx4 a[164:167], v208, s[36:39], s51 offen offset:1024 sc1
    v_cvt_pk_bf16_f32 v120, v120, v121
    v_cvt_pk_bf16_f32 v121, v122, v123
    v_cvt_pk_bf16_f32 v122, v144, v145
    v_cvt_pk_bf16_f32 v123, v146, v147
    v_pk_add_f32 v[220:221], v[220:221], v[252:253] op_sel_hi:[1,0] neg_lo:[0,1] neg_hi:[0,1]
    v_pk_add_f32 v[222:223], v[222:223], v[252:253] op_sel_hi:[1,0] neg_lo:[0,1] neg_hi:[0,1]
    v_mfma_f32_16x16x32_bf16 v[40:43], a[120:123], v[120:123], v[40:43]
    v_exp_f32 v220, v220
    v_mfma_f32_16x16x32_bf16 v[56:59], a[124:127], v[120:123], v[56:59]
    v_exp_f32 v221, v221
    v_exp_f32 v222, v222
    v_exp_f32 v223, v223
    buffer_load_dwordx4 a[168:171], v208, s[36:39], s51 offen offset:2048 sc1
    v_pk_add_f32 v[180:181], v[180:181], v[252:253] op_sel_hi:[1,0] neg_lo:[0,1] neg_hi:[0,1]
    v_pk_add_f32 v[182:183], v[182:183], v[252:253] op_sel_hi:[1,0] neg_lo:[0,1] neg_hi:[0,1]
    v_mfma_f32_16x16x32_bf16 v[72:75], v[248:251], v[120:123], v[72:75]
    v_exp_f32 v180, v180
    v_exp_f32 v181, v181
    v_exp_f32 v182, v182
    v_exp_f32 v183, v183
    buffer_load_dwordx4 a[172:175], v208, s[36:39], s51 offen offset:3072 sc1
    v_cvt_pk_bf16_f32 v152, v152, v153
    v_cvt_pk_bf16_f32 v153, v154, v155
    v_cvt_pk_bf16_f32 v154, v212, v213
    v_cvt_pk_bf16_f32 v155, v214, v215
    v_pk_add_f32 v[188:189], v[188:189], v[252:253] op_sel_hi:[1,0] neg_lo:[0,1] neg_hi:[0,1]
    v_pk_add_f32 v[190:191], v[190:191], v[252:253] op_sel_hi:[1,0] neg_lo:[0,1] neg_hi:[0,1]
    v_mfma_f32_16x16x32_bf16 v[40:43], a[128:131], v[152:155], v[40:43]
    s_add_u32 s51, s51, 4096
    v_exp_f32 v188, v188
    v_mfma_f32_16x16x32_bf16 v[56:59], a[132:135], v[152:155], v[56:59]
    v_exp_f32 v189, v189
    v_exp_f32 v190, v190
    v_exp_f32 v191, v191
    buffer_load_dwordx4 a[176:179], v208, s[36:39], s51 offen offset:0 sc1
    v_pk_add_f32 v[60:61], v[60:61], v[252:253] op_sel_hi:[1,0] neg_lo:[0,1] neg_hi:[0,1]
    v_pk_add_f32 v[62:63], v[62:63], v[252:253] op_sel_hi:[1,0] neg_lo:[0,1] neg_hi:[0,1]
    v_mfma_f32_16x16x32_bf16 v[72:75], v[248:251], v[152:155], v[72:75]
    v_exp_f32 v60, v60
    v_exp_f32 v61, v61
    v_exp_f32 v62, v62
    v_exp_f32 v63, v63
    buffer_load_dwordx4 a[180:183], v208, s[36:39], s51 offen offset:1024 sc1
    v_cvt_pk_bf16_f32 v220, v220, v221
    v_cvt_pk_bf16_f32 v221, v222, v223
    v_cvt_pk_bf16_f32 v222, v180, v181
    v_cvt_pk_bf16_f32 v223, v182, v183
    v_pk_add_f32 v[24:25], v[24:25], v[252:253] op_sel_hi:[1,0] neg_lo:[0,1] neg_hi:[0,1]
    v_pk_add_f32 v[26:27], v[26:27], v[252:253] op_sel_hi:[1,0] neg_lo:[0,1] neg_hi:[0,1]
    v_mfma_f32_16x16x32_bf16 v[40:43], a[136:139], v[220:223], v[40:43]
    v_exp_f32 v24, v24
    v_mfma_f32_16x16x32_bf16 v[56:59], a[140:143], v[220:223], v[56:59]
    v_exp_f32 v25, v25
    v_exp_f32 v26, v26
    v_exp_f32 v27, v27
    buffer_load_dwordx4 a[184:187], v208, s[36:39], s51 offen offset:2048 sc1
    v_cvt_pk_bf16_f32 v188, v188, v189
    v_cvt_pk_bf16_f32 v189, v190, v191
    v_cvt_pk_bf16_f32 v190, v60, v61
    v_cvt_pk_bf16_f32 v191, v62, v63
    v_cvt_pk_bf16_f32 v148, v24, v25
    v_cvt_pk_bf16_f32 v149, v26, v27
    buffer_load_dwordx4 v210, s[28:31], s46 offen offset:1024 lds
    s_nop 0
    s_add_u32 s46, s46, 65536
    s_nop 0
    v_mov_b32 v232, v231
    v_xor_b32 v233, 32, v231
    v_mfma_f32_16x16x32_bf16 v[72:75], v[248:251], v[220:223], v[72:75]
    buffer_load_dwordx4 a[188:191], v208, s[36:39], s51 offen offset:3072 sc1
    s_add_u32 s51, s51, 4096
    v_mfma_f32_16x16x32_bf16 v[40:43], a[144:147], v[188:191], v[40:43]
    v_xor_b32 v234, 64, v231
    v_xor_b32 v235, 96, v231
    v_mfma_f32_16x16x32_bf16 v[56:59], a[148:151], v[188:191], v[56:59]
    v_xor_b32 v236, 128, v231
    v_xor_b32 v237, 160, v231
    v_mfma_f32_16x16x32_bf16 v[72:75], v[248:251], v[188:191], v[72:75]
    v_xor_b32 v238, 192, v231
    v_xor_b32 v239, 224, v231
    v_mfma_f32_16x16x32_bf16 v[40:43], a[152:155], v[148:151], v[40:43]
    v_add_u32 v240, 57344, v232
    v_add_u32 v241, 57344, v233
    v_mfma_f32_16x16x32_bf16 v[56:59], a[156:159], v[148:151], v[56:59]
    v_add_u32 v242, 57344, v234
    v_add_u32 v243, 57344, v235
    v_mfma_f32_16x16x32_bf16 v[72:75], v[248:251], v[148:151], v[72:75]
    v_add_u32 v244, 57344, v236
    v_add_u32 v245, 57344, v237
    v_add_u32 v246, 57344, v238
    v_add_u32 v247, 57344, v239
    s_barrier
    ds_read_b64_tr_b16 a[208:209], v232 offset:1024
    ds_read_b64_tr_b16 a[210:211], v232 offset:2048
    ds_read_b64_tr_b16 a[212:213], v232 offset:29696
    ds_read_b64_tr_b16 a[214:215], v232 offset:30720
    ds_read_b64_tr_b16 a[216:217], v240 offset:1024
    ds_read_b64_tr_b16 a[218:219], v240 offset:2048
    ds_read_b64_tr_b16 a[220:221], v233 offset:1024
    ds_read_b64_tr_b16 a[222:223], v233 offset:2048
    ds_read_b64_tr_b16 a[224:225], v233 offset:29696
    ds_read_b64_tr_b16 a[226:227], v233 offset:30720
    ds_read_b64_tr_b16 a[228:229], v241 offset:1024
    ds_read_b64_tr_b16 a[230:231], v241 offset:2048
    s_waitcnt lgkmcnt(6)
    v_mfma_f32_16x16x32_bf16 v[0:3], a[208:211], v[96:99], 0
    ds_read_b64_tr_b16 a[232:233], v234 offset:1024
    v_mfma_f32_16x16x32_bf16 v[0:3], a[212:215], v[128:131], v[0:3]
    ds_read_b64_tr_b16 a[234:235], v234 offset:2048
    v_mfma_f32_16x16x32_bf16 v[0:3], a[216:219], v[160:163], v[0:3]
    buffer_load_dwordx4 a[192:195], v208, s[36:39], s51 offen offset:0 sc1
    v_mfma_f32_16x16x32_bf16 v[4:7], a[208:211], v[100:103], 0
    v_mfma_f32_16x16x32_bf16 v[4:7], a[212:215], v[132:135], v[4:7]
    ds_read_b64_tr_b16 a[236:237], v234 offset:29696
    v_mfma_f32_16x16x32_bf16 v[4:7], a[216:219], v[164:167], v[4:7]
    ds_read_b64_tr_b16 a[238:239], v234 offset:30720
    v_mfma_f32_16x16x32_bf16 v[8:11], a[208:211], v[104:107], 0
    v_rcp_f32 v72, v72
    s_nop 0
    v_mfma_f32_16x16x32_bf16 v[8:11], a[212:215], v[136:139], v[8:11]
    v_mul_f32 v40, v40, v72
    v_mul_f32 v41, v41, v72
    v_mfma_f32_16x16x32_bf16 v[8:11], a[216:219], v[168:171], v[8:11]
    ds_read_b64_tr_b16 a[240:241], v242 offset:1024
    v_mul_f32 v42, v42, v72
    v_mfma_f32_16x16x32_bf16 v[12:15], a[208:211], v[108:111], 0
    ds_read_b64_tr_b16 a[242:243], v242 offset:2048
    v_mul_f32 v43, v43, v72
    v_mfma_f32_16x16x32_bf16 v[12:15], a[212:215], v[140:143], v[12:15]
    buffer_load_dwordx4 a[196:199], v208, s[36:39], s51 offen offset:1024 sc1
    v_mfma_f32_16x16x32_bf16 v[12:15], a[216:219], v[172:175], v[12:15]
    s_waitcnt lgkmcnt(6)
    v_mul_f32 v56, v56, v72
    v_mul_f32 v57, v57, v72
    v_mfma_f32_16x16x32_bf16 v[28:31], a[220:223], v[108:111], 0
    ds_read_b64_tr_b16 a[244:245], v235 offset:1024
    v_mul_f32 v58, v58, v72
    v_mfma_f32_16x16x32_bf16 v[28:31], a[224:227], v[140:143], v[28:31]
    ds_read_b64_tr_b16 a[246:247], v235 offset:2048
    v_mul_f32 v59, v59, v72
    v_mfma_f32_16x16x32_bf16 v[28:31], a[228:231], v[172:175], v[28:31]
    buffer_load_dwordx4 a[200:203], v208, s[36:39], s51 offen offset:2048 sc1
    v_mfma_f32_16x16x32_bf16 v[24:27], a[220:223], v[104:107], 0
    v_cvt_pk_bf16_f32 v40, v40, v41
    v_cvt_pk_bf16_f32 v41, v42, v43
    v_mfma_f32_16x16x32_bf16 v[24:27], a[224:227], v[136:139], v[24:27]
    ds_read_b64_tr_b16 a[208:209], v235 offset:29696
    v_cvt_pk_bf16_f32 v42, v56, v57
    v_mfma_f32_16x16x32_bf16 v[24:27], a[228:231], v[168:171], v[24:27]
    ds_read_b64_tr_b16 a[210:211], v235 offset:30720
    v_cvt_pk_bf16_f32 v43, v58, v59
    v_mfma_f32_16x16x32_bf16 v[20:23], a[220:223], v[100:103], 0
    buffer_load_dwordx4 a[204:207], v208, s[36:39], s51 offen offset:3072 sc1
    v_mfma_f32_16x16x32_bf16 v[20:23], a[224:227], v[132:135], v[20:23]
    s_add_u32 s51, s51, 4096
    s_cmp_eq_u32 s51, s80
    s_cselect_b32 s51, s78, s51
    v_mfma_f32_16x16x32_bf16 v[20:23], a[228:231], v[164:167], v[20:23]
    ds_read_b64_tr_b16 a[212:213], v243 offset:1024
    v_mfma_f32_16x16x32_bf16 v[16:19], a[220:223], v[96:99], 0
    s_add_u32 m0, s50, 89088
    ds_read_b64_tr_b16 a[214:215], v243 offset:2048
    v_mfma_f32_16x16x32_bf16 v[16:19], a[224:227], v[128:131], v[16:19]
    buffer_load_dwordx4 v209, s[28:31], s46 offen lds
    v_mfma_f32_16x16x32_bf16 v[16:19], a[228:231], v[160:163], v[16:19]
    s_waitcnt lgkmcnt(6)
    buffer_store_dwordx4 v[40:43], v208, s[36:39], s77 offen offset:3072 sc1
    v_mfma_f32_16x16x32_bf16 v[32:35], a[232:235], v[96:99], 0
    ds_read_b64_tr_b16 a[216:217], v236 offset:1024
    v_add_u32 v248, 114688, v232
    v_mfma_f32_16x16x32_bf16 v[32:35], a[236:239], v[128:131], v[32:35]
    ds_read_b64_tr_b16 a[218:219], v236 offset:2048
    v_add_u32 v249, 114688, v233
    v_mfma_f32_16x16x32_bf16 v[32:35], a[240:243], v[160:163], v[32:35]
    buffer_load_dwordx4 v210, s[28:31], s46 offen offset:1024 lds
    v_mfma_f32_16x16x32_bf16 v[36:39], a[232:235], v[100:103], 0
    s_add_u32 s46, s46, 65536
    v_add_u32 v250, 114688, v234
    v_add_u32 v251, 114688, v235
    v_mfma_f32_16x16x32_bf16 v[36:39], a[236:239], v[132:135], v[36:39]
    ds_read_b64_tr_b16 a[220:221], v236 offset:29696
    v_add_u32 v252, 114688, v236
    v_mfma_f32_16x16x32_bf16 v[36:39], a[240:243], v[164:167], v[36:39]
    ds_read_b64_tr_b16 a[222:223], v236 offset:30720
    v_add_u32 v253, 114688, v237
    v_mfma_f32_16x16x32_bf16 v[44:47], a[232:235], v[104:107], 0
    v_add_u32 v254, 114688, v238
    v_add_u32 v255, 114688, v239
    v_mfma_f32_16x16x32_bf16 v[44:47], a[236:239], v[136:139], v[44:47]
    s_mov_b32 s20, s10
    s_and_b32 s21, s11, 0xffff
    s_mov_b32 s22, 0x400000
    v_mfma_f32_16x16x32_bf16 v[44:47], a[240:243], v[168:171], v[44:47]
    s_mov_b32 s23, 0x00020000
    ds_read_b64_tr_b16 a[224:225], v244 offset:1024
    s_mov_b32 s24, s16
    v_mfma_f32_16x16x32_bf16 v[48:51], a[232:235], v[108:111], 0
    s_and_b32 s25, s17, 0xffff
    ds_read_b64_tr_b16 a[226:227], v244 offset:2048
    s_mov_b32 s26, 0x400000
    v_mfma_f32_16x16x32_bf16 v[48:51], a[236:239], v[140:143], v[48:51]
    s_mov_b32 s27, 0x00020000
    buffer_load_dwordx4 a[0:3], v208, s[36:39], s51 offen offset:0 sc1
    v_mfma_f32_16x16x32_bf16 v[48:51], a[240:243], v[172:175], v[48:51]
    s_waitcnt lgkmcnt(6)
    v_lshlrev_b32 v207, 3, v224
    s_xor_b32 s54, s2, 6
    v_mfma_f32_16x16x32_bf16 v[68:71], a[244:247], v[108:111], 0
    s_lshl_b32 s54, s54, 2
    ds_read_b64_tr_b16 a[228:229], v237 offset:1024
    s_add_u32 s54, s54, s40
    v_mfma_f32_16x16x32_bf16 v[68:71], a[208:211], v[140:143], v[68:71]
    s_mul_i32 s66, s54, 12288
    ds_read_b64_tr_b16 a[230:231], v237 offset:2048
    s_add_u32 s66, s66, 0x2300000
    v_mfma_f32_16x16x32_bf16 v[68:71], a[212:215], v[172:175], v[68:71]
    s_lshl_b32 s69, s54, 7
    buffer_load_dwordx4 a[4:7], v208, s[36:39], s51 offen offset:1024 sc1
    v_mfma_f32_16x16x32_bf16 v[64:67], a[244:247], v[104:107], 0
    s_add_u32 s69, s69, 0x2f00000
    s_xor_b32 s54, s2, 4
    s_lshl_b32 s54, s54, 2
    v_mfma_f32_16x16x32_bf16 v[64:67], a[208:211], v[136:139], v[64:67]
    s_add_u32 s54, s54, s40
    ds_read_b64_tr_b16 a[232:233], v237 offset:29696
    s_mul_i32 s67, s54, 12288
    v_mfma_f32_16x16x32_bf16 v[64:67], a[212:215], v[168:171], v[64:67]
    s_add_u32 s67, s67, 0x2301000
    ds_read_b64_tr_b16 a[234:235], v237 offset:30720
    s_lshl_b32 s70, s54, 7
    v_mfma_f32_16x16x32_bf16 v[60:63], a[244:247], v[100:103], 0
    s_add_u32 s70, s70, 0x2f00004
    buffer_load_dwordx4 a[8:11], v208, s[36:39], s51 offen offset:2048 sc1
    v_mfma_f32_16x16x32_bf16 v[60:63], a[208:211], v[132:135], v[60:63]
    s_xor_b32 s54, s2, 2
    s_lshl_b32 s54, s54, 2
    s_add_u32 s54, s54, s40
    v_mfma_f32_16x16x32_bf16 v[60:63], a[212:215], v[164:167], v[60:63]
    s_mul_i32 s68, s54, 12288
    ds_read_b64_tr_b16 a[236:237], v245 offset:1024
    s_add_u32 s68, s68, 0x2302000
    v_mfma_f32_16x16x32_bf16 v[52:55], a[244:247], v[96:99], 0
    s_lshl_b32 s72, s54, 7
    ds_read_b64_tr_b16 a[238:239], v245 offset:2048
    s_add_u32 s72, s72, 0x2f00008
    v_mfma_f32_16x16x32_bf16 v[52:55], a[208:211], v[128:131], v[52:55]
    s_lshl_b32 s54, s2, 2
    s_add_u32 s54, s54, s40
    s_mul_i32 s73, s54, 12288
    v_mfma_f32_16x16x32_bf16 v[52:55], a[212:215], v[160:163], v[52:55]
    s_waitcnt lgkmcnt(6)
    s_add_u32 s73, s73, 0x2300000
    v_mfma_f32_16x16x32_bf16 v[76:79], a[216:219], v[96:99], 0
    ds_read_b64_tr_b16 a[240:241], v238 offset:1024
    v_mfma_f32_16x16x32_bf16 v[76:79], a[220:223], v[128:131], v[76:79]
    ds_read_b64_tr_b16 a[242:243], v238 offset:2048
    v_mfma_f32_16x16x32_bf16 v[76:79], a[224:227], v[160:163], v[76:79]
    buffer_load_dwordx4 a[12:15], v208, s[36:39], s51 offen offset:3072 sc1
    v_mfma_f32_16x16x32_bf16 v[80:83], a[216:219], v[100:103], 0
    s_add_u32 s51, s51, 4096
    v_mfma_f32_16x16x32_bf16 v[80:83], a[220:223], v[132:135], v[80:83]
    ds_read_b64_tr_b16 a[244:245], v238 offset:29696
    v_mfma_f32_16x16x32_bf16 v[80:83], a[224:227], v[164:167], v[80:83]
    s_add_u32 m0, s50, 91136
    ds_read_b64_tr_b16 a[246:247], v238 offset:30720
    v_mfma_f32_16x16x32_bf16 v[84:87], a[216:219], v[104:107], 0
    buffer_load_dwordx4 v209, s[28:31], s46 offen lds
    v_mfma_f32_16x16x32_bf16 v[84:87], a[220:223], v[136:139], v[84:87]
    v_mfma_f32_16x16x32_bf16 v[84:87], a[224:227], v[168:171], v[84:87]
    ds_read_b64_tr_b16 a[208:209], v246 offset:1024
    v_mfma_f32_16x16x32_bf16 v[88:91], a[216:219], v[108:111], 0
    ds_read_b64_tr_b16 a[210:211], v246 offset:2048
    v_mfma_f32_16x16x32_bf16 v[88:91], a[220:223], v[140:143], v[88:91]
    buffer_load_dwordx4 v210, s[28:31], s46 offen offset:1024 lds
    v_mfma_f32_16x16x32_bf16 v[88:91], a[224:227], v[172:175], v[88:91]
    s_waitcnt lgkmcnt(6)
    s_cmp_le_u32 s45, 3
    s_cselect_b32 s79, 196608, 0
    v_mfma_f32_16x16x32_bf16 v[120:123], a[228:231], v[108:111], 0
    s_add_u32 s46, s48, s79
    ds_read_b64_tr_b16 a[212:213], v239 offset:1024
    s_add_u32 s46, s46, 720896
    v_mfma_f32_16x16x32_bf16 v[120:123], a[232:235], v[140:143], v[120:123]
    ds_read_b64_tr_b16 a[214:215], v239 offset:2048
    v_mfma_f32_16x16x32_bf16 v[120:123], a[236:239], v[172:175], v[120:123]
    v_mfma_f32_16x16x32_bf16 v[116:119], a[228:231], v[104:107], 0
    v_mfma_f32_16x16x32_bf16 v[116:119], a[232:235], v[136:139], v[116:119]
    ds_read_b64_tr_b16 a[216:217], v239 offset:29696
    v_mfma_f32_16x16x32_bf16 v[116:119], a[236:239], v[168:171], v[116:119]
    ds_read_b64_tr_b16 a[218:219], v239 offset:30720
    v_mfma_f32_16x16x32_bf16 v[112:115], a[228:231], v[100:103], 0
    buffer_load_dwordx4 a[16:19], v208, s[36:39], s51 offen offset:0 sc1
    v_mfma_f32_16x16x32_bf16 v[112:115], a[232:235], v[132:135], v[112:115]
    v_mfma_f32_16x16x32_bf16 v[112:115], a[236:239], v[164:167], v[112:115]
    ds_read_b64_tr_b16 a[220:221], v247 offset:1024
    v_mfma_f32_16x16x32_bf16 v[92:95], a[228:231], v[96:99], 0
    ds_read_b64_tr_b16 a[222:223], v247 offset:2048
    v_mfma_f32_16x16x32_bf16 v[92:95], a[232:235], v[128:131], v[92:95]
    buffer_load_dwordx4 a[20:23], v208, s[36:39], s51 offen offset:1024 sc1
    v_mfma_f32_16x16x32_bf16 v[92:95], a[236:239], v[160:163], v[92:95]
    s_waitcnt lgkmcnt(6)
    v_mfma_f32_16x16x32_bf16 v[124:127], a[240:243], v[96:99], 0
    ds_read_b64_tr_b16 a[224:225], v232 offset:3072
    v_mfma_f32_16x16x32_bf16 v[124:127], a[244:247], v[128:131], v[124:127]
    ds_read_b64_tr_b16 a[226:227], v232 offset:4096
    v_mfma_f32_16x16x32_bf16 v[124:127], a[208:211], v[160:163], v[124:127]
    buffer_load_dwordx4 a[24:27], v208, s[36:39], s51 offen offset:2048 sc1
    v_mfma_f32_16x16x32_bf16 v[144:147], a[240:243], v[100:103], 0
    v_mfma_f32_16x16x32_bf16 v[144:147], a[244:247], v[132:135], v[144:147]
    ds_read_b64_tr_b16 a[228:229], v232 offset:31744
    v_mfma_f32_16x16x32_bf16 v[144:147], a[208:211], v[164:167], v[144:147]
    ds_read_b64_tr_b16 a[230:231], v232 offset:32768
    v_mfma_f32_16x16x32_bf16 v[148:151], a[240:243], v[104:107], 0
    buffer_load_dwordx4 a[28:31], v208, s[36:39], s51 offen offset:3072 sc1
    v_mfma_f32_16x16x32_bf16 v[148:151], a[244:247], v[136:139], v[148:151]
    s_add_u32 s51, s51, 4096
    v_mfma_f32_16x16x32_bf16 v[148:151], a[208:211], v[168:171], v[148:151]
    ds_read_b64_tr_b16 a[232:233], v233 offset:3072
    v_mfma_f32_16x16x32_bf16 v[152:155], a[240:243], v[108:111], 0
    s_add_u32 m0, s50, 115712
    ds_read_b64_tr_b16 a[234:235], v233 offset:4096
    v_mfma_f32_16x16x32_bf16 v[152:155], a[244:247], v[140:143], v[152:155]
    buffer_load_dwordx4 v209, s[28:31], s46 offen lds
    v_mfma_f32_16x16x32_bf16 v[152:155], a[208:211], v[172:175], v[152:155]
    s_waitcnt lgkmcnt(6)
    v_mfma_f32_16x16x32_bf16 v[184:187], a[212:215], v[108:111], 0
    ds_read_b64_tr_b16 a[236:237], v233 offset:31744
    v_mfma_f32_16x16x32_bf16 v[184:187], a[216:219], v[140:143], v[184:187]
    ds_read_b64_tr_b16 a[238:239], v233 offset:32768
    v_mfma_f32_16x16x32_bf16 v[184:187], a[220:223], v[172:175], v[184:187]
    buffer_load_dwordx4 v210, s[28:31], s46 offen offset:1024 lds
    v_mfma_f32_16x16x32_bf16 v[180:183], a[212:215], v[104:107], 0
    s_add_u32 s46, s46, 65536
    v_mfma_f32_16x16x32_bf16 v[180:183], a[216:219], v[136:139], v[180:183]
    ds_read_b64_tr_b16 a[240:241], v234 offset:3072
    v_mfma_f32_16x16x32_bf16 v[180:183], a[220:223], v[168:171], v[180:183]
    ds_read_b64_tr_b16 a[242:243], v234 offset:4096
    v_mfma_f32_16x16x32_bf16 v[176:179], a[212:215], v[100:103], 0
    v_mfma_f32_16x16x32_bf16 v[176:179], a[216:219], v[132:135], v[176:179]
    v_mfma_f32_16x16x32_bf16 v[176:179], a[220:223], v[164:167], v[176:179]
    ds_read_b64_tr_b16 a[244:245], v234 offset:31744
    v_mfma_f32_16x16x32_bf16 v[156:159], a[212:215], v[96:99], 0
    ds_read_b64_tr_b16 a[246:247], v234 offset:32768
    v_mfma_f32_16x16x32_bf16 v[156:159], a[216:219], v[128:131], v[156:159]
    buffer_load_dwordx4 a[32:35], v208, s[36:39], s51 offen offset:0 sc1
    v_mfma_f32_16x16x32_bf16 v[156:159], a[220:223], v[160:163], v[156:159]
    s_waitcnt vmcnt(20) lgkmcnt(8)
    v_mfma_f32_16x16x32_bf16 v[0:3], a[224:227], a[160:163], v[0:3]
    ds_read_b64_tr_b16 a[208:209], v235 offset:3072
    v_mfma_f32_16x16x32_bf16 v[0:3], a[228:231], a[176:179], v[0:3]
    ds_read_b64_tr_b16 a[210:211], v235 offset:4096
    v_mfma_f32_16x16x32_bf16 v[4:7], a[228:231], a[180:183], v[4:7]
    buffer_load_dwordx4 a[36:39], v208, s[36:39], s51 offen offset:1024 sc1
    v_mfma_f32_16x16x32_bf16 v[4:7], a[224:227], a[164:167], v[4:7]
    v_mfma_f32_16x16x32_bf16 v[8:11], a[224:227], a[168:171], v[8:11]
    ds_read_b64_tr_b16 a[212:213], v235 offset:31744
    v_mfma_f32_16x16x32_bf16 v[8:11], a[228:231], a[184:187], v[8:11]
    ds_read_b64_tr_b16 a[214:215], v235 offset:32768
    v_mfma_f32_16x16x32_bf16 v[12:15], a[228:231], a[188:191], v[12:15]
    buffer_load_dwordx4 a[40:43], v208, s[36:39], s51 offen offset:2048 sc1
    v_mfma_f32_16x16x32_bf16 v[12:15], a[224:227], a[172:175], v[12:15]
    s_waitcnt lgkmcnt(8)
    s_waitcnt vmcnt(16)
    buffer_store_dword v226, v229, s[36:39], 0 offen offset:64 sc1
    s_barrier
    v_mfma_f32_16x16x32_bf16 v[28:31], a[232:235], a[172:175], v[28:31]
    ds_read_b64_tr_b16 a[216:217], v236 offset:3072
    v_and_b32 v204, 15, v224
    v_mfma_f32_16x16x32_bf16 v[28:31], a[236:239], a[188:191], v[28:31]
    ds_read_b64_tr_b16 a[218:219], v236 offset:4096
    v_lshlrev_b32 v211, 11, v204
    v_mfma_f32_16x16x32_bf16 v[24:27], a[236:239], a[184:187], v[24:27]
    v_lshrrev_b32 v204, 4, v224
    v_lshl_add_u32 v206, v204, 3, v211
    v_mfma_f32_16x16x32_bf16 v[24:27], a[232:235], a[168:171], v[24:27]
    v_bfe_u32 v204, v224, 4, 1
    v_lshl_add_u32 v211, v204, 5, v211
    v_mfma_f32_16x16x32_bf16 v[20:23], a[232:235], a[164:167], v[20:23]
    ds_read_b64_tr_b16 a[220:221], v236 offset:31744
    v_lshrrev_b32 v204, 5, v224
    v_mfma_f32_16x16x32_bf16 v[20:23], a[236:239], a[180:183], v[20:23]
    ds_read_b64_tr_b16 a[222:223], v236 offset:32768
    v_lshl_add_u32 v211, v204, 4, v211
    v_mfma_f32_16x16x32_bf16 v[16:19], a[236:239], a[176:179], v[16:19]
    s_mul_i32 s54, s40, 5120
    buffer_load_dwordx4 a[44:47], v208, s[36:39], s51 offen offset:3072 sc1
    v_mfma_f32_16x16x32_bf16 v[16:19], a[232:235], a[160:163], v[16:19]
    s_waitcnt lgkmcnt(8)
    s_add_u32 s51, s51, 4096
    s_add_u32 s54, s54, 143360
    v_mfma_f32_16x16x32_bf16 v[32:35], a[240:243], a[160:163], v[32:35]
    s_cmp_eq_u32 s51, s80
    s_cselect_b32 s51, s78, s51
    ds_read_b64_tr_b16 a[224:225], v237 offset:3072
    v_mfma_f32_16x16x32_bf16 v[32:35], a[244:247], a[176:179], v[32:35]
    s_add_u32 m0, s50, 117760
    ds_read_b64_tr_b16 a[226:227], v237 offset:4096
    v_and_b32 v204, 15, v224
    v_mfma_f32_16x16x32_bf16 v[36:39], a[244:247], a[180:183], v[36:39]
    buffer_load_dwordx4 v209, s[28:31], s46 offen lds
    v_mfma_f32_16x16x32_bf16 v[36:39], a[240:243], a[164:167], v[36:39]
    v_mul_u32_u24 v228, 80, v204
    v_lshrrev_b32 v204, 4, v224
    v_mfma_f32_16x16x32_bf16 v[44:47], a[240:243], a[168:171], v[44:47]
    ds_read_b64_tr_b16 a[228:229], v237 offset:31744
    v_lshl_add_u32 v228, v204, 3, v228
    v_mfma_f32_16x16x32_bf16 v[44:47], a[244:247], a[184:187], v[44:47]
    ds_read_b64_tr_b16 a[230:231], v237 offset:32768
    v_add_u32 v228, s54, v228
    v_mfma_f32_16x16x32_bf16 v[48:51], a[244:247], a[188:191], v[48:51]
    buffer_load_dwordx4 v210, s[28:31], s46 offen offset:1024 lds
    v_mfma_f32_16x16x32_bf16 v[48:51], a[240:243], a[172:175], v[48:51]
    s_waitcnt lgkmcnt(8)
    s_add_u32 s46, s46, 65536
    v_lshrrev_b32 v204, 2, v224
    v_mfma_f32_16x16x32_bf16 v[68:71], a[208:211], a[172:175], v[68:71]
    ds_read_b64_tr_b16 a[232:233], v238 offset:3072
    v_mul_u32_u24 v231, 80, v204
    v_mfma_f32_16x16x32_bf16 v[68:71], a[212:215], a[188:191], v[68:71]
    ds_read_b64_tr_b16 a[234:235], v238 offset:4096
    v_lshlrev_b32 v211, 11, v204
    v_mfma_f32_16x16x32_bf16 v[64:67], a[212:215], a[184:187], v[64:67]
    buffer_load_dwordx4 a[48:51], v208, s[36:39], s51 offen offset:0 sc1
    v_mfma_f32_16x16x32_bf16 v[64:67], a[208:211], a[168:171], v[64:67]
    v_and_b32 v204, 3, v224
    v_lshl_add_u32 v231, v204, 4, v231
    v_mfma_f32_16x16x32_bf16 v[60:63], a[208:211], a[164:167], v[60:63]
    ds_read_b64_tr_b16 a[236:237], v238 offset:31744
    v_add_u32 v231, s54, v231
    v_mfma_f32_16x16x32_bf16 v[60:63], a[212:215], a[180:183], v[60:63]
    ds_read_b64_tr_b16 a[238:239], v238 offset:32768
    v_lshl_add_u32 v211, v204, 4, v211
    v_mfma_f32_16x16x32_bf16 v[52:55], a[212:215], a[176:179], v[52:55]
    buffer_load_dwordx4 a[52:55], v208, s[36:39], s51 offen offset:1024 sc1
    v_mfma_f32_16x16x32_bf16 v[52:55], a[208:211], a[160:163], v[52:55]
    s_waitcnt lgkmcnt(8)
    v_and_b32 v204, 15, v224
    v_lshlrev_b32 v206, 6, v204
    v_mfma_f32_16x16x32_bf16 v[76:79], a[216:219], a[160:163], v[76:79]
    ds_read_b64_tr_b16 a[240:241], v239 offset:3072
    v_lshrrev_b32 v204, 4, v224
    v_mfma_f32_16x16x32_bf16 v[76:79], a[220:223], a[176:179], v[76:79]
    ds_read_b64_tr_b16 a[242:243], v239 offset:4096
    v_lshl_add_u32 v206, v204, 3, v206
    v_mfma_f32_16x16x32_bf16 v[80:83], a[220:223], a[180:183], v[80:83]
    v_add_u32 v206, s54, v206
    v_mfma_f32_16x16x32_bf16 v[80:83], a[216:219], a[164:167], v[80:83]
    v_mfma_f32_16x16x32_bf16 v[84:87], a[216:219], a[168:171], v[84:87]
    ds_read_b64_tr_b16 a[244:245], v239 offset:31744
    v_mfma_f32_16x16x32_bf16 v[84:87], a[220:223], a[184:187], v[84:87]
    ds_read_b64_tr_b16 a[246:247], v239 offset:32768
    v_mfma_f32_16x16x32_bf16 v[88:91], a[220:223], a[188:191], v[88:91]
    buffer_load_dwordx4 a[56:59], v208, s[36:39], s51 offen offset:2048 sc1
    v_mfma_f32_16x16x32_bf16 v[88:91], a[216:219], a[172:175], v[88:91]
    s_waitcnt lgkmcnt(8)
    v_mfma_f32_16x16x32_bf16 v[120:123], a[224:227], a[172:175], v[120:123]
    ds_read_b64_tr_b16 a[208:209], v240 offset:3072
    v_mfma_f32_16x16x32_bf16 v[120:123], a[228:231], a[188:191], v[120:123]
    ds_read_b64_tr_b16 a[210:211], v240 offset:4096
    v_mfma_f32_16x16x32_bf16 v[116:119], a[228:231], a[184:187], v[116:119]
    buffer_load_dwordx4 a[60:63], v208, s[36:39], s51 offen offset:3072 sc1
    v_mfma_f32_16x16x32_bf16 v[116:119], a[224:227], a[168:171], v[116:119]
    s_add_u32 s51, s51, 4096
    s_barrier
    v_mfma_f32_16x16x32_bf16 v[112:115], a[224:227], a[164:167], v[112:115]
    ds_read_b64_tr_b16 a[212:213], v232 offset:5120
    v_mfma_f32_16x16x32_bf16 v[112:115], a[228:231], a[180:183], v[112:115]
    s_add_u32 m0, s50, 119808
    ds_read_b64_tr_b16 a[214:215], v232 offset:6144
    v_mfma_f32_16x16x32_bf16 v[92:95], a[228:231], a[176:179], v[92:95]
    buffer_load_dwordx4 v209, s[28:31], s46 offen lds
    v_mfma_f32_16x16x32_bf16 v[92:95], a[224:227], a[160:163], v[92:95]
    s_waitcnt lgkmcnt(8)
    v_mfma_f32_16x16x32_bf16 v[124:127], a[232:235], a[160:163], v[124:127]
    ds_read_b64_tr_b16 a[216:217], v241 offset:3072
    v_mfma_f32_16x16x32_bf16 v[124:127], a[236:239], a[176:179], v[124:127]
    ds_read_b64_tr_b16 a[218:219], v241 offset:4096
    v_mfma_f32_16x16x32_bf16 v[144:147], a[236:239], a[180:183], v[144:147]
    buffer_load_dwordx4 v210, s[28:31], s46 offen offset:1024 lds
    v_mfma_f32_16x16x32_bf16 v[144:147], a[232:235], a[164:167], v[144:147]
    s_cmp_le_u32 s45, 4
    s_cselect_b32 s79, 262144, 0
    s_add_u32 s46, s48, s79
    v_mfma_f32_16x16x32_bf16 v[148:151], a[232:235], a[168:171], v[148:151]
    s_add_u32 s46, s46, 917504
    ds_read_b64_tr_b16 a[220:221], v233 offset:5120
    v_mfma_f32_16x16x32_bf16 v[148:151], a[236:239], a[184:187], v[148:151]
    ds_read_b64_tr_b16 a[222:223], v233 offset:6144
    v_mfma_f32_16x16x32_bf16 v[152:155], a[236:239], a[188:191], v[152:155]
    v_mfma_f32_16x16x32_bf16 v[152:155], a[232:235], a[172:175], v[152:155]
    s_waitcnt lgkmcnt(8)
    v_mfma_f32_16x16x32_bf16 v[184:187], a[240:243], a[172:175], v[184:187]
    ds_read_b64_tr_b16 a[224:225], v242 offset:3072
    v_mfma_f32_16x16x32_bf16 v[184:187], a[244:247], a[188:191], v[184:187]
    ds_read_b64_tr_b16 a[226:227], v242 offset:4096
    v_mfma_f32_16x16x32_bf16 v[180:183], a[244:247], a[184:187], v[180:183]
    buffer_load_dwordx4 a[64:67], v208, s[36:39], s51 offen offset:0 sc1
    v_mfma_f32_16x16x32_bf16 v[180:183], a[240:243], a[168:171], v[180:183]
    v_mfma_f32_16x16x32_bf16 v[176:179], a[240:243], a[164:167], v[176:179]
    ds_read_b64_tr_b16 a[228:229], v234 offset:5120
    v_mfma_f32_16x16x32_bf16 v[176:179], a[244:247], a[180:183], v[176:179]
    ds_read_b64_tr_b16 a[230:231], v234 offset:6144
    v_mfma_f32_16x16x32_bf16 v[156:159], a[244:247], a[176:179], v[156:159]
    buffer_load_dwordx4 a[68:71], v208, s[36:39], s51 offen offset:1024 sc1
    v_mfma_f32_16x16x32_bf16 v[156:159], a[240:243], a[160:163], v[156:159]
    s_waitcnt vmcnt(23) lgkmcnt(8)
    v_mfma_f32_16x16x32_bf16 v[0:3], a[208:211], a[192:195], v[0:3]
    ds_read_b64_tr_b16 a[232:233], v243 offset:3072
    v_mfma_f32_16x16x32_bf16 v[0:3], a[212:215], a[0:3], v[0:3]
    ds_read_b64_tr_b16 a[234:235], v243 offset:4096
    v_mfma_f32_16x16x32_bf16 v[4:7], a[212:215], a[4:7], v[4:7]
    buffer_load_dwordx4 a[72:75], v208, s[36:39], s51 offen offset:2048 sc1
    v_mfma_f32_16x16x32_bf16 v[4:7], a[208:211], a[196:199], v[4:7]
    v_mfma_f32_16x16x32_bf16 v[8:11], a[208:211], a[200:203], v[8:11]
    ds_read_b64_tr_b16 a[236:237], v235 offset:5120
    v_mfma_f32_16x16x32_bf16 v[8:11], a[212:215], a[8:11], v[8:11]
    ds_read_b64_tr_b16 a[238:239], v235 offset:6144
    v_mfma_f32_16x16x32_bf16 v[12:15], a[212:215], a[12:15], v[12:15]
    buffer_load_dwordx4 a[76:79], v208, s[36:39], s51 offen offset:3072 sc1
    v_mfma_f32_16x16x32_bf16 v[12:15], a[208:211], a[204:207], v[12:15]
    s_waitcnt lgkmcnt(8)
    s_add_u32 s51, s51, 4096
    s_barrier
    v_mfma_f32_16x16x32_bf16 v[28:31], a[216:219], a[204:207], v[28:31]
    ds_read_b64_tr_b16 a[240:241], v244 offset:3072
    v_mfma_f32_16x16x32_bf16 v[28:31], a[220:223], a[12:15], v[28:31]
    ds_read_b64_tr_b16 a[242:243], v244 offset:4096
    v_mfma_f32_16x16x32_bf16 v[24:27], a[220:223], a[8:11], v[24:27]
    v_mfma_f32_16x16x32_bf16 v[24:27], a[216:219], a[200:203], v[24:27]
    v_mfma_f32_16x16x32_bf16 v[20:23], a[216:219], a[196:199], v[20:23]
    ds_read_b64_tr_b16 a[244:245], v236 offset:5120
    v_mfma_f32_16x16x32_bf16 v[20:23], a[220:223], a[4:7], v[20:23]
    s_add_u32 m0, s50, 1024
    ds_read_b64_tr_b16 a[246:247], v236 offset:6144
    v_mfma_f32_16x16x32_bf16 v[16:19], a[220:223], a[0:3], v[16:19]
    buffer_load_dwordx4 v209, s[28:31], s46 offen lds
    v_mfma_f32_16x16x32_bf16 v[16:19], a[216:219], a[192:195], v[16:19]
    s_waitcnt lgkmcnt(8)
    v_mfma_f32_16x16x32_bf16 v[32:35], a[224:227], a[192:195], v[32:35]
    ds_read_b64_tr_b16 a[208:209], v245 offset:3072
    v_mfma_f32_16x16x32_bf16 v[32:35], a[228:231], a[0:3], v[32:35]
    ds_read_b64_tr_b16 a[210:211], v245 offset:4096
    v_mfma_f32_16x16x32_bf16 v[36:39], a[228:231], a[4:7], v[36:39]
    buffer_load_dwordx4 v210, s[28:31], s46 offen offset:1024 lds
    v_mfma_f32_16x16x32_bf16 v[36:39], a[224:227], a[196:199], v[36:39]
    s_add_u32 s46, s46, 65536
    v_mfma_f32_16x16x32_bf16 v[44:47], a[224:227], a[200:203], v[44:47]
    ds_read_b64_tr_b16 a[212:213], v237 offset:5120
    v_mfma_f32_16x16x32_bf16 v[44:47], a[228:231], a[8:11], v[44:47]
    ds_read_b64_tr_b16 a[214:215], v237 offset:6144
    v_mfma_f32_16x16x32_bf16 v[48:51], a[228:231], a[12:15], v[48:51]
    buffer_load_dwordx4 a[80:83], v208, s[36:39], s51 offen offset:0 sc1
    v_mfma_f32_16x16x32_bf16 v[48:51], a[224:227], a[204:207], v[48:51]
    s_waitcnt lgkmcnt(8)
    v_mfma_f32_16x16x32_bf16 v[68:71], a[232:235], a[204:207], v[68:71]
    ds_read_b64_tr_b16 a[216:217], v246 offset:3072
    v_mfma_f32_16x16x32_bf16 v[68:71], a[236:239], a[12:15], v[68:71]
    ds_read_b64_tr_b16 a[218:219], v246 offset:4096
    v_mfma_f32_16x16x32_bf16 v[64:67], a[236:239], a[8:11], v[64:67]
    buffer_load_dwordx4 a[84:87], v208, s[36:39], s51 offen offset:1024 sc1
    v_mfma_f32_16x16x32_bf16 v[64:67], a[232:235], a[200:203], v[64:67]
    v_mfma_f32_16x16x32_bf16 v[60:63], a[232:235], a[196:199], v[60:63]
    ds_read_b64_tr_b16 a[220:221], v238 offset:5120
    v_mfma_f32_16x16x32_bf16 v[60:63], a[236:239], a[4:7], v[60:63]
    ds_read_b64_tr_b16 a[222:223], v238 offset:6144
    v_mfma_f32_16x16x32_bf16 v[52:55], a[236:239], a[0:3], v[52:55]
    v_mfma_f32_16x16x32_bf16 v[52:55], a[232:235], a[192:195], v[52:55]
    s_waitcnt lgkmcnt(8)
    v_mfma_f32_16x16x32_bf16 v[76:79], a[240:243], a[192:195], v[76:79]
    ds_read_b64_tr_b16 a[224:225], v247 offset:3072
    v_mfma_f32_16x16x32_bf16 v[76:79], a[244:247], a[0:3], v[76:79]
    ds_read_b64_tr_b16 a[226:227], v247 offset:4096
    v_mfma_f32_16x16x32_bf16 v[80:83], a[244:247], a[4:7], v[80:83]
    buffer_load_dwordx4 a[88:91], v208, s[36:39], s51 offen offset:2048 sc1
    v_mfma_f32_16x16x32_bf16 v[80:83], a[240:243], a[196:199], v[80:83]
    v_mfma_f32_16x16x32_bf16 v[84:87], a[240:243], a[200:203], v[84:87]
    ds_read_b64_tr_b16 a[228:229], v239 offset:5120
    v_mfma_f32_16x16x32_bf16 v[84:87], a[244:247], a[8:11], v[84:87]
    ds_read_b64_tr_b16 a[230:231], v239 offset:6144
    v_mfma_f32_16x16x32_bf16 v[88:91], a[244:247], a[12:15], v[88:91]
    buffer_load_dwordx4 a[92:95], v208, s[36:39], s51 offen offset:3072 sc1
    v_mfma_f32_16x16x32_bf16 v[88:91], a[240:243], a[204:207], v[88:91]
    s_waitcnt lgkmcnt(8)
    s_add_u32 s51, s51, 4096
    v_mfma_f32_16x16x32_bf16 v[120:123], a[208:211], a[204:207], v[120:123]
    s_cmp_eq_u32 s51, s80
    s_cselect_b32 s51, s78, s51
    ds_read_b64_tr_b16 a[232:233], v232 offset:33792
    v_mfma_f32_16x16x32_bf16 v[120:123], a[212:215], a[12:15], v[120:123]
    s_add_u32 m0, s50, 29696
    ds_read_b64_tr_b16 a[234:235], v232 offset:34816
    v_mfma_f32_16x16x32_bf16 v[116:119], a[212:215], a[8:11], v[116:119]
    buffer_load_dwordx4 v209, s[28:31], s46 offen lds
    v_mfma_f32_16x16x32_bf16 v[116:119], a[208:211], a[200:203], v[116:119]
    v_mfma_f32_16x16x32_bf16 v[112:115], a[208:211], a[196:199], v[112:115]
    ds_read_b64_tr_b16 a[236:237], v240 offset:5120
    v_mfma_f32_16x16x32_bf16 v[112:115], a[212:215], a[4:7], v[112:115]
    ds_read_b64_tr_b16 a[238:239], v240 offset:6144
    v_mfma_f32_16x16x32_bf16 v[92:95], a[212:215], a[0:3], v[92:95]
    buffer_load_dwordx4 v210, s[28:31], s46 offen offset:1024 lds
    v_mfma_f32_16x16x32_bf16 v[92:95], a[208:211], a[192:195], v[92:95]
    s_waitcnt lgkmcnt(8)
    s_add_u32 s46, s46, 65536
    v_mfma_f32_16x16x32_bf16 v[124:127], a[216:219], a[192:195], v[124:127]
    ds_read_b64_tr_b16 a[240:241], v233 offset:33792
    v_mfma_f32_16x16x32_bf16 v[124:127], a[220:223], a[0:3], v[124:127]
    ds_read_b64_tr_b16 a[242:243], v233 offset:34816
    v_mfma_f32_16x16x32_bf16 v[144:147], a[220:223], a[4:7], v[144:147]
    v_mfma_f32_16x16x32_bf16 v[144:147], a[216:219], a[196:199], v[144:147]
    v_mfma_f32_16x16x32_bf16 v[148:151], a[216:219], a[200:203], v[148:151]
    ds_read_b64_tr_b16 a[244:245], v241 offset:5120
    v_mfma_f32_16x16x32_bf16 v[148:151], a[220:223], a[8:11], v[148:151]
    ds_read_b64_tr_b16 a[246:247], v241 offset:6144
    v_mfma_f32_16x16x32_bf16 v[152:155], a[220:223], a[12:15], v[152:155]
    buffer_load_dwordx4 a[96:99], v208, s[36:39], s51 offen offset:0 sc1
    v_mfma_f32_16x16x32_bf16 v[152:155], a[216:219], a[204:207], v[152:155]
    s_waitcnt lgkmcnt(8)
    v_mfma_f32_16x16x32_bf16 v[184:187], a[224:227], a[204:207], v[184:187]
    ds_read_b64_tr_b16 a[208:209], v234 offset:33792
    v_mfma_f32_16x16x32_bf16 v[184:187], a[228:231], a[12:15], v[184:187]
    ds_read_b64_tr_b16 a[210:211], v234 offset:34816
    v_mfma_f32_16x16x32_bf16 v[180:183], a[228:231], a[8:11], v[180:183]
    buffer_load_dwordx4 a[100:103], v208, s[36:39], s51 offen offset:1024 sc1
    v_mfma_f32_16x16x32_bf16 v[180:183], a[224:227], a[200:203], v[180:183]
    v_mfma_f32_16x16x32_bf16 v[176:179], a[224:227], a[196:199], v[176:179]
    ds_read_b64_tr_b16 a[212:213], v242 offset:5120
    v_mfma_f32_16x16x32_bf16 v[176:179], a[228:231], a[4:7], v[176:179]
    ds_read_b64_tr_b16 a[214:215], v242 offset:6144
    v_mfma_f32_16x16x32_bf16 v[156:159], a[228:231], a[0:3], v[156:159]
    buffer_load_dwordx4 a[104:107], v208, s[36:39], s51 offen offset:2048 sc1
    v_mfma_f32_16x16x32_bf16 v[156:159], a[224:227], a[192:195], v[156:159]
    s_waitcnt vmcnt(23) lgkmcnt(8)
    v_mfma_f32_16x16x32_bf16 v[0:3], a[232:235], a[16:19], v[0:3]
    ds_read_b64_tr_b16 a[216:217], v235 offset:33792
    v_mfma_f32_16x16x32_bf16 v[0:3], a[236:239], a[32:35], v[0:3]
    ds_read_b64_tr_b16 a[218:219], v235 offset:34816
    v_mfma_f32_16x16x32_bf16 v[4:7], a[236:239], a[36:39], v[4:7]
    buffer_load_dwordx4 a[108:111], v208, s[36:39], s51 offen offset:3072 sc1
    v_mfma_f32_16x16x32_bf16 v[4:7], a[232:235], a[20:23], v[4:7]
    s_add_u32 s51, s51, 4096
    v_mfma_f32_16x16x32_bf16 v[8:11], a[232:235], a[24:27], v[8:11]
    ds_read_b64_tr_b16 a[220:221], v243 offset:5120
    v_mfma_f32_16x16x32_bf16 v[8:11], a[236:239], a[40:43], v[8:11]
    s_add_u32 m0, s50, 58368
    ds_read_b64_tr_b16 a[222:223], v243 offset:6144
    v_mfma_f32_16x16x32_bf16 v[12:15], a[236:239], a[44:47], v[12:15]
    buffer_load_dwordx4 v209, s[28:31], s46 offen lds
    v_mfma_f32_16x16x32_bf16 v[12:15], a[232:235], a[28:31], v[12:15]
    s_waitcnt lgkmcnt(8)
    s_barrier
    v_mfma_f32_16x16x32_bf16 v[28:31], a[240:243], a[28:31], v[28:31]
    ds_read_b64_tr_b16 a[224:225], v236 offset:33792
    v_mfma_f32_16x16x32_bf16 v[28:31], a[244:247], a[44:47], v[28:31]
    ds_read_b64_tr_b16 a[226:227], v236 offset:34816
    v_mfma_f32_16x16x32_bf16 v[24:27], a[244:247], a[40:43], v[24:27]
    buffer_load_dwordx4 v210, s[28:31], s46 offen offset:1024 lds
    v_mfma_f32_16x16x32_bf16 v[24:27], a[240:243], a[24:27], v[24:27]
    s_cmp_le_u32 s45, 5
    s_cselect_b32 s79, 196608, 0
    s_add_u32 s46, s48, s79
    v_mfma_f32_16x16x32_bf16 v[20:23], a[240:243], a[20:23], v[20:23]
    s_add_u32 s46, s46, 1179648
    ds_read_b64_tr_b16 a[228:229], v244 offset:5120
    v_mfma_f32_16x16x32_bf16 v[20:23], a[244:247], a[36:39], v[20:23]
    ds_read_b64_tr_b16 a[230:231], v244 offset:6144
    v_mfma_f32_16x16x32_bf16 v[16:19], a[244:247], a[32:35], v[16:19]
    v_mfma_f32_16x16x32_bf16 v[16:19], a[240:243], a[16:19], v[16:19]
    s_waitcnt lgkmcnt(8)
    v_mfma_f32_16x16x32_bf16 v[32:35], a[208:211], a[16:19], v[32:35]
    ds_read_b64_tr_b16 a[232:233], v237 offset:33792
    v_mfma_f32_16x16x32_bf16 v[32:35], a[212:215], a[32:35], v[32:35]
    ds_read_b64_tr_b16 a[234:235], v237 offset:34816
    v_mfma_f32_16x16x32_bf16 v[36:39], a[212:215], a[36:39], v[36:39]
    buffer_load_dwordx4 a[112:115], v208, s[36:39], s51 offen offset:0 sc1
    v_mfma_f32_16x16x32_bf16 v[36:39], a[208:211], a[20:23], v[36:39]
    v_mfma_f32_16x16x32_bf16 v[44:47], a[208:211], a[24:27], v[44:47]
    ds_read_b64_tr_b16 a[236:237], v245 offset:5120
    v_mfma_f32_16x16x32_bf16 v[44:47], a[212:215], a[40:43], v[44:47]
    ds_read_b64_tr_b16 a[238:239], v245 offset:6144
    v_mfma_f32_16x16x32_bf16 v[48:51], a[212:215], a[44:47], v[48:51]
    buffer_load_dwordx4 a[116:119], v208, s[36:39], s51 offen offset:1024 sc1
    v_mfma_f32_16x16x32_bf16 v[48:51], a[208:211], a[28:31], v[48:51]
    s_waitcnt lgkmcnt(8)
    v_mfma_f32_16x16x32_bf16 v[68:71], a[216:219], a[28:31], v[68:71]
    ds_read_b64_tr_b16 a[240:241], v238 offset:33792
    v_mfma_f32_16x16x32_bf16 v[68:71], a[220:223], a[44:47], v[68:71]
    ds_read_b64_tr_b16 a[242:243], v238 offset:34816
    v_mfma_f32_16x16x32_bf16 v[64:67], a[220:223], a[40:43], v[64:67]
    buffer_load_dwordx4 a[120:123], v208, s[36:39], s51 offen offset:2048 sc1
    v_mfma_f32_16x16x32_bf16 v[64:67], a[216:219], a[24:27], v[64:67]
    v_mfma_f32_16x16x32_bf16 v[60:63], a[216:219], a[20:23], v[60:63]
    ds_read_b64_tr_b16 a[244:245], v246 offset:5120
    v_mfma_f32_16x16x32_bf16 v[60:63], a[220:223], a[36:39], v[60:63]
    ds_read_b64_tr_b16 a[246:247], v246 offset:6144
    v_mfma_f32_16x16x32_bf16 v[52:55], a[220:223], a[32:35], v[52:55]
    v_mfma_f32_16x16x32_bf16 v[52:55], a[216:219], a[16:19], v[52:55]
    s_waitcnt lgkmcnt(8)
    v_mfma_f32_16x16x32_bf16 v[76:79], a[224:227], a[16:19], v[76:79]
    ds_read_b64_tr_b16 a[208:209], v239 offset:33792
    v_mfma_f32_16x16x32_bf16 v[76:79], a[228:231], a[32:35], v[76:79]
    ds_read_b64_tr_b16 a[210:211], v239 offset:34816
    v_mfma_f32_16x16x32_bf16 v[80:83], a[228:231], a[36:39], v[80:83]
    buffer_load_dwordx4 a[124:127], v208, s[36:39], s51 offen offset:3072 sc1
    v_mfma_f32_16x16x32_bf16 v[80:83], a[224:227], a[20:23], v[80:83]
    s_add_u32 s51, s51, 4096
    v_mfma_f32_16x16x32_bf16 v[84:87], a[224:227], a[24:27], v[84:87]
    ds_read_b64_tr_b16 a[212:213], v247 offset:5120
    v_mfma_f32_16x16x32_bf16 v[84:87], a[228:231], a[40:43], v[84:87]
    s_add_u32 m0, s50, 3072
    ds_read_b64_tr_b16 a[214:215], v247 offset:6144
    v_mfma_f32_16x16x32_bf16 v[88:91], a[228:231], a[44:47], v[88:91]
    buffer_load_dwordx4 v209, s[28:31], s46 offen lds
    v_mfma_f32_16x16x32_bf16 v[88:91], a[224:227], a[28:31], v[88:91]
    s_waitcnt lgkmcnt(8)
    v_mfma_f32_16x16x32_bf16 v[120:123], a[232:235], a[28:31], v[120:123]
    ds_read_b64_tr_b16 a[216:217], v240 offset:29696
    v_mfma_f32_16x16x32_bf16 v[120:123], a[236:239], a[44:47], v[120:123]
    ds_read_b64_tr_b16 a[218:219], v240 offset:30720
    v_mfma_f32_16x16x32_bf16 v[116:119], a[236:239], a[40:43], v[116:119]
    buffer_load_dwordx4 v210, s[28:31], s46 offen offset:1024 lds
    v_mfma_f32_16x16x32_bf16 v[116:119], a[232:235], a[24:27], v[116:119]
    s_add_u32 s46, s46, 65536
    s_waitcnt vmcnt(30)
    s_barrier
    v_mfma_f32_16x16x32_bf16 v[112:115], a[232:235], a[20:23], v[112:115]
    ds_read_b64_tr_b16 a[220:221], v240 offset:31744
    v_mfma_f32_16x16x32_bf16 v[112:115], a[236:239], a[36:39], v[112:115]
    ds_read_b64_tr_b16 a[222:223], v240 offset:32768
    v_mfma_f32_16x16x32_bf16 v[92:95], a[236:239], a[32:35], v[92:95]
    buffer_load_dwordx4 a[128:131], v208, s[36:39], s51 offen offset:0 sc1
    v_mfma_f32_16x16x32_bf16 v[92:95], a[232:235], a[16:19], v[92:95]
    s_waitcnt lgkmcnt(8)
    v_mfma_f32_16x16x32_bf16 v[124:127], a[240:243], a[16:19], v[124:127]
    ds_read_b64_tr_b16 a[224:225], v241 offset:29696
    v_mfma_f32_16x16x32_bf16 v[124:127], a[244:247], a[32:35], v[124:127]
    ds_read_b64_tr_b16 a[226:227], v241 offset:30720
    v_mfma_f32_16x16x32_bf16 v[144:147], a[244:247], a[36:39], v[144:147]
    v_mfma_f32_16x16x32_bf16 v[144:147], a[240:243], a[20:23], v[144:147]
    v_mfma_f32_16x16x32_bf16 v[148:151], a[240:243], a[24:27], v[148:151]
    ds_read_b64_tr_b16 a[228:229], v241 offset:31744
    v_mfma_f32_16x16x32_bf16 v[148:151], a[244:247], a[40:43], v[148:151]
    ds_read_b64_tr_b16 a[230:231], v241 offset:32768
    v_mfma_f32_16x16x32_bf16 v[152:155], a[244:247], a[44:47], v[152:155]
    buffer_load_dwordx4 a[132:135], v208, s[36:39], s51 offen offset:1024 sc1
    v_mfma_f32_16x16x32_bf16 v[152:155], a[240:243], a[28:31], v[152:155]
    s_waitcnt lgkmcnt(8)
    v_mfma_f32_16x16x32_bf16 v[184:187], a[208:211], a[28:31], v[184:187]
    ds_read_b64_tr_b16 a[232:233], v242 offset:29696
    v_mfma_f32_16x16x32_bf16 v[184:187], a[212:215], a[44:47], v[184:187]
    ds_read_b64_tr_b16 a[234:235], v242 offset:30720
    v_mfma_f32_16x16x32_bf16 v[180:183], a[212:215], a[40:43], v[180:183]
    buffer_load_dwordx4 a[136:139], v208, s[36:39], s51 offen offset:2048 sc1
    v_mfma_f32_16x16x32_bf16 v[180:183], a[208:211], a[24:27], v[180:183]
    v_mfma_f32_16x16x32_bf16 v[176:179], a[208:211], a[20:23], v[176:179]
    ds_read_b64_tr_b16 a[236:237], v242 offset:31744
    v_mfma_f32_16x16x32_bf16 v[176:179], a[212:215], a[36:39], v[176:179]
    ds_read_b64_tr_b16 a[238:239], v242 offset:32768
    v_mfma_f32_16x16x32_bf16 v[156:159], a[212:215], a[32:35], v[156:159]
    buffer_load_dwordx4 a[140:143], v208, s[36:39], s51 offen offset:3072 sc1
    v_mfma_f32_16x16x32_bf16 v[156:159], a[208:211], a[16:19], v[156:159]
    s_waitcnt vmcnt(24) lgkmcnt(8)
    s_add_u32 s51, s51, 4096
    v_mfma_f32_16x16x32_bf16 v[0:3], a[216:219], a[48:51], v[0:3]
    s_cmp_eq_u32 s51, s80
    s_cselect_b32 s51, s78, s51
    ds_read_b64_tr_b16 a[240:241], v243 offset:29696
    v_mfma_f32_16x16x32_bf16 v[0:3], a[220:223], a[64:67], v[0:3]
    s_add_u32 m0, s50, 31744
    ds_read_b64_tr_b16 a[242:243], v243 offset:30720
    v_mfma_f32_16x16x32_bf16 v[4:7], a[220:223], a[68:71], v[4:7]
    buffer_load_dwordx4 v209, s[28:31], s46 offen lds
    v_mfma_f32_16x16x32_bf16 v[4:7], a[216:219], a[52:55], v[4:7]
    v_mfma_f32_16x16x32_bf16 v[8:11], a[216:219], a[56:59], v[8:11]
    ds_read_b64_tr_b16 a[244:245], v243 offset:31744
    v_mfma_f32_16x16x32_bf16 v[8:11], a[220:223], a[72:75], v[8:11]
    ds_read_b64_tr_b16 a[246:247], v243 offset:32768
    v_mfma_f32_16x16x32_bf16 v[12:15], a[220:223], a[76:79], v[12:15]
    buffer_load_dwordx4 v210, s[28:31], s46 offen offset:1024 lds
    v_mfma_f32_16x16x32_bf16 v[12:15], a[216:219], a[60:63], v[12:15]
    s_waitcnt lgkmcnt(8)
    s_add_u32 s46, s46, 65536
    s_barrier
    v_mfma_f32_16x16x32_bf16 v[28:31], a[224:227], a[60:63], v[28:31]
    ds_read_b64_tr_b16 a[208:209], v244 offset:29696
    v_mfma_f32_16x16x32_bf16 v[28:31], a[228:231], a[76:79], v[28:31]
    ds_read_b64_tr_b16 a[210:211], v244 offset:30720
    v_mfma_f32_16x16x32_bf16 v[24:27], a[228:231], a[72:75], v[24:27]
    v_mfma_f32_16x16x32_bf16 v[24:27], a[224:227], a[56:59], v[24:27]
    v_mfma_f32_16x16x32_bf16 v[20:23], a[224:227], a[52:55], v[20:23]
    ds_read_b64_tr_b16 a[212:213], v244 offset:31744
    v_mfma_f32_16x16x32_bf16 v[20:23], a[228:231], a[68:71], v[20:23]
    ds_read_b64_tr_b16 a[214:215], v244 offset:32768
    v_mfma_f32_16x16x32_bf16 v[16:19], a[228:231], a[64:67], v[16:19]
    buffer_load_dwordx4 a[144:147], v208, s[36:39], s51 offen offset:0 sc1
    v_mfma_f32_16x16x32_bf16 v[16:19], a[224:227], a[48:51], v[16:19]
    s_waitcnt lgkmcnt(8)
    v_mfma_f32_16x16x32_bf16 v[32:35], a[232:235], a[48:51], v[32:35]
    ds_read_b64_tr_b16 a[216:217], v245 offset:29696
    v_mfma_f32_16x16x32_bf16 v[32:35], a[236:239], a[64:67], v[32:35]
    ds_read_b64_tr_b16 a[218:219], v245 offset:30720
    v_mfma_f32_16x16x32_bf16 v[36:39], a[236:239], a[68:71], v[36:39]
    buffer_load_dwordx4 a[148:151], v208, s[36:39], s51 offen offset:1024 sc1
    v_mfma_f32_16x16x32_bf16 v[36:39], a[232:235], a[52:55], v[36:39]
    v_mfma_f32_16x16x32_bf16 v[44:47], a[232:235], a[56:59], v[44:47]
    ds_read_b64_tr_b16 a[220:221], v245 offset:31744
    v_mfma_f32_16x16x32_bf16 v[44:47], a[236:239], a[72:75], v[44:47]
    ds_read_b64_tr_b16 a[222:223], v245 offset:32768
    v_mfma_f32_16x16x32_bf16 v[48:51], a[236:239], a[76:79], v[48:51]
    buffer_load_dwordx4 a[152:155], v208, s[36:39], s51 offen offset:2048 sc1
    v_mfma_f32_16x16x32_bf16 v[48:51], a[232:235], a[60:63], v[48:51]
    s_waitcnt lgkmcnt(8)
    v_mfma_f32_16x16x32_bf16 v[68:71], a[240:243], a[60:63], v[68:71]
    ds_read_b64_tr_b16 a[224:225], v246 offset:29696
    v_mfma_f32_16x16x32_bf16 v[68:71], a[244:247], a[76:79], v[68:71]
    ds_read_b64_tr_b16 a[226:227], v246 offset:30720
    v_mfma_f32_16x16x32_bf16 v[64:67], a[244:247], a[72:75], v[64:67]
    v_mfma_f32_16x16x32_bf16 v[64:67], a[240:243], a[56:59], v[64:67]
    v_mfma_f32_16x16x32_bf16 v[60:63], a[240:243], a[52:55], v[60:63]
    ds_read_b64_tr_b16 a[228:229], v246 offset:31744
    v_mfma_f32_16x16x32_bf16 v[60:63], a[244:247], a[68:71], v[60:63]
    ds_read_b64_tr_b16 a[230:231], v246 offset:32768
    v_mfma_f32_16x16x32_bf16 v[52:55], a[244:247], a[64:67], v[52:55]
    buffer_load_dwordx4 a[156:159], v208, s[36:39], s51 offen offset:3072 sc1
    v_mfma_f32_16x16x32_bf16 v[52:55], a[240:243], a[48:51], v[52:55]
    s_waitcnt lgkmcnt(8)
    s_add_u32 s51, s51, 4096
    buffer_load_dword v227, v230, s[36:39], s71 offen sc1
    v_mfma_f32_16x16x32_bf16 v[76:79], a[208:211], a[48:51], v[76:79]
    ds_read_b64_tr_b16 a[232:233], v247 offset:29696
    v_mfma_f32_16x16x32_bf16 v[76:79], a[212:215], a[64:67], v[76:79]
    s_add_u32 m0, s50, 60416
    ds_read_b64_tr_b16 a[234:235], v247 offset:30720
    v_mfma_f32_16x16x32_bf16 v[80:83], a[212:215], a[68:71], v[80:83]
    buffer_load_dwordx4 v209, s[28:31], s46 offen lds
    v_mfma_f32_16x16x32_bf16 v[80:83], a[208:211], a[52:55], v[80:83]
    v_mfma_f32_16x16x32_bf16 v[84:87], a[208:211], a[56:59], v[84:87]
    ds_read_b64_tr_b16 a[236:237], v247 offset:31744
    v_mfma_f32_16x16x32_bf16 v[84:87], a[212:215], a[72:75], v[84:87]
    ds_read_b64_tr_b16 a[238:239], v247 offset:32768
    v_mfma_f32_16x16x32_bf16 v[88:91], a[212:215], a[76:79], v[88:91]
    buffer_load_dwordx4 v210, s[28:31], s46 offen offset:1024 lds
    v_mfma_f32_16x16x32_bf16 v[88:91], a[208:211], a[60:63], v[88:91]
    s_waitcnt lgkmcnt(8)
    s_cmp_le_u32 s45, 6
    s_cselect_b32 s79, 262144, 0
    v_mfma_f32_16x16x32_bf16 v[120:123], a[216:219], a[60:63], v[120:123]
    s_add_u32 s46, s48, s79
    ds_read_b64_tr_b16 a[240:241], v240 offset:33792
    s_add_u32 s46, s46, 1376256
    v_mfma_f32_16x16x32_bf16 v[120:123], a[220:223], a[76:79], v[120:123]
    ds_read_b64_tr_b16 a[242:243], v240 offset:34816
    v_mfma_f32_16x16x32_bf16 v[116:119], a[220:223], a[72:75], v[116:119]
    v_mfma_f32_16x16x32_bf16 v[116:119], a[216:219], a[56:59], v[116:119]
    v_mfma_f32_16x16x32_bf16 v[112:115], a[216:219], a[52:55], v[112:115]
    ds_read_b64_tr_b16 a[244:245], v248 offset:1024
    v_mfma_f32_16x16x32_bf16 v[112:115], a[220:223], a[68:71], v[112:115]
    ds_read_b64_tr_b16 a[246:247], v248 offset:2048
    v_mfma_f32_16x16x32_bf16 v[92:95], a[220:223], a[64:67], v[92:95]
    buffer_load_dwordx4 a[160:163], v208, s[36:39], s51 offen offset:0 sc1
    v_mfma_f32_16x16x32_bf16 v[92:95], a[216:219], a[48:51], v[92:95]
    s_waitcnt lgkmcnt(8)
    v_mfma_f32_16x16x32_bf16 v[124:127], a[224:227], a[48:51], v[124:127]
    ds_read_b64_tr_b16 a[208:209], v241 offset:33792
    v_mfma_f32_16x16x32_bf16 v[124:127], a[228:231], a[64:67], v[124:127]
    ds_read_b64_tr_b16 a[210:211], v241 offset:34816
    v_mfma_f32_16x16x32_bf16 v[144:147], a[228:231], a[68:71], v[144:147]
    buffer_load_dwordx4 a[164:167], v208, s[36:39], s51 offen offset:1024 sc1
    v_mfma_f32_16x16x32_bf16 v[144:147], a[224:227], a[52:55], v[144:147]
    v_mfma_f32_16x16x32_bf16 v[148:151], a[224:227], a[56:59], v[148:151]
    ds_read_b64_tr_b16 a[212:213], v249 offset:1024
    v_mfma_f32_16x16x32_bf16 v[148:151], a[228:231], a[72:75], v[148:151]
    ds_read_b64_tr_b16 a[214:215], v249 offset:2048
    v_mfma_f32_16x16x32_bf16 v[152:155], a[228:231], a[76:79], v[152:155]
    buffer_load_dwordx4 a[168:171], v208, s[36:39], s51 offen offset:2048 sc1
    v_mfma_f32_16x16x32_bf16 v[152:155], a[224:227], a[60:63], v[152:155]
    s_waitcnt lgkmcnt(8)
    v_mfma_f32_16x16x32_bf16 v[184:187], a[232:235], a[60:63], v[184:187]
    ds_read_b64_tr_b16 a[216:217], v242 offset:33792
    v_mfma_f32_16x16x32_bf16 v[184:187], a[236:239], a[76:79], v[184:187]
    ds_read_b64_tr_b16 a[218:219], v242 offset:34816
    v_mfma_f32_16x16x32_bf16 v[180:183], a[236:239], a[72:75], v[180:183]
    buffer_load_dwordx4 a[172:175], v208, s[36:39], s51 offen offset:3072 sc1
    v_mfma_f32_16x16x32_bf16 v[180:183], a[232:235], a[56:59], v[180:183]
    s_add_u32 s51, s51, 4096
    v_mfma_f32_16x16x32_bf16 v[176:179], a[232:235], a[52:55], v[176:179]
    ds_read_b64_tr_b16 a[220:221], v250 offset:1024
    v_mfma_f32_16x16x32_bf16 v[176:179], a[236:239], a[68:71], v[176:179]
    s_add_u32 m0, s50, 5120
    ds_read_b64_tr_b16 a[222:223], v250 offset:2048
    v_mfma_f32_16x16x32_bf16 v[156:159], a[236:239], a[64:67], v[156:159]
    buffer_load_dwordx4 v209, s[28:31], s46 offen lds
    v_mfma_f32_16x16x32_bf16 v[156:159], a[232:235], a[48:51], v[156:159]
    s_waitcnt vmcnt(26) lgkmcnt(8)
    v_mfma_f32_16x16x32_bf16 v[0:3], a[240:243], a[80:83], v[0:3]
    ds_read_b64_tr_b16 a[224:225], v243 offset:33792
    v_mfma_f32_16x16x32_bf16 v[0:3], a[244:247], a[96:99], v[0:3]
    ds_read_b64_tr_b16 a[226:227], v243 offset:34816
    v_mfma_f32_16x16x32_bf16 v[4:7], a[244:247], a[100:103], v[4:7]
    buffer_load_dwordx4 v210, s[28:31], s46 offen offset:1024 lds
    v_mfma_f32_16x16x32_bf16 v[4:7], a[240:243], a[84:87], v[4:7]
    s_add_u32 s46, s46, 65536
    v_mfma_f32_16x16x32_bf16 v[8:11], a[240:243], a[88:91], v[8:11]
    ds_read_b64_tr_b16 a[228:229], v251 offset:1024
    v_mfma_f32_16x16x32_bf16 v[8:11], a[244:247], a[104:107], v[8:11]
    ds_read_b64_tr_b16 a[230:231], v251 offset:2048
    v_mfma_f32_16x16x32_bf16 v[12:15], a[244:247], a[108:111], v[12:15]
    v_mfma_f32_16x16x32_bf16 v[12:15], a[240:243], a[92:95], v[12:15]
    s_waitcnt lgkmcnt(8)
    s_barrier
    v_mfma_f32_16x16x32_bf16 v[28:31], a[208:211], a[92:95], v[28:31]
    ds_read_b64_tr_b16 a[232:233], v244 offset:33792
    v_mfma_f32_16x16x32_bf16 v[28:31], a[212:215], a[108:111], v[28:31]
    ds_read_b64_tr_b16 a[234:235], v244 offset:34816
    v_mfma_f32_16x16x32_bf16 v[24:27], a[212:215], a[104:107], v[24:27]
    buffer_load_dwordx4 a[176:179], v208, s[36:39], s51 offen offset:0 sc1
    v_mfma_f32_16x16x32_bf16 v[24:27], a[208:211], a[88:91], v[24:27]
    v_mfma_f32_16x16x32_bf16 v[20:23], a[208:211], a[84:87], v[20:23]
    ds_read_b64_tr_b16 a[236:237], v252 offset:1024
    v_mfma_f32_16x16x32_bf16 v[20:23], a[212:215], a[100:103], v[20:23]
    ds_read_b64_tr_b16 a[238:239], v252 offset:2048
    v_mfma_f32_16x16x32_bf16 v[16:19], a[212:215], a[96:99], v[16:19]
    buffer_load_dwordx4 a[180:183], v208, s[36:39], s51 offen offset:1024 sc1
    v_mfma_f32_16x16x32_bf16 v[16:19], a[208:211], a[80:83], v[16:19]
    s_waitcnt lgkmcnt(8)
    s_waitcnt vmcnt(10)
    s_mov_b32 s83, 0x40000
F_sp_30:
    v_cmp_ne_u32 vcc, 0, v227
    s_and_b32 s53, vcc_lo, 0xff0000
    s_cmp_eq_u32 s53, 0xff0000
    s_cbranch_scc1 F_ok_31
    buffer_load_dword v227, v230, s[36:39], s71 offen sc1
    s_sub_u32 s83, s83, 1
    s_waitcnt vmcnt(0)
    s_cbranch_scc0 F_sp_30
F_ok_31:
    v_mfma_f32_16x16x32_bf16 v[32:35], a[216:219], a[80:83], v[32:35]
    ds_read_b64_tr_b16 a[240:241], v245 offset:33792
    v_mfma_f32_16x16x32_bf16 v[32:35], a[220:223], a[96:99], v[32:35]
    ds_read_b64_tr_b16 a[242:243], v245 offset:34816
    v_mfma_f32_16x16x32_bf16 v[36:39], a[220:223], a[100:103], v[36:39]
    buffer_load_dwordx4 a[184:187], v208, s[36:39], s51 offen offset:2048 sc1
    v_mfma_f32_16x16x32_bf16 v[36:39], a[216:219], a[84:87], v[36:39]
    v_mfma_f32_16x16x32_bf16 v[44:47], a[216:219], a[88:91], v[44:47]
    ds_read_b64_tr_b16 a[244:245], v253 offset:1024
    v_mfma_f32_16x16x32_bf16 v[44:47], a[220:223], a[104:107], v[44:47]
    ds_read_b64_tr_b16 a[246:247], v253 offset:2048
    v_mfma_f32_16x16x32_bf16 v[48:51], a[220:223], a[108:111], v[48:51]
    buffer_load_dwordx4 a[188:191], v208, s[36:39], s51 offen offset:3072 sc1
    v_mfma_f32_16x16x32_bf16 v[48:51], a[216:219], a[92:95], v[48:51]
    s_waitcnt lgkmcnt(8)
    s_add_u32 s51, s51, 4096
    v_mfma_f32_16x16x32_bf16 v[68:71], a[224:227], a[92:95], v[68:71]
    s_cmp_eq_u32 s51, s80
    s_cselect_b32 s51, s78, s51
    ds_read_b64_tr_b16 a[208:209], v246 offset:33792
    v_mfma_f32_16x16x32_bf16 v[68:71], a[228:231], a[108:111], v[68:71]
    ds_read_b64_tr_b16 a[210:211], v246 offset:34816
    v_mfma_f32_16x16x32_bf16 v[64:67], a[228:231], a[104:107], v[64:67]
    v_mfma_f32_16x16x32_bf16 v[64:67], a[224:227], a[88:91], v[64:67]
    v_mfma_f32_16x16x32_bf16 v[60:63], a[224:227], a[84:87], v[60:63]
    ds_read_b64_tr_b16 a[212:213], v254 offset:1024
    v_mfma_f32_16x16x32_bf16 v[60:63], a[228:231], a[100:103], v[60:63]
    s_add_u32 m0, s50, 33792
    ds_read_b64_tr_b16 a[214:215], v254 offset:2048
    v_mfma_f32_16x16x32_bf16 v[52:55], a[228:231], a[96:99], v[52:55]
    buffer_load_dwordx4 v209, s[28:31], s46 offen lds
    v_mfma_f32_16x16x32_bf16 v[52:55], a[224:227], a[80:83], v[52:55]
    s_waitcnt lgkmcnt(8)
    v_mfma_f32_16x16x32_bf16 v[76:79], a[232:235], a[80:83], v[76:79]
    ds_read_b64_tr_b16 a[216:217], v247 offset:33792
    v_mfma_f32_16x16x32_bf16 v[76:79], a[236:239], a[96:99], v[76:79]
    ds_read_b64_tr_b16 a[218:219], v247 offset:34816
    v_mfma_f32_16x16x32_bf16 v[80:83], a[236:239], a[100:103], v[80:83]
    buffer_load_dwordx4 v210, s[28:31], s46 offen offset:1024 lds
    v_mfma_f32_16x16x32_bf16 v[80:83], a[232:235], a[84:87], v[80:83]
    s_add_u32 s46, s46, 65536
    v_mfma_f32_16x16x32_bf16 v[84:87], a[232:235], a[88:91], v[84:87]
    ds_read_b64_tr_b16 a[220:221], v255 offset:1024
    v_mfma_f32_16x16x32_bf16 v[84:87], a[236:239], a[104:107], v[84:87]
    ds_read_b64_tr_b16 a[222:223], v255 offset:2048
    v_mfma_f32_16x16x32_bf16 v[88:91], a[236:239], a[108:111], v[88:91]
    buffer_load_dwordx4 a[192:195], v208, s[36:39], s51 offen offset:0 sc1
    v_mfma_f32_16x16x32_bf16 v[88:91], a[232:235], a[92:95], v[88:91]
    s_waitcnt lgkmcnt(8)
    v_mfma_f32_16x16x32_bf16 v[120:123], a[240:243], a[92:95], v[120:123]
    ds_read_b64_tr_b16 a[224:225], v248 offset:3072
    v_mfma_f32_16x16x32_bf16 v[120:123], a[244:247], a[108:111], v[120:123]
    ds_read_b64_tr_b16 a[226:227], v248 offset:4096
    v_mfma_f32_16x16x32_bf16 v[116:119], a[244:247], a[104:107], v[116:119]
    buffer_load_dwordx4 a[196:199], v208, s[36:39], s51 offen offset:1024 sc1
    v_mfma_f32_16x16x32_bf16 v[116:119], a[240:243], a[88:91], v[116:119]
    s_barrier
    v_mfma_f32_16x16x32_bf16 v[112:115], a[240:243], a[84:87], v[112:115]
    ds_read_b64_tr_b16 a[228:229], v248 offset:5120
    v_mfma_f32_16x16x32_bf16 v[112:115], a[244:247], a[100:103], v[112:115]
    ds_read_b64_tr_b16 a[230:231], v248 offset:6144
    v_mfma_f32_16x16x32_bf16 v[92:95], a[244:247], a[96:99], v[92:95]
    v_mfma_f32_16x16x32_bf16 v[92:95], a[240:243], a[80:83], v[92:95]
    s_waitcnt lgkmcnt(8)
    v_mfma_f32_16x16x32_bf16 v[124:127], a[208:211], a[80:83], v[124:127]
    ds_read_b64_tr_b16 a[232:233], v249 offset:3072
    v_mfma_f32_16x16x32_bf16 v[124:127], a[212:215], a[96:99], v[124:127]
    ds_read_b64_tr_b16 a[234:235], v249 offset:4096
    v_mfma_f32_16x16x32_bf16 v[144:147], a[212:215], a[100:103], v[144:147]
    buffer_load_dwordx4 a[200:203], v208, s[36:39], s51 offen offset:2048 sc1
    v_mfma_f32_16x16x32_bf16 v[144:147], a[208:211], a[84:87], v[144:147]
    v_mfma_f32_16x16x32_bf16 v[148:151], a[208:211], a[88:91], v[148:151]
    ds_read_b64_tr_b16 a[236:237], v249 offset:5120
    v_mfma_f32_16x16x32_bf16 v[148:151], a[212:215], a[104:107], v[148:151]
    ds_read_b64_tr_b16 a[238:239], v249 offset:6144
    v_mfma_f32_16x16x32_bf16 v[152:155], a[212:215], a[108:111], v[152:155]
    buffer_load_dwordx4 a[204:207], v208, s[36:39], s51 offen offset:3072 sc1
    v_mfma_f32_16x16x32_bf16 v[152:155], a[208:211], a[92:95], v[152:155]
    s_waitcnt lgkmcnt(8)
    s_add_u32 s51, s51, 4096
    v_mfma_f32_16x16x32_bf16 v[184:187], a[216:219], a[92:95], v[184:187]
    ds_read_b64_tr_b16 a[240:241], v250 offset:3072
    v_mfma_f32_16x16x32_bf16 v[184:187], a[220:223], a[108:111], v[184:187]
    s_add_u32 m0, s50, 62464
    ds_read_b64_tr_b16 a[242:243], v250 offset:4096
    v_mfma_f32_16x16x32_bf16 v[180:183], a[220:223], a[104:107], v[180:183]
    buffer_load_dwordx4 v209, s[28:31], s46 offen lds
    v_mfma_f32_16x16x32_bf16 v[180:183], a[216:219], a[88:91], v[180:183]
    v_mfma_f32_16x16x32_bf16 v[176:179], a[216:219], a[84:87], v[176:179]
    ds_read_b64_tr_b16 a[244:245], v250 offset:5120
    v_mfma_f32_16x16x32_bf16 v[176:179], a[220:223], a[100:103], v[176:179]
    ds_read_b64_tr_b16 a[246:247], v250 offset:6144
    v_mfma_f32_16x16x32_bf16 v[156:159], a[220:223], a[96:99], v[156:159]
    buffer_load_dwordx4 v210, s[28:31], s46 offen offset:1024 lds
    v_mfma_f32_16x16x32_bf16 v[156:159], a[216:219], a[80:83], v[156:159]
    s_waitcnt lgkmcnt(8)
    s_add_u32 s46, s48, 196608
    v_mfma_f32_16x16x32_bf16 v[0:3], a[224:227], a[112:115], v[0:3]
    ds_read_b64_tr_b16 a[208:209], v251 offset:3072
    v_mfma_f32_16x16x32_bf16 v[0:3], a[228:231], a[128:131], v[0:3]
    ds_read_b64_tr_b16 a[210:211], v251 offset:4096
    v_mfma_f32_16x16x32_bf16 v[4:7], a[228:231], a[132:135], v[4:7]
    v_mfma_f32_16x16x32_bf16 v[4:7], a[224:227], a[116:119], v[4:7]
    v_mfma_f32_16x16x32_bf16 v[8:11], a[224:227], a[120:123], v[8:11]
    ds_read_b64_tr_b16 a[212:213], v251 offset:5120
    v_mfma_f32_16x16x32_bf16 v[8:11], a[228:231], a[136:139], v[8:11]
    ds_read_b64_tr_b16 a[214:215], v251 offset:6144
    v_mfma_f32_16x16x32_bf16 v[12:15], a[228:231], a[140:143], v[12:15]
    buffer_load_dwordx4 a[0:3], v208, s[36:39], s51 offen offset:0 sc1
    v_mfma_f32_16x16x32_bf16 v[12:15], a[224:227], a[124:127], v[12:15]
    s_waitcnt lgkmcnt(8)
    s_barrier
    v_mfma_f32_16x16x32_bf16 v[28:31], a[232:235], a[124:127], v[28:31]
    ds_read_b64_tr_b16 a[216:217], v252 offset:3072
    v_mfma_f32_16x16x32_bf16 v[28:31], a[236:239], a[140:143], v[28:31]
    ds_read_b64_tr_b16 a[218:219], v252 offset:4096
    v_mfma_f32_16x16x32_bf16 v[24:27], a[236:239], a[136:139], v[24:27]
    buffer_load_dwordx4 a[4:7], v208, s[36:39], s51 offen offset:1024 sc1
    v_mfma_f32_16x16x32_bf16 v[24:27], a[232:235], a[120:123], v[24:27]
    v_mfma_f32_16x16x32_bf16 v[20:23], a[232:235], a[116:119], v[20:23]
    ds_read_b64_tr_b16 a[220:221], v252 offset:5120
    v_mfma_f32_16x16x32_bf16 v[20:23], a[236:239], a[132:135], v[20:23]
    ds_read_b64_tr_b16 a[222:223], v252 offset:6144
    v_mfma_f32_16x16x32_bf16 v[16:19], a[236:239], a[128:131], v[16:19]
    buffer_load_dwordx4 a[8:11], v208, s[36:39], s51 offen offset:2048 sc1
    v_mfma_f32_16x16x32_bf16 v[16:19], a[232:235], a[112:115], v[16:19]
    s_waitcnt lgkmcnt(8)
    v_mfma_f32_16x16x32_bf16 v[32:35], a[240:243], a[112:115], v[32:35]
    ds_read_b64_tr_b16 a[224:225], v253 offset:3072
    v_mfma_f32_16x16x32_bf16 v[32:35], a[244:247], a[128:131], v[32:35]
    ds_read_b64_tr_b16 a[226:227], v253 offset:4096
    v_mfma_f32_16x16x32_bf16 v[36:39], a[244:247], a[132:135], v[36:39]
    buffer_load_dwordx4 a[12:15], v208, s[36:39], s51 offen offset:3072 sc1
    v_mfma_f32_16x16x32_bf16 v[36:39], a[240:243], a[116:119], v[36:39]
    s_add_u32 s51, s51, 4096
    v_mfma_f32_16x16x32_bf16 v[44:47], a[240:243], a[120:123], v[44:47]
    ds_read_b64_tr_b16 a[228:229], v253 offset:5120
    v_mfma_f32_16x16x32_bf16 v[44:47], a[244:247], a[136:139], v[44:47]
    s_add_u32 m0, s50, 87040
    ds_read_b64_tr_b16 a[230:231], v253 offset:6144
    v_mfma_f32_16x16x32_bf16 v[48:51], a[244:247], a[140:143], v[48:51]
    buffer_load_dwordx4 v209, s[28:31], s46 offen lds
    v_mfma_f32_16x16x32_bf16 v[48:51], a[240:243], a[124:127], v[48:51]
    s_waitcnt lgkmcnt(8)
    v_mfma_f32_16x16x32_bf16 v[68:71], a[208:211], a[124:127], v[68:71]
    ds_read_b64_tr_b16 a[232:233], v254 offset:3072
    v_mfma_f32_16x16x32_bf16 v[68:71], a[212:215], a[140:143], v[68:71]
    ds_read_b64_tr_b16 a[234:235], v254 offset:4096
    v_mfma_f32_16x16x32_bf16 v[64:67], a[212:215], a[136:139], v[64:67]
    buffer_load_dwordx4 v210, s[28:31], s46 offen offset:1024 lds
    v_mfma_f32_16x16x32_bf16 v[64:67], a[208:211], a[120:123], v[64:67]
    s_add_u32 s46, s46, 458752
    v_mfma_f32_16x16x32_bf16 v[60:63], a[208:211], a[116:119], v[60:63]
    ds_read_b64_tr_b16 a[236:237], v254 offset:5120
    v_mfma_f32_16x16x32_bf16 v[60:63], a[212:215], a[132:135], v[60:63]
    ds_read_b64_tr_b16 a[238:239], v254 offset:6144
    v_mfma_f32_16x16x32_bf16 v[52:55], a[212:215], a[128:131], v[52:55]
    v_mfma_f32_16x16x32_bf16 v[52:55], a[208:211], a[112:115], v[52:55]
    s_waitcnt lgkmcnt(8)
    v_mfma_f32_16x16x32_bf16 v[76:79], a[216:219], a[112:115], v[76:79]
    ds_read_b64_tr_b16 a[240:241], v255 offset:3072
    v_mfma_f32_16x16x32_bf16 v[76:79], a[220:223], a[128:131], v[76:79]
    ds_read_b64_tr_b16 a[242:243], v255 offset:4096
    v_mfma_f32_16x16x32_bf16 v[80:83], a[220:223], a[132:135], v[80:83]
    buffer_load_dwordx4 a[16:19], v208, s[36:39], s51 offen offset:0 sc1
    v_mfma_f32_16x16x32_bf16 v[80:83], a[216:219], a[116:119], v[80:83]
    v_mfma_f32_16x16x32_bf16 v[84:87], a[216:219], a[120:123], v[84:87]
    ds_read_b64_tr_b16 a[244:245], v255 offset:5120
    v_mfma_f32_16x16x32_bf16 v[84:87], a[220:223], a[136:139], v[84:87]
    ds_read_b64_tr_b16 a[246:247], v255 offset:6144
    v_mfma_f32_16x16x32_bf16 v[88:91], a[220:223], a[140:143], v[88:91]
    buffer_load_dwordx4 a[20:23], v208, s[36:39], s51 offen offset:1024 sc1
    v_mfma_f32_16x16x32_bf16 v[88:91], a[216:219], a[124:127], v[88:91]
    s_waitcnt lgkmcnt(8)
    v_mfma_f32_16x16x32_bf16 v[120:123], a[224:227], a[124:127], v[120:123]
    ds_read_b64_tr_b16 a[208:209], v232 offset:1024
    v_mfma_f32_16x16x32_bf16 v[120:123], a[228:231], a[140:143], v[120:123]
    ds_read_b64_tr_b16 a[210:211], v232 offset:2048
    v_mfma_f32_16x16x32_bf16 v[116:119], a[228:231], a[136:139], v[116:119]
    buffer_load_dwordx4 a[24:27], v208, s[36:39], s51 offen offset:2048 sc1
    v_mfma_f32_16x16x32_bf16 v[116:119], a[224:227], a[120:123], v[116:119]
    v_mfma_f32_16x16x32_bf16 v[112:115], a[224:227], a[116:119], v[112:115]
    ds_read_b64_tr_b16 a[212:213], v232 offset:29696
    v_mfma_f32_16x16x32_bf16 v[112:115], a[228:231], a[132:135], v[112:115]
    ds_read_b64_tr_b16 a[214:215], v232 offset:30720
    v_mfma_f32_16x16x32_bf16 v[92:95], a[228:231], a[128:131], v[92:95]
    v_mfma_f32_16x16x32_bf16 v[92:95], a[224:227], a[112:115], v[92:95]
    s_waitcnt lgkmcnt(8)
    v_mfma_f32_16x16x32_bf16 v[124:127], a[232:235], a[112:115], v[124:127]
    ds_read_b64_tr_b16 a[216:217], v233 offset:1024
    v_mfma_f32_16x16x32_bf16 v[124:127], a[236:239], a[128:131], v[124:127]
    ds_read_b64_tr_b16 a[218:219], v233 offset:2048
    v_mfma_f32_16x16x32_bf16 v[144:147], a[236:239], a[132:135], v[144:147]
    buffer_load_dwordx4 a[28:31], v208, s[36:39], s51 offen offset:3072 sc1
    v_mfma_f32_16x16x32_bf16 v[144:147], a[232:235], a[116:119], v[144:147]
    s_add_u32 s51, s51, 4096
    s_cmp_eq_u32 s51, s80
    s_cselect_b32 s51, s78, s51
    v_mfma_f32_16x16x32_bf16 v[148:151], a[232:235], a[120:123], v[148:151]
    ds_read_b64_tr_b16 a[220:221], v233 offset:29696
    v_mfma_f32_16x16x32_bf16 v[148:151], a[236:239], a[136:139], v[148:151]
    s_add_u32 m0, s50, 89088
    ds_read_b64_tr_b16 a[222:223], v233 offset:30720
    v_mfma_f32_16x16x32_bf16 v[152:155], a[236:239], a[140:143], v[152:155]
    buffer_load_dwordx4 v209, s[28:31], s46 offen lds
    v_mfma_f32_16x16x32_bf16 v[152:155], a[232:235], a[124:127], v[152:155]
    s_waitcnt lgkmcnt(8)
    v_mfma_f32_16x16x32_bf16 v[184:187], a[240:243], a[124:127], v[184:187]
    ds_read_b64_tr_b16 a[224:225], v234 offset:1024
    v_mfma_f32_16x16x32_bf16 v[184:187], a[244:247], a[140:143], v[184:187]
    ds_read_b64_tr_b16 a[226:227], v234 offset:2048
    v_mfma_f32_16x16x32_bf16 v[180:183], a[244:247], a[136:139], v[180:183]
    buffer_load_dwordx4 v210, s[28:31], s46 offen offset:1024 lds
    v_mfma_f32_16x16x32_bf16 v[180:183], a[240:243], a[120:123], v[180:183]
    s_add_u32 s46, s46, 458752
    v_mfma_f32_16x16x32_bf16 v[176:179], a[240:243], a[116:119], v[176:179]
    ds_read_b64_tr_b16 a[228:229], v234 offset:29696
    v_mfma_f32_16x16x32_bf16 v[176:179], a[244:247], a[132:135], v[176:179]
    ds_read_b64_tr_b16 a[230:231], v234 offset:30720
    v_mfma_f32_16x16x32_bf16 v[156:159], a[244:247], a[128:131], v[156:159]
    buffer_load_dwordx4 a[32:35], v208, s[36:39], s51 offen offset:0 sc1
    v_mfma_f32_16x16x32_bf16 v[156:159], a[240:243], a[112:115], v[156:159]
    s_waitcnt vmcnt(27) lgkmcnt(8)
    v_mfma_f32_16x16x32_bf16 v[0:3], a[208:211], a[144:147], v[0:3]
    ds_read_b64_tr_b16 a[232:233], v235 offset:1024
    v_mfma_f32_16x16x32_bf16 v[0:3], a[212:215], a[160:163], v[0:3]
    ds_read_b64_tr_b16 a[234:235], v235 offset:2048
    v_mfma_f32_16x16x32_bf16 v[4:7], a[212:215], a[164:167], v[4:7]
    v_mfma_f32_16x16x32_bf16 v[4:7], a[208:211], a[148:151], v[4:7]
    v_mfma_f32_16x16x32_bf16 v[8:11], a[208:211], a[152:155], v[8:11]
    ds_read_b64_tr_b16 a[236:237], v235 offset:29696
    v_mfma_f32_16x16x32_bf16 v[8:11], a[212:215], a[168:171], v[8:11]
    ds_read_b64_tr_b16 a[238:239], v235 offset:30720
    v_mfma_f32_16x16x32_bf16 v[12:15], a[212:215], a[172:175], v[12:15]
    buffer_load_dwordx4 a[36:39], v208, s[36:39], s51 offen offset:1024 sc1
    v_mfma_f32_16x16x32_bf16 v[12:15], a[208:211], a[156:159], v[12:15]
    s_waitcnt lgkmcnt(8)
    s_barrier
    v_mfma_f32_16x16x32_bf16 v[28:31], a[216:219], a[156:159], v[28:31]
    ds_read_b64_tr_b16 a[240:241], v236 offset:1024
    v_mfma_f32_16x16x32_bf16 v[28:31], a[220:223], a[172:175], v[28:31]
    ds_read_b64_tr_b16 a[242:243], v236 offset:2048
    v_mfma_f32_16x16x32_bf16 v[24:27], a[220:223], a[168:171], v[24:27]
    buffer_load_dwordx4 a[40:43], v208, s[36:39], s51 offen offset:2048 sc1
    v_mfma_f32_16x16x32_bf16 v[24:27], a[216:219], a[152:155], v[24:27]
    v_mfma_f32_16x16x32_bf16 v[20:23], a[216:219], a[148:151], v[20:23]
    ds_read_b64_tr_b16 a[244:245], v236 offset:29696
    v_mfma_f32_16x16x32_bf16 v[20:23], a[220:223], a[164:167], v[20:23]
    ds_read_b64_tr_b16 a[246:247], v236 offset:30720
    v_mfma_f32_16x16x32_bf16 v[16:19], a[220:223], a[160:163], v[16:19]
    buffer_load_dwordx4 a[44:47], v208, s[36:39], s51 offen offset:3072 sc1
    v_mfma_f32_16x16x32_bf16 v[16:19], a[216:219], a[144:147], v[16:19]
    s_waitcnt lgkmcnt(8)
    s_add_u32 s51, s51, 4096
    v_mfma_f32_16x16x32_bf16 v[32:35], a[224:227], a[144:147], v[32:35]
    ds_read_b64_tr_b16 a[208:209], v237 offset:1024
    v_mfma_f32_16x16x32_bf16 v[32:35], a[228:231], a[160:163], v[32:35]
    s_add_u32 m0, s50, 91136
    ds_read_b64_tr_b16 a[210:211], v237 offset:2048
    v_mfma_f32_16x16x32_bf16 v[36:39], a[228:231], a[164:167], v[36:39]
    buffer_load_dwordx4 v209, s[28:31], s46 offen lds
    v_mfma_f32_16x16x32_bf16 v[36:39], a[224:227], a[148:151], v[36:39]
    v_mfma_f32_16x16x32_bf16 v[44:47], a[224:227], a[152:155], v[44:47]
    ds_read_b64_tr_b16 a[212:213], v237 offset:29696
    v_mfma_f32_16x16x32_bf16 v[44:47], a[228:231], a[168:171], v[44:47]
    ds_read_b64_tr_b16 a[214:215], v237 offset:30720
    v_mfma_f32_16x16x32_bf16 v[48:51], a[228:231], a[172:175], v[48:51]
    buffer_load_dwordx4 v210, s[28:31], s46 offen offset:1024 lds
    v_mfma_f32_16x16x32_bf16 v[48:51], a[224:227], a[156:159], v[48:51]
    s_waitcnt lgkmcnt(8)
    s_add_u32 s46, s46, 458752
    v_mfma_f32_16x16x32_bf16 v[68:71], a[232:235], a[156:159], v[68:71]
    ds_read_b64_tr_b16 a[216:217], v238 offset:1024
    v_mfma_f32_16x16x32_bf16 v[68:71], a[236:239], a[172:175], v[68:71]
    ds_read_b64_tr_b16 a[218:219], v238 offset:2048
    v_mfma_f32_16x16x32_bf16 v[64:67], a[236:239], a[168:171], v[64:67]
    v_mfma_f32_16x16x32_bf16 v[64:67], a[232:235], a[152:155], v[64:67]
    v_mfma_f32_16x16x32_bf16 v[60:63], a[232:235], a[148:151], v[60:63]
    ds_read_b64_tr_b16 a[220:221], v238 offset:29696
    v_mfma_f32_16x16x32_bf16 v[60:63], a[236:239], a[164:167], v[60:63]
    ds_read_b64_tr_b16 a[222:223], v238 offset:30720
    v_mfma_f32_16x16x32_bf16 v[52:55], a[236:239], a[160:163], v[52:55]
    buffer_load_dwordx4 a[48:51], v208, s[36:39], s51 offen offset:0 sc1
    v_mfma_f32_16x16x32_bf16 v[52:55], a[232:235], a[144:147], v[52:55]
    s_waitcnt lgkmcnt(8)
    v_mfma_f32_16x16x32_bf16 v[76:79], a[240:243], a[144:147], v[76:79]
    ds_read_b64_tr_b16 a[224:225], v239 offset:1024
    v_mfma_f32_16x16x32_bf16 v[76:79], a[244:247], a[160:163], v[76:79]
    ds_read_b64_tr_b16 a[226:227], v239 offset:2048
    v_mfma_f32_16x16x32_bf16 v[80:83], a[244:247], a[164:167], v[80:83]
    buffer_load_dwordx4 a[52:55], v208, s[36:39], s51 offen offset:1024 sc1
    v_mfma_f32_16x16x32_bf16 v[80:83], a[240:243], a[148:151], v[80:83]
    v_mfma_f32_16x16x32_bf16 v[84:87], a[240:243], a[152:155], v[84:87]
    ds_read_b64_tr_b16 a[228:229], v239 offset:29696
    v_mfma_f32_16x16x32_bf16 v[84:87], a[244:247], a[168:171], v[84:87]
    ds_read_b64_tr_b16 a[230:231], v239 offset:30720
    v_mfma_f32_16x16x32_bf16 v[88:91], a[244:247], a[172:175], v[88:91]
    buffer_load_dwordx4 a[56:59], v208, s[36:39], s51 offen offset:2048 sc1
    v_mfma_f32_16x16x32_bf16 v[88:91], a[240:243], a[156:159], v[88:91]
    s_waitcnt lgkmcnt(8)
    v_mfma_f32_16x16x32_bf16 v[120:123], a[208:211], a[156:159], v[120:123]
    ds_read_b64_tr_b16 a[232:233], v240 offset:1024
    v_mfma_f32_16x16x32_bf16 v[120:123], a[212:215], a[172:175], v[120:123]
    ds_read_b64_tr_b16 a[234:235], v240 offset:2048
    v_mfma_f32_16x16x32_bf16 v[116:119], a[212:215], a[168:171], v[116:119]
    v_mfma_f32_16x16x32_bf16 v[116:119], a[208:211], a[152:155], v[116:119]
    s_waitcnt vmcnt(33)
    s_barrier
    v_mfma_f32_16x16x32_bf16 v[112:115], a[208:211], a[148:151], v[112:115]
    ds_read_b64_tr_b16 a[236:237], v232 offset:3072
    v_mfma_f32_16x16x32_bf16 v[112:115], a[212:215], a[164:167], v[112:115]
    ds_read_b64_tr_b16 a[238:239], v232 offset:4096
    v_mfma_f32_16x16x32_bf16 v[92:95], a[212:215], a[160:163], v[92:95]
    buffer_load_dwordx4 a[60:63], v208, s[36:39], s51 offen offset:3072 sc1
    v_mfma_f32_16x16x32_bf16 v[92:95], a[208:211], a[144:147], v[92:95]
    s_waitcnt lgkmcnt(8)
    s_add_u32 s51, s51, 4096
    v_mfma_f32_16x16x32_bf16 v[124:127], a[216:219], a[144:147], v[124:127]
    ds_read_b64_tr_b16 a[240:241], v241 offset:1024
    v_mfma_f32_16x16x32_bf16 v[124:127], a[220:223], a[160:163], v[124:127]
    s_add_u32 m0, s50, 115712
    ds_read_b64_tr_b16 a[242:243], v241 offset:2048
    v_mfma_f32_16x16x32_bf16 v[144:147], a[220:223], a[164:167], v[144:147]
    buffer_load_dwordx4 v209, s[28:31], s46 offen lds
    v_mfma_f32_16x16x32_bf16 v[144:147], a[216:219], a[148:151], v[144:147]
    v_mfma_f32_16x16x32_bf16 v[148:151], a[216:219], a[152:155], v[148:151]
    ds_read_b64_tr_b16 a[244:245], v233 offset:3072
    v_mfma_f32_16x16x32_bf16 v[148:151], a[220:223], a[168:171], v[148:151]
    ds_read_b64_tr_b16 a[246:247], v233 offset:4096
    v_mfma_f32_16x16x32_bf16 v[152:155], a[220:223], a[172:175], v[152:155]
    buffer_load_dwordx4 v210, s[28:31], s46 offen offset:1024 lds
    v_mfma_f32_16x16x32_bf16 v[152:155], a[216:219], a[156:159], v[152:155]
    s_waitcnt lgkmcnt(8)
    v_mfma_f32_16x16x32_bf16 v[184:187], a[224:227], a[156:159], v[184:187]
    ds_read_b64_tr_b16 a[208:209], v242 offset:1024
    v_mfma_f32_16x16x32_bf16 v[184:187], a[228:231], a[172:175], v[184:187]
    ds_read_b64_tr_b16 a[210:211], v242 offset:2048
    v_mfma_f32_16x16x32_bf16 v[180:183], a[228:231], a[168:171], v[180:183]
    buffer_load_dwordx4 a[64:67], v208, s[36:39], s51 offen offset:0 sc1
    v_mfma_f32_16x16x32_bf16 v[180:183], a[224:227], a[152:155], v[180:183]
    v_mfma_f32_16x16x32_bf16 v[176:179], a[224:227], a[148:151], v[176:179]
    ds_read_b64_tr_b16 a[212:213], v234 offset:3072
    v_mfma_f32_16x16x32_bf16 v[176:179], a[228:231], a[164:167], v[176:179]
    ds_read_b64_tr_b16 a[214:215], v234 offset:4096
    v_mfma_f32_16x16x32_bf16 v[156:159], a[228:231], a[160:163], v[156:159]
    v_mfma_f32_16x16x32_bf16 v[156:159], a[224:227], a[144:147], v[156:159]
    s_waitcnt vmcnt(27) lgkmcnt(8)
    v_mfma_f32_16x16x32_bf16 v[0:3], a[232:235], a[176:179], v[0:3]
    ds_read_b64_tr_b16 a[216:217], v243 offset:1024
    v_mfma_f32_16x16x32_bf16 v[0:3], a[236:239], a[192:195], v[0:3]
    ds_read_b64_tr_b16 a[218:219], v243 offset:2048
    v_mfma_f32_16x16x32_bf16 v[4:7], a[236:239], a[196:199], v[4:7]
    buffer_load_dwordx4 a[68:71], v208, s[36:39], s51 offen offset:1024 sc1
    v_mfma_f32_16x16x32_bf16 v[4:7], a[232:235], a[180:183], v[4:7]
    v_mfma_f32_16x16x32_bf16 v[8:11], a[232:235], a[184:187], v[8:11]
    ds_read_b64_tr_b16 a[220:221], v235 offset:3072
    v_mfma_f32_16x16x32_bf16 v[8:11], a[236:239], a[200:203], v[8:11]
    ds_read_b64_tr_b16 a[222:223], v235 offset:4096
    v_mfma_f32_16x16x32_bf16 v[12:15], a[236:239], a[204:207], v[12:15]
    buffer_load_dwordx4 a[72:75], v208, s[36:39], s51 offen offset:2048 sc1
    v_mfma_f32_16x16x32_bf16 v[12:15], a[232:235], a[188:191], v[12:15]
    s_waitcnt lgkmcnt(8)
    s_barrier
    v_mfma_f32_16x16x32_bf16 v[28:31], a[240:243], a[188:191], v[28:31]
    ds_read_b64_tr_b16 a[224:225], v244 offset:1024
    v_mfma_f32_16x16x32_bf16 v[28:31], a[244:247], a[204:207], v[28:31]
    ds_read_b64_tr_b16 a[226:227], v244 offset:2048
    v_mfma_f32_16x16x32_bf16 v[24:27], a[244:247], a[200:203], v[24:27]
    buffer_load_dwordx4 a[76:79], v208, s[36:39], s51 offen offset:3072 sc1
    v_mfma_f32_16x16x32_bf16 v[24:27], a[240:243], a[184:187], v[24:27]
    s_add_u32 s51, s51, 4096
    s_cmp_eq_u32 s51, s80
    s_cselect_b32 s51, s78, s51
    v_mfma_f32_16x16x32_bf16 v[20:23], a[240:243], a[180:183], v[20:23]
    ds_read_b64_tr_b16 a[228:229], v236 offset:3072
    v_mfma_f32_16x16x32_bf16 v[20:23], a[244:247], a[196:199], v[20:23]
    s_add_u32 m0, s50, 117760
    ds_read_b64_tr_b16 a[230:231], v236 offset:4096
    v_mfma_f32_16x16x32_bf16 v[16:19], a[244:247], a[192:195], v[16:19]
    buffer_load_dwordx4 v209, s[32:35], s47 offen lds
    v_mfma_f32_16x16x32_bf16 v[16:19], a[240:243], a[176:179], v[16:19]
    s_waitcnt lgkmcnt(8)
    v_mfma_f32_16x16x32_bf16 v[32:35], a[208:211], a[176:179], v[32:35]
    ds_read_b64_tr_b16 a[232:233], v245 offset:1024
    v_mfma_f32_16x16x32_bf16 v[32:35], a[212:215], a[192:195], v[32:35]
    ds_read_b64_tr_b16 a[234:235], v245 offset:2048
    v_mfma_f32_16x16x32_bf16 v[36:39], a[212:215], a[196:199], v[36:39]
    buffer_load_dwordx4 v210, s[32:35], s47 offen offset:1024 lds
    v_mfma_f32_16x16x32_bf16 v[36:39], a[208:211], a[180:183], v[36:39]
    s_add_u32 s47, s47, 65536
    v_mfma_f32_16x16x32_bf16 v[44:47], a[208:211], a[184:187], v[44:47]
    ds_read_b64_tr_b16 a[236:237], v237 offset:3072
    v_mfma_f32_16x16x32_bf16 v[44:47], a[212:215], a[200:203], v[44:47]
    ds_read_b64_tr_b16 a[238:239], v237 offset:4096
    v_mfma_f32_16x16x32_bf16 v[48:51], a[212:215], a[204:207], v[48:51]
    v_mfma_f32_16x16x32_bf16 v[48:51], a[208:211], a[188:191], v[48:51]
    s_waitcnt lgkmcnt(8)
    v_mfma_f32_16x16x32_bf16 v[68:71], a[216:219], a[188:191], v[68:71]
    ds_read_b64_tr_b16 a[240:241], v246 offset:1024
    v_mfma_f32_16x16x32_bf16 v[68:71], a[220:223], a[204:207], v[68:71]
    ds_read_b64_tr_b16 a[242:243], v246 offset:2048
    v_mfma_f32_16x16x32_bf16 v[64:67], a[220:223], a[200:203], v[64:67]
    buffer_load_dwordx4 a[80:83], v208, s[36:39], s51 offen offset:0 sc1
    v_mfma_f32_16x16x32_bf16 v[64:67], a[216:219], a[184:187], v[64:67]
    v_mfma_f32_16x16x32_bf16 v[60:63], a[216:219], a[180:183], v[60:63]
    ds_read_b64_tr_b16 a[244:245], v238 offset:3072
    v_mfma_f32_16x16x32_bf16 v[60:63], a[220:223], a[196:199], v[60:63]
    ds_read_b64_tr_b16 a[246:247], v238 offset:4096
    v_mfma_f32_16x16x32_bf16 v[52:55], a[220:223], a[192:195], v[52:55]
    buffer_load_dwordx4 a[88:91], v208, s[36:39], s51 offen offset:1024 sc1
    v_mfma_f32_16x16x32_bf16 v[52:55], a[216:219], a[176:179], v[52:55]
    s_waitcnt lgkmcnt(8)
    v_mfma_f32_16x16x32_bf16 v[76:79], a[224:227], a[176:179], v[76:79]
    ds_read_b64_tr_b16 a[208:209], v247 offset:1024
    v_mfma_f32_16x16x32_bf16 v[76:79], a[228:231], a[192:195], v[76:79]
    ds_read_b64_tr_b16 a[210:211], v247 offset:2048
    v_mfma_f32_16x16x32_bf16 v[80:83], a[228:231], a[196:199], v[80:83]
    buffer_load_dwordx4 a[84:87], v208, s[36:39], s51 offen offset:2048 sc1
    v_mfma_f32_16x16x32_bf16 v[80:83], a[224:227], a[180:183], v[80:83]
    v_mfma_f32_16x16x32_bf16 v[84:87], a[224:227], a[184:187], v[84:87]
    ds_read_b64_tr_b16 a[212:213], v239 offset:3072
    v_mfma_f32_16x16x32_bf16 v[84:87], a[228:231], a[200:203], v[84:87]
    ds_read_b64_tr_b16 a[214:215], v239 offset:4096
    v_mfma_f32_16x16x32_bf16 v[88:91], a[228:231], a[204:207], v[88:91]
    buffer_load_dwordx4 a[92:95], v208, s[36:39], s51 offen offset:3072 sc1
    v_mfma_f32_16x16x32_bf16 v[88:91], a[224:227], a[188:191], v[88:91]
    s_waitcnt lgkmcnt(8)
    s_add_u32 s51, s51, 4096
    v_mfma_f32_16x16x32_bf16 v[120:123], a[232:235], a[188:191], v[120:123]
    ds_read_b64_tr_b16 a[216:217], v232 offset:31744
    v_mfma_f32_16x16x32_bf16 v[120:123], a[236:239], a[204:207], v[120:123]
    ds_read_b64_tr_b16 a[218:219], v232 offset:32768
    v_mfma_f32_16x16x32_bf16 v[116:119], a[236:239], a[200:203], v[116:119]
    v_mfma_f32_16x16x32_bf16 v[116:119], a[232:235], a[184:187], v[116:119]
    v_mfma_f32_16x16x32_bf16 v[112:115], a[232:235], a[180:183], v[112:115]
    ds_read_b64_tr_b16 a[220:221], v240 offset:3072
    v_mfma_f32_16x16x32_bf16 v[112:115], a[236:239], a[196:199], v[112:115]
    s_add_u32 m0, s50, 119808
    ds_read_b64_tr_b16 a[222:223], v240 offset:4096
    v_mfma_f32_16x16x32_bf16 v[92:95], a[236:239], a[192:195], v[92:95]
    buffer_load_dwordx4 v209, s[32:35], s47 offen lds
    v_mfma_f32_16x16x32_bf16 v[92:95], a[232:235], a[176:179], v[92:95]
    s_waitcnt lgkmcnt(8)
    v_mfma_f32_16x16x32_bf16 v[124:127], a[240:243], a[176:179], v[124:127]
    ds_read_b64_tr_b16 a[224:225], v233 offset:31744
    v_mfma_f32_16x16x32_bf16 v[124:127], a[244:247], a[192:195], v[124:127]
    ds_read_b64_tr_b16 a[226:227], v233 offset:32768
    v_mfma_f32_16x16x32_bf16 v[144:147], a[244:247], a[196:199], v[144:147]
    buffer_load_dwordx4 v210, s[32:35], s47 offen offset:1024 lds
    v_mfma_f32_16x16x32_bf16 v[144:147], a[240:243], a[180:183], v[144:147]
    s_add_u32 s47, s47, 65536
    v_mfma_f32_16x16x32_bf16 v[148:151], a[240:243], a[184:187], v[148:151]
    ds_read_b64_tr_b16 a[228:229], v241 offset:3072
    v_mfma_f32_16x16x32_bf16 v[148:151], a[244:247], a[200:203], v[148:151]
    ds_read_b64_tr_b16 a[230:231], v241 offset:4096
    v_mfma_f32_16x16x32_bf16 v[152:155], a[244:247], a[204:207], v[152:155]
    buffer_load_dwordx4 a[96:99], v208, s[36:39], s51 offen offset:0 sc1
    v_mfma_f32_16x16x32_bf16 v[152:155], a[240:243], a[188:191], v[152:155]
    s_waitcnt lgkmcnt(8)
    v_mfma_f32_16x16x32_bf16 v[184:187], a[208:211], a[188:191], v[184:187]
    ds_read_b64_tr_b16 a[232:233], v234 offset:31744
    v_mfma_f32_16x16x32_bf16 v[184:187], a[212:215], a[204:207], v[184:187]
    ds_read_b64_tr_b16 a[234:235], v234 offset:32768
    v_mfma_f32_16x16x32_bf16 v[180:183], a[212:215], a[200:203], v[180:183]
    buffer_load_dwordx4 a[104:107], v208, s[36:39], s51 offen offset:1024 sc1
    v_mfma_f32_16x16x32_bf16 v[180:183], a[208:211], a[184:187], v[180:183]
    v_mfma_f32_16x16x32_bf16 v[176:179], a[208:211], a[180:183], v[176:179]
    ds_read_b64_tr_b16 a[236:237], v242 offset:3072
    v_mfma_f32_16x16x32_bf16 v[176:179], a[212:215], a[196:199], v[176:179]
    ds_read_b64_tr_b16 a[238:239], v242 offset:4096
    v_mfma_f32_16x16x32_bf16 v[156:159], a[212:215], a[192:195], v[156:159]
    v_mfma_f32_16x16x32_bf16 v[156:159], a[208:211], a[176:179], v[156:159]
    s_waitcnt vmcnt(28) lgkmcnt(8)
    v_mfma_f32_16x16x32_bf16 v[0:3], a[216:219], a[0:3], v[0:3]
    ds_read_b64_tr_b16 a[240:241], v235 offset:31744
    v_mfma_f32_16x16x32_bf16 v[0:3], a[220:223], a[16:19], v[0:3]
    ds_read_b64_tr_b16 a[242:243], v235 offset:32768
    v_mfma_f32_16x16x32_bf16 v[4:7], a[220:223], a[20:23], v[4:7]
    buffer_load_dwordx4 a[100:103], v208, s[36:39], s51 offen offset:2048 sc1
    v_mfma_f32_16x16x32_bf16 v[4:7], a[216:219], a[4:7], v[4:7]
    v_mfma_f32_16x16x32_bf16 v[8:11], a[216:219], a[8:11], v[8:11]
    ds_read_b64_tr_b16 a[244:245], v243 offset:3072
    v_mfma_f32_16x16x32_bf16 v[8:11], a[220:223], a[24:27], v[8:11]
    ds_read_b64_tr_b16 a[246:247], v243 offset:4096
    v_mfma_f32_16x16x32_bf16 v[12:15], a[220:223], a[28:31], v[12:15]
    buffer_load_dwordx4 a[108:111], v208, s[36:39], s51 offen offset:3072 sc1
    v_mfma_f32_16x16x32_bf16 v[12:15], a[216:219], a[12:15], v[12:15]
    s_waitcnt lgkmcnt(8)
    s_add_u32 s51, s51, 4096
    s_barrier
    v_mfma_f32_16x16x32_bf16 v[28:31], a[224:227], a[12:15], v[28:31]
    ds_read_b64_tr_b16 a[208:209], v236 offset:31744
    v_mfma_f32_16x16x32_bf16 v[28:31], a[228:231], a[28:31], v[28:31]
    s_add_u32 m0, s50, 1024
    ds_read_b64_tr_b16 a[210:211], v236 offset:32768
    v_mfma_f32_16x16x32_bf16 v[24:27], a[228:231], a[24:27], v[24:27]
    buffer_load_dwordx4 v209, s[32:35], s47 offen lds
    v_mfma_f32_16x16x32_bf16 v[24:27], a[224:227], a[8:11], v[24:27]
    v_mfma_f32_16x16x32_bf16 v[20:23], a[224:227], a[4:7], v[20:23]
    ds_read_b64_tr_b16 a[212:213], v244 offset:3072
    v_mfma_f32_16x16x32_bf16 v[20:23], a[228:231], a[20:23], v[20:23]
    ds_read_b64_tr_b16 a[214:215], v244 offset:4096
    v_mfma_f32_16x16x32_bf16 v[16:19], a[228:231], a[16:19], v[16:19]
    buffer_load_dwordx4 v210, s[32:35], s47 offen offset:1024 lds
    v_mfma_f32_16x16x32_bf16 v[16:19], a[224:227], a[0:3], v[16:19]
    s_waitcnt lgkmcnt(8)
    s_add_u32 s47, s47, 65536
    v_mfma_f32_16x16x32_bf16 v[32:35], a[232:235], a[0:3], v[32:35]
    ds_read_b64_tr_b16 a[216:217], v237 offset:31744
    v_mfma_f32_16x16x32_bf16 v[32:35], a[236:239], a[16:19], v[32:35]
    ds_read_b64_tr_b16 a[218:219], v237 offset:32768
    v_mfma_f32_16x16x32_bf16 v[36:39], a[236:239], a[20:23], v[36:39]
    v_mfma_f32_16x16x32_bf16 v[36:39], a[232:235], a[4:7], v[36:39]
    v_mfma_f32_16x16x32_bf16 v[44:47], a[232:235], a[8:11], v[44:47]
    ds_read_b64_tr_b16 a[220:221], v245 offset:3072
    v_mfma_f32_16x16x32_bf16 v[44:47], a[236:239], a[24:27], v[44:47]
    ds_read_b64_tr_b16 a[222:223], v245 offset:4096
    v_mfma_f32_16x16x32_bf16 v[48:51], a[236:239], a[28:31], v[48:51]
    buffer_load_dwordx4 a[112:115], v208, s[36:39], s51 offen offset:0 sc1
    v_mfma_f32_16x16x32_bf16 v[48:51], a[232:235], a[12:15], v[48:51]
    s_waitcnt lgkmcnt(8)
    v_mfma_f32_16x16x32_bf16 v[68:71], a[240:243], a[12:15], v[68:71]
    ds_read_b64_tr_b16 a[224:225], v238 offset:31744
    v_mfma_f32_16x16x32_bf16 v[68:71], a[244:247], a[28:31], v[68:71]
    ds_read_b64_tr_b16 a[226:227], v238 offset:32768
    v_mfma_f32_16x16x32_bf16 v[64:67], a[244:247], a[24:27], v[64:67]
    buffer_load_dwordx4 a[120:123], v208, s[36:39], s51 offen offset:1024 sc1
    v_mfma_f32_16x16x32_bf16 v[64:67], a[240:243], a[8:11], v[64:67]
    v_mfma_f32_16x16x32_bf16 v[60:63], a[240:243], a[4:7], v[60:63]
    ds_read_b64_tr_b16 a[228:229], v246 offset:3072
    v_mfma_f32_16x16x32_bf16 v[60:63], a[244:247], a[20:23], v[60:63]
    ds_read_b64_tr_b16 a[230:231], v246 offset:4096
    v_mfma_f32_16x16x32_bf16 v[52:55], a[244:247], a[16:19], v[52:55]
    buffer_load_dwordx4 a[116:119], v208, s[36:39], s51 offen offset:2048 sc1
    v_mfma_f32_16x16x32_bf16 v[52:55], a[240:243], a[0:3], v[52:55]
    s_waitcnt lgkmcnt(8)
    v_mfma_f32_16x16x32_bf16 v[76:79], a[208:211], a[0:3], v[76:79]
    ds_read_b64_tr_b16 a[232:233], v239 offset:31744
    v_mfma_f32_16x16x32_bf16 v[76:79], a[212:215], a[16:19], v[76:79]
    ds_read_b64_tr_b16 a[234:235], v239 offset:32768
    v_mfma_f32_16x16x32_bf16 v[80:83], a[212:215], a[20:23], v[80:83]
    buffer_load_dwordx4 a[124:127], v208, s[36:39], s51 offen offset:3072 sc1
    v_mfma_f32_16x16x32_bf16 v[80:83], a[208:211], a[4:7], v[80:83]
    s_add_u32 s51, s51, 4096
    v_mfma_f32_16x16x32_bf16 v[84:87], a[208:211], a[8:11], v[84:87]
    ds_read_b64_tr_b16 a[236:237], v247 offset:3072
    v_mfma_f32_16x16x32_bf16 v[84:87], a[212:215], a[24:27], v[84:87]
    ds_read_b64_tr_b16 a[238:239], v247 offset:4096
    v_mfma_f32_16x16x32_bf16 v[88:91], a[212:215], a[28:31], v[88:91]
    v_mfma_f32_16x16x32_bf16 v[88:91], a[208:211], a[12:15], v[88:91]
    s_waitcnt lgkmcnt(8)
    v_mfma_f32_16x16x32_bf16 v[120:123], a[216:219], a[12:15], v[120:123]
    ds_read_b64_tr_b16 a[240:241], v232 offset:5120
    v_mfma_f32_16x16x32_bf16 v[120:123], a[220:223], a[28:31], v[120:123]
    s_add_u32 m0, s50, 29696
    ds_read_b64_tr_b16 a[242:243], v232 offset:6144
    v_mfma_f32_16x16x32_bf16 v[116:119], a[220:223], a[24:27], v[116:119]
    buffer_load_dwordx4 v209, s[32:35], s47 offen lds
    v_mfma_f32_16x16x32_bf16 v[116:119], a[216:219], a[8:11], v[116:119]
    buffer_load_dwordx4 v210, s[32:35], s47 offen offset:1024 lds
    s_waitcnt vmcnt(36)
    s_barrier
    v_mfma_f32_16x16x32_bf16 v[112:115], a[216:219], a[4:7], v[112:115]
    s_add_u32 s47, s47, 65536
    ds_read_b64_tr_b16 a[244:245], v232 offset:33792
    v_mfma_f32_16x16x32_bf16 v[112:115], a[220:223], a[20:23], v[112:115]
    ds_read_b64_tr_b16 a[246:247], v232 offset:34816
    v_mfma_f32_16x16x32_bf16 v[92:95], a[220:223], a[16:19], v[92:95]
    v_mfma_f32_16x16x32_bf16 v[92:95], a[216:219], a[0:3], v[92:95]
    s_waitcnt lgkmcnt(8)
    v_mfma_f32_16x16x32_bf16 v[124:127], a[224:227], a[0:3], v[124:127]
    ds_read_b64_tr_b16 a[208:209], v233 offset:5120
    v_mfma_f32_16x16x32_bf16 v[124:127], a[228:231], a[16:19], v[124:127]
    ds_read_b64_tr_b16 a[210:211], v233 offset:6144
    v_mfma_f32_16x16x32_bf16 v[144:147], a[228:231], a[20:23], v[144:147]
    buffer_load_dwordx4 a[128:131], v208, s[36:39], s51 offen offset:0 sc1
    v_mfma_f32_16x16x32_bf16 v[144:147], a[224:227], a[4:7], v[144:147]
    v_mfma_f32_16x16x32_bf16 v[148:151], a[224:227], a[8:11], v[148:151]
    ds_read_b64_tr_b16 a[212:213], v233 offset:33792
    v_mfma_f32_16x16x32_bf16 v[148:151], a[228:231], a[24:27], v[148:151]
    ds_read_b64_tr_b16 a[214:215], v233 offset:34816
    v_mfma_f32_16x16x32_bf16 v[152:155], a[228:231], a[28:31], v[152:155]
    buffer_load_dwordx4 a[136:139], v208, s[36:39], s51 offen offset:1024 sc1
    v_mfma_f32_16x16x32_bf16 v[152:155], a[224:227], a[12:15], v[152:155]
    s_waitcnt lgkmcnt(8)
    v_mfma_f32_16x16x32_bf16 v[184:187], a[232:235], a[12:15], v[184:187]
    ds_read_b64_tr_b16 a[216:217], v234 offset:5120
    v_mfma_f32_16x16x32_bf16 v[184:187], a[236:239], a[28:31], v[184:187]
    ds_read_b64_tr_b16 a[218:219], v234 offset:6144
    v_mfma_f32_16x16x32_bf16 v[180:183], a[236:239], a[24:27], v[180:183]
    buffer_load_dwordx4 a[132:135], v208, s[36:39], s51 offen offset:2048 sc1
    v_mfma_f32_16x16x32_bf16 v[180:183], a[232:235], a[8:11], v[180:183]
    v_mfma_f32_16x16x32_bf16 v[176:179], a[232:235], a[4:7], v[176:179]
    ds_read_b64_tr_b16 a[220:221], v234 offset:33792
    v_mfma_f32_16x16x32_bf16 v[176:179], a[236:239], a[20:23], v[176:179]
    ds_read_b64_tr_b16 a[222:223], v234 offset:34816
    v_mfma_f32_16x16x32_bf16 v[156:159], a[236:239], a[16:19], v[156:159]
    v_mfma_f32_16x16x32_bf16 v[156:159], a[232:235], a[0:3], v[156:159]
    s_waitcnt vmcnt(29) lgkmcnt(8)
    v_mfma_f32_16x16x32_bf16 v[0:3], a[240:243], a[32:35], v[0:3]
    ds_read_b64_tr_b16 a[224:225], v235 offset:5120
    v_mfma_f32_16x16x32_bf16 v[0:3], a[244:247], a[48:51], v[0:3]
    ds_read_b64_tr_b16 a[226:227], v235 offset:6144
    v_mfma_f32_16x16x32_bf16 v[4:7], a[244:247], a[52:55], v[4:7]
    buffer_load_dwordx4 a[140:143], v208, s[36:39], s51 offen offset:3072 sc1
    v_mfma_f32_16x16x32_bf16 v[4:7], a[240:243], a[36:39], v[4:7]
    s_add_u32 s51, s51, 4096
    v_mfma_f32_16x16x32_bf16 v[8:11], a[240:243], a[40:43], v[8:11]
    ds_read_b64_tr_b16 a[228:229], v235 offset:33792
    v_mfma_f32_16x16x32_bf16 v[8:11], a[244:247], a[56:59], v[8:11]
    s_add_u32 m0, s50, 58368
    ds_read_b64_tr_b16 a[230:231], v235 offset:34816
    v_mfma_f32_16x16x32_bf16 v[12:15], a[244:247], a[60:63], v[12:15]
    buffer_load_dwordx4 v209, s[32:35], s47 offen lds
    v_mfma_f32_16x16x32_bf16 v[12:15], a[240:243], a[44:47], v[12:15]
    s_waitcnt lgkmcnt(8)
    s_barrier
    v_mfma_f32_16x16x32_bf16 v[28:31], a[208:211], a[44:47], v[28:31]
    ds_read_b64_tr_b16 a[232:233], v236 offset:5120
    v_mfma_f32_16x16x32_bf16 v[28:31], a[212:215], a[60:63], v[28:31]
    ds_read_b64_tr_b16 a[234:235], v236 offset:6144
    v_mfma_f32_16x16x32_bf16 v[24:27], a[212:215], a[56:59], v[24:27]
    buffer_load_dwordx4 v210, s[32:35], s47 offen offset:1024 lds
    v_mfma_f32_16x16x32_bf16 v[24:27], a[208:211], a[40:43], v[24:27]
    s_add_u32 s47, s47, 65536
    v_mfma_f32_16x16x32_bf16 v[20:23], a[208:211], a[36:39], v[20:23]
    ds_read_b64_tr_b16 a[236:237], v236 offset:33792
    v_mfma_f32_16x16x32_bf16 v[20:23], a[212:215], a[52:55], v[20:23]
    ds_read_b64_tr_b16 a[238:239], v236 offset:34816
    v_mfma_f32_16x16x32_bf16 v[16:19], a[212:215], a[48:51], v[16:19]
    buffer_load_dwordx4 a[144:147], v208, s[36:39], s51 offen offset:0 sc1
    v_mfma_f32_16x16x32_bf16 v[16:19], a[208:211], a[32:35], v[16:19]
    s_waitcnt lgkmcnt(8)
    v_mfma_f32_16x16x32_bf16 v[32:35], a[216:219], a[32:35], v[32:35]
    s_waitcnt vmcnt(21)
    ds_read_b64_tr_b16 a[240:241], v237 offset:5120
    v_accvgpr_mov_b32 a252, a82
    v_mfma_f32_16x16x32_bf16 v[32:35], a[220:223], a[48:51], v[32:35]
    ds_read_b64_tr_b16 a[242:243], v237 offset:6144
    v_accvgpr_mov_b32 a82, a84
    v_mfma_f32_16x16x32_bf16 v[36:39], a[220:223], a[52:55], v[36:39]
    v_accvgpr_mov_b32 a84, a252
    v_accvgpr_mov_b32 a252, a83
    v_mfma_f32_16x16x32_bf16 v[36:39], a[216:219], a[36:39], v[36:39]
    v_accvgpr_mov_b32 a83, a85
    v_accvgpr_mov_b32 a85, a252
    v_mfma_f32_16x16x32_bf16 v[44:47], a[216:219], a[40:43], v[44:47]
    ds_read_b64_tr_b16 a[244:245], v237 offset:33792
    v_accvgpr_mov_b32 a252, a90
    v_mfma_f32_16x16x32_bf16 v[44:47], a[220:223], a[56:59], v[44:47]
    ds_read_b64_tr_b16 a[246:247], v237 offset:34816
    v_accvgpr_mov_b32 a90, a92
    v_mfma_f32_16x16x32_bf16 v[48:51], a[220:223], a[60:63], v[48:51]
    buffer_load_dwordx4 a[148:151], v208, s[36:39], s51 offen offset:1024 sc1
    v_mfma_f32_16x16x32_bf16 v[48:51], a[216:219], a[44:47], v[48:51]
    s_waitcnt lgkmcnt(8)
    v_accvgpr_mov_b32 a92, a252
    v_accvgpr_mov_b32 a252, a91
    v_mfma_f32_16x16x32_bf16 v[68:71], a[224:227], a[44:47], v[68:71]
    ds_read_b64_tr_b16 a[208:209], v238 offset:5120
    v_accvgpr_mov_b32 a91, a93
    v_mfma_f32_16x16x32_bf16 v[68:71], a[228:231], a[60:63], v[68:71]
    ds_read_b64_tr_b16 a[210:211], v238 offset:6144
    v_accvgpr_mov_b32 a93, a252
    v_mfma_f32_16x16x32_bf16 v[64:67], a[228:231], a[56:59], v[64:67]
    buffer_load_dwordx4 a[152:155], v208, s[36:39], s51 offen offset:2048 sc1
    v_mfma_f32_16x16x32_bf16 v[64:67], a[224:227], a[40:43], v[64:67]
    v_mfma_f32_16x16x32_bf16 v[60:63], a[224:227], a[36:39], v[60:63]
    ds_read_b64_tr_b16 a[212:213], v238 offset:33792
    v_mfma_f32_16x16x32_bf16 v[60:63], a[228:231], a[52:55], v[60:63]
    ds_read_b64_tr_b16 a[214:215], v238 offset:34816
    v_mfma_f32_16x16x32_bf16 v[52:55], a[228:231], a[48:51], v[52:55]
    buffer_load_dwordx4 a[156:159], v208, s[36:39], s51 offen offset:3072 sc1
    v_mfma_f32_16x16x32_bf16 v[52:55], a[224:227], a[32:35], v[52:55]
    s_waitcnt lgkmcnt(8)
    s_add_u32 s51, s51, 4096
    v_mfma_f32_16x16x32_bf16 v[76:79], a[232:235], a[32:35], v[76:79]
    ds_read_b64_tr_b16 a[216:217], v239 offset:5120
    v_mfma_f32_16x16x32_bf16 v[76:79], a[236:239], a[48:51], v[76:79]
    s_add_u32 m0, s50, 3072
    ds_read_b64_tr_b16 a[218:219], v239 offset:6144
    v_mfma_f32_16x16x32_bf16 v[80:83], a[236:239], a[52:55], v[80:83]
    buffer_load_dwordx4 v209, s[32:35], s47 offen lds
    v_mfma_f32_16x16x32_bf16 v[80:83], a[232:235], a[36:39], v[80:83]
    v_mfma_f32_16x16x32_bf16 v[84:87], a[232:235], a[40:43], v[84:87]
    ds_read_b64_tr_b16 a[220:221], v239 offset:33792
    v_mfma_f32_16x16x32_bf16 v[84:87], a[236:239], a[56:59], v[84:87]
    ds_read_b64_tr_b16 a[222:223], v239 offset:34816
    v_mfma_f32_16x16x32_bf16 v[88:91], a[236:239], a[60:63], v[88:91]
    buffer_load_dwordx4 v210, s[32:35], s47 offen offset:1024 lds
    v_mfma_f32_16x16x32_bf16 v[88:91], a[232:235], a[44:47], v[88:91]
    s_waitcnt lgkmcnt(8)
    s_add_u32 s47, s47, 65536
    v_mfma_f32_16x16x32_bf16 v[120:123], a[240:243], a[44:47], v[120:123]
    ds_read_b64_tr_b16 a[224:225], v240 offset:5120
    v_mfma_f32_16x16x32_bf16 v[120:123], a[244:247], a[60:63], v[120:123]
    ds_read_b64_tr_b16 a[226:227], v240 offset:6144
    v_mfma_f32_16x16x32_bf16 v[116:119], a[244:247], a[56:59], v[116:119]
    v_mfma_f32_16x16x32_bf16 v[116:119], a[240:243], a[40:43], v[116:119]
    v_mfma_f32_16x16x32_bf16 v[112:115], a[240:243], a[36:39], v[112:115]
    ds_read_b64_tr_b16 a[228:229], v240 offset:29696
    v_mfma_f32_16x16x32_bf16 v[112:115], a[244:247], a[52:55], v[112:115]
    ds_read_b64_tr_b16 a[230:231], v240 offset:30720
    v_mfma_f32_16x16x32_bf16 v[92:95], a[244:247], a[48:51], v[92:95]
    buffer_load_dwordx4 a[160:163], v208, s[36:39], s51 offen offset:0 sc1
    v_mfma_f32_16x16x32_bf16 v[92:95], a[240:243], a[32:35], v[92:95]
    s_waitcnt lgkmcnt(8)
    v_mfma_f32_16x16x32_bf16 v[124:127], a[208:211], a[32:35], v[124:127]
    ds_read_b64_tr_b16 a[232:233], v241 offset:5120
    v_mfma_f32_16x16x32_bf16 v[124:127], a[212:215], a[48:51], v[124:127]
    ds_read_b64_tr_b16 a[234:235], v241 offset:6144
    v_mfma_f32_16x16x32_bf16 v[144:147], a[212:215], a[52:55], v[144:147]
    buffer_load_dwordx4 a[164:167], v208, s[36:39], s51 offen offset:1024 sc1
    v_mfma_f32_16x16x32_bf16 v[144:147], a[208:211], a[36:39], v[144:147]
    v_mfma_f32_16x16x32_bf16 v[148:151], a[208:211], a[40:43], v[148:151]
    ds_read_b64_tr_b16 a[236:237], v241 offset:29696
    v_mfma_f32_16x16x32_bf16 v[148:151], a[212:215], a[56:59], v[148:151]
    ds_read_b64_tr_b16 a[238:239], v241 offset:30720
    v_mfma_f32_16x16x32_bf16 v[152:155], a[212:215], a[60:63], v[152:155]
    buffer_load_dwordx4 a[168:171], v208, s[36:39], s51 offen offset:2048 sc1
    v_mfma_f32_16x16x32_bf16 v[152:155], a[208:211], a[44:47], v[152:155]
    s_waitcnt lgkmcnt(8)
    v_mfma_f32_16x16x32_bf16 v[184:187], a[216:219], a[44:47], v[184:187]
    ds_read_b64_tr_b16 a[240:241], v242 offset:5120
    v_mfma_f32_16x16x32_bf16 v[184:187], a[220:223], a[60:63], v[184:187]
    ds_read_b64_tr_b16 a[242:243], v242 offset:6144
    v_mfma_f32_16x16x32_bf16 v[180:183], a[220:223], a[56:59], v[180:183]
    v_mfma_f32_16x16x32_bf16 v[180:183], a[216:219], a[40:43], v[180:183]
    v_mfma_f32_16x16x32_bf16 v[176:179], a[216:219], a[36:39], v[176:179]
    ds_read_b64_tr_b16 a[244:245], v242 offset:29696
    v_mfma_f32_16x16x32_bf16 v[176:179], a[220:223], a[52:55], v[176:179]
    ds_read_b64_tr_b16 a[246:247], v242 offset:30720
    v_mfma_f32_16x16x32_bf16 v[156:159], a[220:223], a[48:51], v[156:159]
    buffer_load_dwordx4 a[172:175], v208, s[36:39], s51 offen offset:3072 sc1
    v_mfma_f32_16x16x32_bf16 v[156:159], a[216:219], a[32:35], v[156:159]
    s_waitcnt lgkmcnt(8)
    s_add_u32 s51, s51, 4096
    v_mfma_f32_16x16x32_bf16 v[0:3], a[224:227], a[64:67], v[0:3]
    ds_read_b64_tr_b16 a[208:209], v243 offset:5120
    v_mfma_f32_16x16x32_bf16 v[0:3], a[228:231], a[80:83], v[0:3]
    s_add_u32 m0, s50, 31744
    ds_read_b64_tr_b16 a[210:211], v243 offset:6144
    v_mfma_f32_16x16x32_bf16 v[4:7], a[228:231], a[84:87], v[4:7]
    buffer_load_dwordx4 v209, s[32:35], s47 offen lds
    v_mfma_f32_16x16x32_bf16 v[4:7], a[224:227], a[68:71], v[4:7]
    v_mfma_f32_16x16x32_bf16 v[8:11], a[224:227], a[72:75], v[8:11]
    ds_read_b64_tr_b16 a[212:213], v243 offset:29696
    v_mfma_f32_16x16x32_bf16 v[8:11], a[228:231], a[88:91], v[8:11]
    ds_read_b64_tr_b16 a[214:215], v243 offset:30720
    v_mfma_f32_16x16x32_bf16 v[12:15], a[228:231], a[92:95], v[12:15]
    buffer_load_dwordx4 v210, s[32:35], s47 offen offset:1024 lds
    v_mfma_f32_16x16x32_bf16 v[12:15], a[224:227], a[76:79], v[12:15]
    s_waitcnt lgkmcnt(8)
    s_add_u32 s47, s47, 65536
    v_mfma_f32_16x16x32_bf16 v[28:31], a[232:235], a[76:79], v[28:31]
    ds_read_b64_tr_b16 a[216:217], v244 offset:5120
    v_mfma_f32_16x16x32_bf16 v[28:31], a[236:239], a[92:95], v[28:31]
    ds_read_b64_tr_b16 a[218:219], v244 offset:6144
    v_mfma_f32_16x16x32_bf16 v[24:27], a[236:239], a[88:91], v[24:27]
    buffer_load_dwordx4 a[176:179], v208, s[36:39], s51 offen offset:0 sc1
    v_mfma_f32_16x16x32_bf16 v[24:27], a[232:235], a[72:75], v[24:27]
    v_mfma_f32_16x16x32_bf16 v[20:23], a[232:235], a[68:71], v[20:23]
    ds_read_b64_tr_b16 a[220:221], v244 offset:29696
    v_mfma_f32_16x16x32_bf16 v[20:23], a[236:239], a[84:87], v[20:23]
    ds_read_b64_tr_b16 a[222:223], v244 offset:30720
    v_mfma_f32_16x16x32_bf16 v[16:19], a[236:239], a[80:83], v[16:19]
    v_mfma_f32_16x16x32_bf16 v[16:19], a[232:235], a[64:67], v[16:19]
    s_waitcnt lgkmcnt(8)
    v_mfma_f32_16x16x32_bf16 v[32:35], a[240:243], a[64:67], v[32:35]
    s_waitcnt vmcnt(27)
    ds_read_b64_tr_b16 a[224:225], v245 offset:5120
    v_accvgpr_mov_b32 a252, a98
    v_mfma_f32_16x16x32_bf16 v[32:35], a[244:247], a[80:83], v[32:35]
    ds_read_b64_tr_b16 a[226:227], v245 offset:6144
    v_accvgpr_mov_b32 a98, a100
    v_mfma_f32_16x16x32_bf16 v[36:39], a[244:247], a[84:87], v[36:39]
    buffer_load_dwordx4 a[180:183], v208, s[36:39], s51 offen offset:1024 sc1
    v_mfma_f32_16x16x32_bf16 v[36:39], a[240:243], a[68:71], v[36:39]
    v_accvgpr_mov_b32 a100, a252
    v_accvgpr_mov_b32 a252, a99
    v_mfma_f32_16x16x32_bf16 v[44:47], a[240:243], a[72:75], v[44:47]
    ds_read_b64_tr_b16 a[228:229], v245 offset:29696
    v_accvgpr_mov_b32 a99, a101
    v_mfma_f32_16x16x32_bf16 v[44:47], a[244:247], a[88:91], v[44:47]
    ds_read_b64_tr_b16 a[230:231], v245 offset:30720
    v_accvgpr_mov_b32 a101, a252
    v_mfma_f32_16x16x32_bf16 v[48:51], a[244:247], a[92:95], v[48:51]
    buffer_load_dwordx4 a[184:187], v208, s[36:39], s51 offen offset:2048 sc1
    v_mfma_f32_16x16x32_bf16 v[48:51], a[240:243], a[76:79], v[48:51]
    s_waitcnt lgkmcnt(8)
    v_accvgpr_mov_b32 a252, a106
    v_accvgpr_mov_b32 a106, a108
    v_mfma_f32_16x16x32_bf16 v[68:71], a[208:211], a[76:79], v[68:71]
    ds_read_b64_tr_b16 a[232:233], v246 offset:5120
    v_accvgpr_mov_b32 a108, a252
    v_mfma_f32_16x16x32_bf16 v[68:71], a[212:215], a[92:95], v[68:71]
    ds_read_b64_tr_b16 a[234:235], v246 offset:6144
    v_accvgpr_mov_b32 a252, a107
    v_mfma_f32_16x16x32_bf16 v[64:67], a[212:215], a[88:91], v[64:67]
    buffer_load_dwordx4 a[188:191], v208, s[36:39], s51 offen offset:3072 sc1
    v_mfma_f32_16x16x32_bf16 v[64:67], a[208:211], a[72:75], v[64:67]
    s_add_u32 s51, s51, 4096
    v_accvgpr_mov_b32 a107, a109
    v_accvgpr_mov_b32 a109, a252
    v_mfma_f32_16x16x32_bf16 v[60:63], a[208:211], a[68:71], v[60:63]
    ds_read_b64_tr_b16 a[236:237], v246 offset:29696
    s_waitcnt vmcnt(24)
    v_mfma_f32_16x16x32_bf16 v[60:63], a[212:215], a[84:87], v[60:63]
    s_add_u32 m0, s50, 60416
    ds_read_b64_tr_b16 a[238:239], v246 offset:30720
    v_accvgpr_mov_b32 a252, a114
    v_mfma_f32_16x16x32_bf16 v[52:55], a[212:215], a[80:83], v[52:55]
    buffer_load_dwordx4 v209, s[32:35], s47 offen lds
    v_mfma_f32_16x16x32_bf16 v[52:55], a[208:211], a[64:67], v[52:55]
    s_waitcnt lgkmcnt(8)
    v_accvgpr_mov_b32 a114, a116
    v_accvgpr_mov_b32 a116, a252
    v_mfma_f32_16x16x32_bf16 v[76:79], a[216:219], a[64:67], v[76:79]
    ds_read_b64_tr_b16 a[240:241], v247 offset:5120
    v_accvgpr_mov_b32 a252, a115
    v_mfma_f32_16x16x32_bf16 v[76:79], a[220:223], a[80:83], v[76:79]
    ds_read_b64_tr_b16 a[242:243], v247 offset:6144
    v_accvgpr_mov_b32 a115, a117
    v_mfma_f32_16x16x32_bf16 v[80:83], a[220:223], a[84:87], v[80:83]
    buffer_load_dwordx4 v210, s[32:35], s47 offen offset:1024 lds
    v_mfma_f32_16x16x32_bf16 v[80:83], a[216:219], a[68:71], v[80:83]
    v_accvgpr_mov_b32 a117, a252
    v_accvgpr_mov_b32 a252, a122
    v_mfma_f32_16x16x32_bf16 v[84:87], a[216:219], a[72:75], v[84:87]
    ds_read_b64_tr_b16 a[244:245], v247 offset:29696
    v_accvgpr_mov_b32 a122, a124
    v_mfma_f32_16x16x32_bf16 v[84:87], a[220:223], a[88:91], v[84:87]
    ds_read_b64_tr_b16 a[246:247], v247 offset:30720
    v_accvgpr_mov_b32 a124, a252
    v_mfma_f32_16x16x32_bf16 v[88:91], a[220:223], a[92:95], v[88:91]
    v_accvgpr_mov_b32 a252, a123
    v_accvgpr_mov_b32 a123, a125
    v_mfma_f32_16x16x32_bf16 v[88:91], a[216:219], a[76:79], v[88:91]
    s_waitcnt lgkmcnt(8)
    v_accvgpr_mov_b32 a125, a252
    v_mfma_f32_16x16x32_bf16 v[120:123], a[224:227], a[76:79], v[120:123]
    ds_read_b64_tr_b16 a[208:209], v240 offset:31744
    v_mfma_f32_16x16x32_bf16 v[120:123], a[228:231], a[92:95], v[120:123]
    ds_read_b64_tr_b16 a[210:211], v240 offset:32768
    v_mfma_f32_16x16x32_bf16 v[116:119], a[228:231], a[88:91], v[116:119]
    buffer_load_dwordx4 a[192:195], v208, s[36:39], s51 offen offset:0 sc1
    v_mfma_f32_16x16x32_bf16 v[116:119], a[224:227], a[72:75], v[116:119]
    s_barrier
    v_mfma_f32_16x16x32_bf16 v[112:115], a[224:227], a[68:71], v[112:115]
    ds_read_b64_tr_b16 a[212:213], v240 offset:33792
    v_mfma_f32_16x16x32_bf16 v[112:115], a[228:231], a[84:87], v[112:115]
    ds_read_b64_tr_b16 a[214:215], v240 offset:34816
    v_mfma_f32_16x16x32_bf16 v[92:95], a[228:231], a[80:83], v[92:95]
    buffer_load_dwordx4 a[196:199], v208, s[36:39], s51 offen offset:1024 sc1
    v_mfma_f32_16x16x32_bf16 v[92:95], a[224:227], a[64:67], v[92:95]
    s_waitcnt lgkmcnt(8)
    v_mfma_f32_16x16x32_bf16 v[124:127], a[232:235], a[64:67], v[124:127]
    ds_read_b64_tr_b16 a[216:217], v241 offset:31744
    v_mfma_f32_16x16x32_bf16 v[124:127], a[236:239], a[80:83], v[124:127]
    ds_read_b64_tr_b16 a[218:219], v241 offset:32768
    v_mfma_f32_16x16x32_bf16 v[144:147], a[236:239], a[84:87], v[144:147]
    buffer_load_dwordx4 a[200:203], v208, s[36:39], s51 offen offset:2048 sc1
    v_mfma_f32_16x16x32_bf16 v[144:147], a[232:235], a[68:71], v[144:147]
    v_mfma_f32_16x16x32_bf16 v[148:151], a[232:235], a[72:75], v[148:151]
    ds_read_b64_tr_b16 a[220:221], v241 offset:33792
    v_mfma_f32_16x16x32_bf16 v[148:151], a[236:239], a[88:91], v[148:151]
    ds_read_b64_tr_b16 a[222:223], v241 offset:34816
    v_mfma_f32_16x16x32_bf16 v[152:155], a[236:239], a[92:95], v[152:155]
    buffer_load_dwordx4 a[204:207], v208, s[36:39], s51 offen offset:3072 sc1
    v_mfma_f32_16x16x32_bf16 v[152:155], a[232:235], a[76:79], v[152:155]
    s_waitcnt lgkmcnt(8)
    s_add_u32 s51, s51, 4096
    v_mfma_f32_16x16x32_bf16 v[184:187], a[240:243], a[76:79], v[184:187]
    ds_read_b64_tr_b16 a[224:225], v242 offset:31744
    v_mfma_f32_16x16x32_bf16 v[184:187], a[244:247], a[92:95], v[184:187]
    ds_read_b64_tr_b16 a[226:227], v242 offset:32768
    v_mfma_f32_16x16x32_bf16 v[180:183], a[244:247], a[88:91], v[180:183]
    v_mfma_f32_16x16x32_bf16 v[180:183], a[240:243], a[72:75], v[180:183]
    v_mfma_f32_16x16x32_bf16 v[176:179], a[240:243], a[68:71], v[176:179]
    ds_read_b64_tr_b16 a[228:229], v242 offset:33792
    v_mfma_f32_16x16x32_bf16 v[176:179], a[244:247], a[84:87], v[176:179]
    ds_read_b64_tr_b16 a[230:231], v242 offset:34816
    v_mfma_f32_16x16x32_bf16 v[156:159], a[244:247], a[80:83], v[156:159]
    buffer_load_dwordx4 a[0:3], v208, s[36:39], s51 offen offset:0 sc1
    v_mfma_f32_16x16x32_bf16 v[156:159], a[240:243], a[64:67], v[156:159]
    s_waitcnt lgkmcnt(8)
    v_mfma_f32_16x16x32_bf16 v[0:3], a[208:211], a[96:99], v[0:3]
    s_waitcnt vmcnt(25)
    ds_read_b64_tr_b16 a[232:233], v243 offset:31744
    v_accvgpr_mov_b32 a252, a130
    v_mfma_f32_16x16x32_bf16 v[0:3], a[212:215], a[112:115], v[0:3]
    ds_read_b64_tr_b16 a[234:235], v243 offset:32768
    v_accvgpr_mov_b32 a130, a132
    v_mfma_f32_16x16x32_bf16 v[4:7], a[212:215], a[116:119], v[4:7]
    buffer_load_dwordx4 a[4:7], v208, s[36:39], s51 offen offset:1024 sc1
    v_mfma_f32_16x16x32_bf16 v[4:7], a[208:211], a[100:103], v[4:7]
    v_accvgpr_mov_b32 a132, a252
    v_accvgpr_mov_b32 a252, a131
    v_mfma_f32_16x16x32_bf16 v[8:11], a[208:211], a[104:107], v[8:11]
    ds_read_b64_tr_b16 a[236:237], v243 offset:33792
    v_accvgpr_mov_b32 a131, a133
    v_mfma_f32_16x16x32_bf16 v[8:11], a[212:215], a[120:123], v[8:11]
    ds_read_b64_tr_b16 a[238:239], v243 offset:34816
    v_accvgpr_mov_b32 a133, a252
    v_mfma_f32_16x16x32_bf16 v[12:15], a[212:215], a[124:127], v[12:15]
    buffer_load_dwordx4 a[8:11], v208, s[36:39], s51 offen offset:2048 sc1
    v_mfma_f32_16x16x32_bf16 v[12:15], a[208:211], a[108:111], v[12:15]
    s_waitcnt lgkmcnt(8)
    v_accvgpr_mov_b32 a252, a138
    v_accvgpr_mov_b32 a138, a140
    v_mfma_f32_16x16x32_bf16 v[28:31], a[216:219], a[108:111], v[28:31]
    ds_read_b64_tr_b16 a[240:241], v244 offset:31744
    v_accvgpr_mov_b32 a140, a252
    v_mfma_f32_16x16x32_bf16 v[28:31], a[220:223], a[124:127], v[28:31]
    ds_read_b64_tr_b16 a[242:243], v244 offset:32768
    v_accvgpr_mov_b32 a252, a139
    v_mfma_f32_16x16x32_bf16 v[24:27], a[220:223], a[120:123], v[24:27]
    buffer_load_dwordx4 a[12:15], v208, s[36:39], s51 offen offset:3072 sc1
    v_mfma_f32_16x16x32_bf16 v[24:27], a[216:219], a[104:107], v[24:27]
    s_add_u32 s51, s51, 4096
    v_accvgpr_mov_b32 a139, a141
    v_accvgpr_mov_b32 a141, a252
    v_mfma_f32_16x16x32_bf16 v[20:23], a[216:219], a[100:103], v[20:23]
    ds_read_b64_tr_b16 a[244:245], v244 offset:33792
    v_mfma_f32_16x16x32_bf16 v[20:23], a[220:223], a[116:119], v[20:23]
    ds_read_b64_tr_b16 a[246:247], v244 offset:34816
    v_mfma_f32_16x16x32_bf16 v[16:19], a[220:223], a[112:115], v[16:19]
    v_mfma_f32_16x16x32_bf16 v[16:19], a[216:219], a[96:99], v[16:19]
    s_waitcnt lgkmcnt(8)
    v_mfma_f32_16x16x32_bf16 v[32:35], a[224:227], a[96:99], v[32:35]
    ds_read_b64_tr_b16 a[208:209], v245 offset:31744
    v_mfma_f32_16x16x32_bf16 v[32:35], a[228:231], a[112:115], v[32:35]
    ds_read_b64_tr_b16 a[210:211], v245 offset:32768
    v_mfma_f32_16x16x32_bf16 v[36:39], a[228:231], a[116:119], v[36:39]
    buffer_load_dwordx4 a[16:19], v208, s[36:39], s51 offen offset:0 sc1
    v_mfma_f32_16x16x32_bf16 v[36:39], a[224:227], a[100:103], v[36:39]
    v_mfma_f32_16x16x32_bf16 v[44:47], a[224:227], a[104:107], v[44:47]
    ds_read_b64_tr_b16 a[212:213], v245 offset:33792
    v_mfma_f32_16x16x32_bf16 v[44:47], a[228:231], a[120:123], v[44:47]
    ds_read_b64_tr_b16 a[214:215], v245 offset:34816
    v_mfma_f32_16x16x32_bf16 v[48:51], a[228:231], a[124:127], v[48:51]
    buffer_load_dwordx4 a[20:23], v208, s[36:39], s51 offen offset:1024 sc1
    v_mfma_f32_16x16x32_bf16 v[48:51], a[224:227], a[108:111], v[48:51]
    s_waitcnt lgkmcnt(8)
    v_mfma_f32_16x16x32_bf16 v[68:71], a[232:235], a[108:111], v[68:71]
    ds_read_b64_tr_b16 a[216:217], v248 offset:1024
    v_mfma_f32_16x16x32_bf16 v[68:71], a[236:239], a[124:127], v[68:71]
    ds_read_b64_tr_b16 a[218:219], v248 offset:2048
    v_mfma_f32_16x16x32_bf16 v[64:67], a[236:239], a[120:123], v[64:67]
    buffer_load_dwordx4 a[24:27], v208, s[36:39], s51 offen offset:2048 sc1
    v_mfma_f32_16x16x32_bf16 v[64:67], a[232:235], a[104:107], v[64:67]
    v_mfma_f32_16x16x32_bf16 v[60:63], a[232:235], a[100:103], v[60:63]
    ds_read_b64_tr_b16 a[220:221], v249 offset:1024
    v_mfma_f32_16x16x32_bf16 v[60:63], a[236:239], a[116:119], v[60:63]
    ds_read_b64_tr_b16 a[222:223], v249 offset:2048
    v_mfma_f32_16x16x32_bf16 v[52:55], a[236:239], a[112:115], v[52:55]
    buffer_load_dwordx4 a[28:31], v208, s[36:39], s51 offen offset:3072 sc1
    v_mfma_f32_16x16x32_bf16 v[52:55], a[232:235], a[96:99], v[52:55]
    s_waitcnt lgkmcnt(8)
    s_add_u32 s51, s51, 4096
    v_mfma_f32_16x16x32_bf16 v[76:79], a[240:243], a[96:99], v[76:79]
    ds_read_b64_tr_b16 a[224:225], v250 offset:1024
    v_mfma_f32_16x16x32_bf16 v[76:79], a[244:247], a[112:115], v[76:79]
    ds_read_b64_tr_b16 a[226:227], v250 offset:2048
    v_mfma_f32_16x16x32_bf16 v[80:83], a[244:247], a[116:119], v[80:83]
    buffer_load_dwordx4 a[32:35], v208, s[36:39], s51 offen offset:0 sc1
    v_mfma_f32_16x16x32_bf16 v[80:83], a[240:243], a[100:103], v[80:83]
    v_mfma_f32_16x16x32_bf16 v[84:87], a[240:243], a[104:107], v[84:87]
    ds_read_b64_tr_b16 a[228:229], v251 offset:1024
    v_mfma_f32_16x16x32_bf16 v[84:87], a[244:247], a[120:123], v[84:87]
    ds_read_b64_tr_b16 a[230:231], v251 offset:2048
    v_mfma_f32_16x16x32_bf16 v[88:91], a[244:247], a[124:127], v[88:91]
    buffer_load_dwordx4 a[36:39], v208, s[36:39], s51 offen offset:1024 sc1
    v_mfma_f32_16x16x32_bf16 v[88:91], a[240:243], a[108:111], v[88:91]
    s_waitcnt lgkmcnt(8)
    v_mfma_f32_16x16x32_bf16 v[120:123], a[208:211], a[108:111], v[120:123]
    ds_read_b64_tr_b16 a[232:233], v252 offset:1024
    v_mfma_f32_16x16x32_bf16 v[120:123], a[212:215], a[124:127], v[120:123]
    ds_read_b64_tr_b16 a[234:235], v252 offset:2048
    v_mfma_f32_16x16x32_bf16 v[116:119], a[212:215], a[120:123], v[116:119]
    buffer_load_dwordx4 a[40:43], v208, s[36:39], s51 offen offset:2048 sc1
    v_mfma_f32_16x16x32_bf16 v[116:119], a[208:211], a[104:107], v[116:119]
    v_mfma_f32_16x16x32_bf16 v[112:115], a[208:211], a[100:103], v[112:115]
    ds_read_b64_tr_b16 a[236:237], v253 offset:1024
    v_mfma_f32_16x16x32_bf16 v[112:115], a[212:215], a[116:119], v[112:115]
    ds_read_b64_tr_b16 a[238:239], v253 offset:2048
    v_mfma_f32_16x16x32_bf16 v[92:95], a[212:215], a[112:115], v[92:95]
    buffer_load_dwordx4 a[44:47], v208, s[36:39], s51 offen offset:3072 sc1
    v_mfma_f32_16x16x32_bf16 v[92:95], a[208:211], a[96:99], v[92:95]
    s_waitcnt lgkmcnt(10)
    s_add_u32 s51, s51, 4096
    v_mfma_f32_16x16x32_bf16 v[0:3], a[216:219], a[128:131], v[0:3]
    ds_read_b64_tr_b16 a[240:241], v248 offset:3072
    v_mfma_f32_16x16x32_bf16 v[4:7], a[216:219], a[132:135], v[4:7]
    ds_read_b64_tr_b16 a[242:243], v248 offset:4096
    v_mfma_f32_16x16x32_bf16 v[8:11], a[216:219], a[136:139], v[8:11]
    buffer_load_dwordx4 a[48:51], v208, s[36:39], s51 offen offset:0 sc1
    v_mfma_f32_16x16x32_bf16 v[12:15], a[216:219], a[140:143], v[12:15]
    s_waitcnt lgkmcnt(10)
    v_mfma_f32_16x16x32_bf16 v[28:31], a[220:223], a[140:143], v[28:31]
    ds_read_b64_tr_b16 a[244:245], v248 offset:5120
    v_mfma_f32_16x16x32_bf16 v[24:27], a[220:223], a[136:139], v[24:27]
    ds_read_b64_tr_b16 a[246:247], v248 offset:6144
    v_mfma_f32_16x16x32_bf16 v[20:23], a[220:223], a[132:135], v[20:23]
    buffer_load_dwordx4 a[52:55], v208, s[36:39], s51 offen offset:1024 sc1
    v_mfma_f32_16x16x32_bf16 v[16:19], a[220:223], a[128:131], v[16:19]
    s_waitcnt lgkmcnt(10)
    s_waitcnt vmcnt(30)
    s_barrier
    v_mfma_f32_16x16x32_bf16 v[32:35], a[224:227], a[128:131], v[32:35]
    ds_read_b64_tr_b16 a[208:209], v232 offset:1024
    v_mfma_f32_16x16x32_bf16 v[36:39], a[224:227], a[132:135], v[36:39]
    ds_read_b64_tr_b16 a[210:211], v232 offset:2048
    v_mfma_f32_16x16x32_bf16 v[44:47], a[224:227], a[136:139], v[44:47]
    buffer_load_dwordx4 a[56:59], v208, s[36:39], s51 offen offset:2048 sc1
    v_mfma_f32_16x16x32_bf16 v[48:51], a[224:227], a[140:143], v[48:51]
    s_waitcnt lgkmcnt(10)
    v_mfma_f32_16x16x32_bf16 v[68:71], a[228:231], a[140:143], v[68:71]
    ds_read_b64_tr_b16 a[212:213], v232 offset:29696
    v_mfma_f32_16x16x32_bf16 v[64:67], a[228:231], a[136:139], v[64:67]
    ds_read_b64_tr_b16 a[214:215], v232 offset:30720
    v_mfma_f32_16x16x32_bf16 v[60:63], a[228:231], a[132:135], v[60:63]
    buffer_load_dwordx4 a[60:63], v208, s[36:39], s51 offen offset:3072 sc1
    v_mfma_f32_16x16x32_bf16 v[52:55], a[228:231], a[128:131], v[52:55]
    s_waitcnt lgkmcnt(10)
    v_mfma_f32_16x16x32_bf16 v[76:79], a[232:235], a[128:131], v[76:79]
    s_mul_i32 s54, s40, 5120
    ds_read_b64_tr_b16 a[216:217], v249 offset:3072
    s_add_u32 m0, s54, 143360
    v_mfma_f32_16x16x32_bf16 v[80:83], a[232:235], a[132:135], v[80:83]
    ds_read_b64_tr_b16 a[218:219], v249 offset:4096
    v_mfma_f32_16x16x32_bf16 v[84:87], a[232:235], a[136:139], v[84:87]
    buffer_load_dwordx4 v211, s[20:23], s82 offen lds
    v_mfma_f32_16x16x32_bf16 v[88:91], a[232:235], a[140:143], v[88:91]
    s_waitcnt lgkmcnt(10)
    s_add_u32 s82, s82, 32768
    s_add_u32 m0, s54, 144384
    v_mfma_f32_16x16x32_bf16 v[120:123], a[236:239], a[140:143], v[120:123]
    ds_read_b64_tr_b16 a[220:221], v249 offset:5120
    v_mfma_f32_16x16x32_bf16 v[116:119], a[236:239], a[136:139], v[116:119]
    ds_read_b64_tr_b16 a[222:223], v249 offset:6144
    v_mfma_f32_16x16x32_bf16 v[112:115], a[236:239], a[132:135], v[112:115]
    buffer_load_dwordx4 v211, s[20:23], s82 offen lds
    v_mfma_f32_16x16x32_bf16 v[92:95], a[236:239], a[128:131], v[92:95]
    s_waitcnt vmcnt(18) lgkmcnt(4)
    s_add_u32 s82, s82, 32768
    s_add_u32 m0, s54, 145408
    v_mfma_f32_16x16x32_bf16 v[0:3], a[240:243], a[144:147], v[0:3]
    ds_read_b64_tr_b16 a[224:225], v233 offset:1024
    v_mfma_f32_16x16x32_bf16 v[0:3], a[244:247], a[160:163], v[0:3]
    ds_read_b64_tr_b16 a[226:227], v233 offset:2048
    v_mfma_f32_16x16x32_bf16 v[0:3], a[208:211], a[176:179], v[0:3]
    buffer_load_dwordx4 v211, s[20:23], s82 offen lds
    v_mfma_f32_16x16x32_bf16 v[0:3], a[212:215], a[192:195], v[0:3]
    s_add_u32 s82, s82, 32768
    s_add_u32 m0, s54, 146432
    v_mfma_f32_16x16x32_bf16 v[4:7], a[212:215], a[196:199], v[4:7]
    ds_read_b64_tr_b16 a[228:229], v233 offset:29696
    v_mfma_f32_16x16x32_bf16 v[4:7], a[208:211], a[180:183], v[4:7]
    ds_read_b64_tr_b16 a[230:231], v233 offset:30720
    v_mfma_f32_16x16x32_bf16 v[4:7], a[244:247], a[164:167], v[4:7]
    buffer_load_dwordx4 v211, s[20:23], s82 offen lds
    v_mfma_f32_16x16x32_bf16 v[4:7], a[240:243], a[148:151], v[4:7]
    s_add_u32 s82, s82, -98304
    v_mfma_f32_16x16x32_bf16 v[8:11], a[240:243], a[152:155], v[8:11]
    ds_read_b64_tr_b16 a[232:233], v240 offset:1024
    v_mfma_f32_16x16x32_bf16 v[8:11], a[244:247], a[168:171], v[8:11]
    ds_read_b64_tr_b16 a[234:235], v240 offset:2048
    v_mfma_f32_16x16x32_bf16 v[8:11], a[208:211], a[184:187], v[8:11]
    v_mfma_f32_16x16x32_bf16 v[8:11], a[212:215], a[200:203], v[8:11]
    v_mfma_f32_16x16x32_bf16 v[12:15], a[212:215], a[204:207], v[12:15]
    ds_read_b64_tr_b16 a[236:237], v232 offset:3072
    v_mfma_f32_16x16x32_bf16 v[12:15], a[208:211], a[188:191], v[12:15]
    ds_read_b64_tr_b16 a[238:239], v232 offset:4096
    v_mfma_f32_16x16x32_bf16 v[12:15], a[244:247], a[172:175], v[12:15]
    v_mfma_f32_16x16x32_bf16 v[12:15], a[240:243], a[156:159], v[12:15]
    s_waitcnt lgkmcnt(4)
    s_barrier
    v_mfma_f32_16x16x32_bf16 v[28:31], a[216:219], a[156:159], v[28:31]
    ds_read_b64_tr_b16 a[240:241], v232 offset:31744
    v_mfma_f32_16x16x32_bf16 v[28:31], a[220:223], a[172:175], v[28:31]
    ds_read_b64_tr_b16 a[242:243], v232 offset:32768
    v_mfma_f32_16x16x32_bf16 v[28:31], a[224:227], a[188:191], v[28:31]
    v_mfma_f32_16x16x32_bf16 v[28:31], a[228:231], a[204:207], v[28:31]
    v_mfma_f32_16x16x32_bf16 v[24:27], a[228:231], a[200:203], v[24:27]
    ds_read_b64_tr_b16 a[244:245], v240 offset:3072
    v_mfma_f32_16x16x32_bf16 v[24:27], a[224:227], a[184:187], v[24:27]
    ds_read_b64_tr_b16 a[246:247], v240 offset:4096
    v_mfma_f32_16x16x32_bf16 v[24:27], a[220:223], a[168:171], v[24:27]
    v_mfma_f32_16x16x32_bf16 v[24:27], a[216:219], a[152:155], v[24:27]
    v_mfma_f32_16x16x32_bf16 v[20:23], a[216:219], a[148:151], v[20:23]
    ds_read_b64_tr_b16 a[208:209], v241 offset:1024
    v_mfma_f32_16x16x32_bf16 v[20:23], a[220:223], a[164:167], v[20:23]
    ds_read_b64_tr_b16 a[210:211], v241 offset:2048
    v_mfma_f32_16x16x32_bf16 v[20:23], a[224:227], a[180:183], v[20:23]
    v_mfma_f32_16x16x32_bf16 v[20:23], a[228:231], a[196:199], v[20:23]
    v_mfma_f32_16x16x32_bf16 v[16:19], a[228:231], a[192:195], v[16:19]
    ds_read_b64_tr_b16 a[212:213], v233 offset:3072
    v_mfma_f32_16x16x32_bf16 v[16:19], a[224:227], a[176:179], v[16:19]
    ds_read_b64_tr_b16 a[214:215], v233 offset:4096
    v_mfma_f32_16x16x32_bf16 v[16:19], a[220:223], a[160:163], v[16:19]
    v_mfma_f32_16x16x32_bf16 v[16:19], a[216:219], a[144:147], v[16:19]
    s_waitcnt vmcnt(4) lgkmcnt(4)
    v_mfma_f32_16x16x32_bf16 v[0:3], a[232:235], a[0:3], v[0:3]
    ds_read_b64_tr_b16 a[216:217], v233 offset:31744
    v_mfma_f32_16x16x32_bf16 v[0:3], a[236:239], a[16:19], v[0:3]
    ds_read_b64_tr_b16 a[218:219], v233 offset:32768
    v_mfma_f32_16x16x32_bf16 v[0:3], a[240:243], a[32:35], v[0:3]
    v_mfma_f32_16x16x32_bf16 v[0:3], a[244:247], a[48:51], v[0:3]
    v_mfma_f32_16x16x32_bf16 v[4:7], a[244:247], a[52:55], v[4:7]
    ds_read_b64_tr_b16 a[220:221], v241 offset:3072
    v_mfma_f32_16x16x32_bf16 v[4:7], a[240:243], a[36:39], v[4:7]
    ds_read_b64_tr_b16 a[222:223], v241 offset:4096
    v_mfma_f32_16x16x32_bf16 v[4:7], a[236:239], a[20:23], v[4:7]
    v_mfma_f32_16x16x32_bf16 v[4:7], a[232:235], a[4:7], v[4:7]
    v_mfma_f32_16x16x32_bf16 v[8:11], a[232:235], a[8:11], v[8:11]
    ds_read_b64_tr_b16 a[224:225], v250 offset:3072
    v_mfma_f32_16x16x32_bf16 v[8:11], a[236:239], a[24:27], v[8:11]
    ds_read_b64_tr_b16 a[226:227], v250 offset:4096
    v_mfma_f32_16x16x32_bf16 v[8:11], a[240:243], a[40:43], v[8:11]
    v_mfma_f32_16x16x32_bf16 v[8:11], a[244:247], a[56:59], v[8:11]
    v_mfma_f32_16x16x32_bf16 v[12:15], a[244:247], a[60:63], v[12:15]
    ds_read_b64_tr_b16 a[228:229], v250 offset:5120
    v_mfma_f32_16x16x32_bf16 v[12:15], a[240:243], a[44:47], v[12:15]
    ds_read_b64_tr_b16 a[230:231], v250 offset:6144
    v_mfma_f32_16x16x32_bf16 v[12:15], a[236:239], a[28:31], v[12:15]
    v_mfma_f32_16x16x32_bf16 v[12:15], a[232:235], a[12:15], v[12:15]
    s_waitcnt lgkmcnt(4)
    v_mfma_f32_16x16x32_bf16 v[28:31], a[208:211], a[12:15], v[28:31]
    ds_read_b64_tr_b16 a[232:233], v234 offset:1024
    v_mfma_f32_16x16x32_bf16 v[28:31], a[212:215], a[28:31], v[28:31]
    ds_read_b64_tr_b16 a[234:235], v234 offset:2048
    v_mfma_f32_16x16x32_bf16 v[28:31], a[216:219], a[44:47], v[28:31]
    v_mfma_f32_16x16x32_bf16 v[28:31], a[220:223], a[60:63], v[28:31]
    v_mfma_f32_16x16x32_bf16 v[24:27], a[220:223], a[56:59], v[24:27]
    ds_read_b64_tr_b16 a[236:237], v234 offset:29696
    v_mfma_f32_16x16x32_bf16 v[24:27], a[216:219], a[40:43], v[24:27]
    ds_read_b64_tr_b16 a[238:239], v234 offset:30720
    v_mfma_f32_16x16x32_bf16 v[24:27], a[212:215], a[24:27], v[24:27]
    v_mfma_f32_16x16x32_bf16 v[24:27], a[208:211], a[8:11], v[24:27]
    v_mfma_f32_16x16x32_bf16 v[20:23], a[208:211], a[4:7], v[20:23]
    ds_read_b64_tr_b16 a[240:241], v251 offset:3072
    v_mfma_f32_16x16x32_bf16 v[20:23], a[212:215], a[20:23], v[20:23]
    ds_read_b64_tr_b16 a[242:243], v251 offset:4096
    v_mfma_f32_16x16x32_bf16 v[20:23], a[216:219], a[36:39], v[20:23]
    v_mfma_f32_16x16x32_bf16 v[20:23], a[220:223], a[52:55], v[20:23]
    v_mfma_f32_16x16x32_bf16 v[16:19], a[220:223], a[48:51], v[16:19]
    ds_read_b64_tr_b16 a[244:245], v251 offset:5120
    v_mfma_f32_16x16x32_bf16 v[16:19], a[216:219], a[32:35], v[16:19]
    ds_read_b64_tr_b16 a[246:247], v251 offset:6144
    v_mfma_f32_16x16x32_bf16 v[16:19], a[212:215], a[16:19], v[16:19]
    v_mfma_f32_16x16x32_bf16 v[16:19], a[208:211], a[0:3], v[16:19]
    s_waitcnt lgkmcnt(4)
    v_mfma_f32_16x16x32_bf16 v[32:35], a[224:227], a[144:147], v[32:35]
    ds_read_b64_tr_b16 a[208:209], v235 offset:1024
    v_mfma_f32_16x16x32_bf16 v[32:35], a[228:231], a[160:163], v[32:35]
    ds_read_b64_tr_b16 a[210:211], v235 offset:2048
    v_mfma_f32_16x16x32_bf16 v[32:35], a[232:235], a[176:179], v[32:35]
    v_mfma_f32_16x16x32_bf16 v[32:35], a[236:239], a[192:195], v[32:35]
    v_mfma_f32_16x16x32_bf16 v[36:39], a[236:239], a[196:199], v[36:39]
    ds_read_b64_tr_b16 a[212:213], v235 offset:29696
    v_mfma_f32_16x16x32_bf16 v[36:39], a[232:235], a[180:183], v[36:39]
    ds_read_b64_tr_b16 a[214:215], v235 offset:30720
    v_cvt_pk_bf16_f32 v0, v0, v1
    v_mfma_f32_16x16x32_bf16 v[36:39], a[228:231], a[164:167], v[36:39]
    v_cvt_pk_bf16_f32 v1, v2, v3
    v_cvt_pk_bf16_f32 v2, v16, v17
    v_mfma_f32_16x16x32_bf16 v[36:39], a[224:227], a[148:151], v[36:39]
    v_cvt_pk_bf16_f32 v3, v18, v19
    v_mfma_f32_16x16x32_bf16 v[44:47], a[224:227], a[152:155], v[44:47]
    ds_read_b64_tr_b16 a[216:217], v242 offset:1024
    v_mfma_f32_16x16x32_bf16 v[44:47], a[228:231], a[168:171], v[44:47]
    ds_read_b64_tr_b16 a[218:219], v242 offset:2048
    v_mfma_f32_16x16x32_bf16 v[44:47], a[232:235], a[184:187], v[44:47]
    buffer_store_dwordx4 v[0:3], v208, s[36:39], s66 offen offset:0 sc1
    v_mfma_f32_16x16x32_bf16 v[44:47], a[236:239], a[200:203], v[44:47]
    v_cvt_pk_bf16_f32 v4, v4, v5
    v_cvt_pk_bf16_f32 v5, v6, v7
    v_mfma_f32_16x16x32_bf16 v[48:51], a[236:239], a[204:207], v[48:51]
    ds_read_b64_tr_b16 a[220:221], v234 offset:3072
    v_cvt_pk_bf16_f32 v6, v20, v21
    v_mfma_f32_16x16x32_bf16 v[48:51], a[232:235], a[188:191], v[48:51]
    ds_read_b64_tr_b16 a[222:223], v234 offset:4096
    v_cvt_pk_bf16_f32 v7, v22, v23
    v_mfma_f32_16x16x32_bf16 v[48:51], a[228:231], a[172:175], v[48:51]
    buffer_store_dwordx4 v[4:7], v208, s[36:39], s66 offen offset:1024 sc1
    v_mfma_f32_16x16x32_bf16 v[48:51], a[224:227], a[156:159], v[48:51]
    s_waitcnt lgkmcnt(4)
    v_cvt_pk_bf16_f32 v8, v8, v9
    v_cvt_pk_bf16_f32 v9, v10, v11
    v_mfma_f32_16x16x32_bf16 v[68:71], a[240:243], a[156:159], v[68:71]
    ds_read_b64_tr_b16 a[224:225], v234 offset:31744
    v_cvt_pk_bf16_f32 v10, v24, v25
    v_mfma_f32_16x16x32_bf16 v[68:71], a[244:247], a[172:175], v[68:71]
    ds_read_b64_tr_b16 a[226:227], v234 offset:32768
    v_cvt_pk_bf16_f32 v11, v26, v27
    v_mfma_f32_16x16x32_bf16 v[68:71], a[208:211], a[188:191], v[68:71]
    buffer_store_dwordx4 v[8:11], v208, s[36:39], s66 offen offset:2048 sc1
    v_mfma_f32_16x16x32_bf16 v[68:71], a[212:215], a[204:207], v[68:71]
    v_cvt_pk_bf16_f32 v12, v12, v13
    v_cvt_pk_bf16_f32 v13, v14, v15
    v_mfma_f32_16x16x32_bf16 v[64:67], a[212:215], a[200:203], v[64:67]
    ds_read_b64_tr_b16 a[228:229], v242 offset:3072
    v_cvt_pk_bf16_f32 v14, v28, v29
    v_mfma_f32_16x16x32_bf16 v[64:67], a[208:211], a[184:187], v[64:67]
    ds_read_b64_tr_b16 a[230:231], v242 offset:4096
    v_cvt_pk_bf16_f32 v15, v30, v31
    v_mfma_f32_16x16x32_bf16 v[64:67], a[244:247], a[168:171], v[64:67]
    buffer_store_dwordx4 v[12:15], v208, s[36:39], s66 offen offset:3072 sc1
    v_mfma_f32_16x16x32_bf16 v[64:67], a[240:243], a[152:155], v[64:67]
    v_mfma_f32_16x16x32_bf16 v[60:63], a[240:243], a[148:151], v[60:63]
    ds_read_b64_tr_b16 a[232:233], v243 offset:1024
    v_mfma_f32_16x16x32_bf16 v[60:63], a[244:247], a[164:167], v[60:63]
    ds_read_b64_tr_b16 a[234:235], v243 offset:2048
    v_mfma_f32_16x16x32_bf16 v[60:63], a[208:211], a[180:183], v[60:63]
    v_mfma_f32_16x16x32_bf16 v[60:63], a[212:215], a[196:199], v[60:63]
    v_mfma_f32_16x16x32_bf16 v[52:55], a[212:215], a[192:195], v[52:55]
    ds_read_b64_tr_b16 a[236:237], v235 offset:3072
    v_mfma_f32_16x16x32_bf16 v[52:55], a[208:211], a[176:179], v[52:55]
    ds_read_b64_tr_b16 a[238:239], v235 offset:4096
    v_mfma_f32_16x16x32_bf16 v[52:55], a[244:247], a[160:163], v[52:55]
    v_mfma_f32_16x16x32_bf16 v[52:55], a[240:243], a[144:147], v[52:55]
    s_waitcnt lgkmcnt(4)
    v_mfma_f32_16x16x32_bf16 v[32:35], a[216:219], a[0:3], v[32:35]
    ds_read_b64_tr_b16 a[240:241], v235 offset:31744
    v_mfma_f32_16x16x32_bf16 v[32:35], a[220:223], a[16:19], v[32:35]
    ds_read_b64_tr_b16 a[242:243], v235 offset:32768
    v_mfma_f32_16x16x32_bf16 v[32:35], a[224:227], a[32:35], v[32:35]
    v_mfma_f32_16x16x32_bf16 v[32:35], a[228:231], a[48:51], v[32:35]
    v_mfma_f32_16x16x32_bf16 v[36:39], a[228:231], a[52:55], v[36:39]
    ds_read_b64_tr_b16 a[244:245], v243 offset:3072
    v_mfma_f32_16x16x32_bf16 v[36:39], a[224:227], a[36:39], v[36:39]
    ds_read_b64_tr_b16 a[246:247], v243 offset:4096
    v_mfma_f32_16x16x32_bf16 v[36:39], a[220:223], a[20:23], v[36:39]
    v_mfma_f32_16x16x32_bf16 v[36:39], a[216:219], a[4:7], v[36:39]
    v_mfma_f32_16x16x32_bf16 v[44:47], a[216:219], a[8:11], v[44:47]
    ds_read_b64_tr_b16 a[208:209], v252 offset:3072
    v_mfma_f32_16x16x32_bf16 v[44:47], a[220:223], a[24:27], v[44:47]
    ds_read_b64_tr_b16 a[210:211], v252 offset:4096
    v_mfma_f32_16x16x32_bf16 v[44:47], a[224:227], a[40:43], v[44:47]
    v_mfma_f32_16x16x32_bf16 v[44:47], a[228:231], a[56:59], v[44:47]
    v_mfma_f32_16x16x32_bf16 v[48:51], a[228:231], a[60:63], v[48:51]
    ds_read_b64_tr_b16 a[212:213], v252 offset:5120
    v_mfma_f32_16x16x32_bf16 v[48:51], a[224:227], a[44:47], v[48:51]
    ds_read_b64_tr_b16 a[214:215], v252 offset:6144
    v_mfma_f32_16x16x32_bf16 v[48:51], a[220:223], a[28:31], v[48:51]
    v_mfma_f32_16x16x32_bf16 v[48:51], a[216:219], a[12:15], v[48:51]
    s_waitcnt lgkmcnt(4)
    v_mfma_f32_16x16x32_bf16 v[68:71], a[232:235], a[12:15], v[68:71]
    ds_read_b64_tr_b16 a[216:217], v236 offset:1024
    v_mfma_f32_16x16x32_bf16 v[68:71], a[236:239], a[28:31], v[68:71]
    ds_read_b64_tr_b16 a[218:219], v236 offset:2048
    v_mfma_f32_16x16x32_bf16 v[68:71], a[240:243], a[44:47], v[68:71]
    v_mfma_f32_16x16x32_bf16 v[68:71], a[244:247], a[60:63], v[68:71]
    v_mfma_f32_16x16x32_bf16 v[64:67], a[244:247], a[56:59], v[64:67]
    ds_read_b64_tr_b16 a[220:221], v236 offset:29696
    v_mfma_f32_16x16x32_bf16 v[64:67], a[240:243], a[40:43], v[64:67]
    ds_read_b64_tr_b16 a[222:223], v236 offset:30720
    v_mfma_f32_16x16x32_bf16 v[64:67], a[236:239], a[24:27], v[64:67]
    v_mfma_f32_16x16x32_bf16 v[64:67], a[232:235], a[8:11], v[64:67]
    v_mfma_f32_16x16x32_bf16 v[60:63], a[232:235], a[4:7], v[60:63]
    ds_read_b64_tr_b16 a[224:225], v253 offset:3072
    v_mfma_f32_16x16x32_bf16 v[60:63], a[236:239], a[20:23], v[60:63]
    ds_read_b64_tr_b16 a[226:227], v253 offset:4096
    v_mfma_f32_16x16x32_bf16 v[60:63], a[240:243], a[36:39], v[60:63]
    v_mfma_f32_16x16x32_bf16 v[60:63], a[244:247], a[52:55], v[60:63]
    v_mfma_f32_16x16x32_bf16 v[52:55], a[244:247], a[48:51], v[52:55]
    ds_read_b64_tr_b16 a[228:229], v253 offset:5120
    v_mfma_f32_16x16x32_bf16 v[52:55], a[240:243], a[32:35], v[52:55]
    ds_read_b64_tr_b16 a[230:231], v253 offset:6144
    v_mfma_f32_16x16x32_bf16 v[52:55], a[236:239], a[16:19], v[52:55]
    v_mfma_f32_16x16x32_bf16 v[52:55], a[232:235], a[0:3], v[52:55]
    s_waitcnt lgkmcnt(4)
    v_mfma_f32_16x16x32_bf16 v[76:79], a[208:211], a[144:147], v[76:79]
    ds_read_b64_tr_b16 a[232:233], v237 offset:1024
    v_mfma_f32_16x16x32_bf16 v[76:79], a[212:215], a[160:163], v[76:79]
    ds_read_b64_tr_b16 a[234:235], v237 offset:2048
    v_mfma_f32_16x16x32_bf16 v[76:79], a[216:219], a[176:179], v[76:79]
    v_mfma_f32_16x16x32_bf16 v[76:79], a[220:223], a[192:195], v[76:79]
    v_mfma_f32_16x16x32_bf16 v[80:83], a[220:223], a[196:199], v[80:83]
    ds_read_b64_tr_b16 a[236:237], v237 offset:29696
    v_mfma_f32_16x16x32_bf16 v[80:83], a[216:219], a[180:183], v[80:83]
    ds_read_b64_tr_b16 a[238:239], v237 offset:30720
    v_cvt_pk_bf16_f32 v32, v32, v33
    v_mfma_f32_16x16x32_bf16 v[80:83], a[212:215], a[164:167], v[80:83]
    v_cvt_pk_bf16_f32 v33, v34, v35
    v_cvt_pk_bf16_f32 v34, v52, v53
    v_mfma_f32_16x16x32_bf16 v[80:83], a[208:211], a[148:151], v[80:83]
    v_cvt_pk_bf16_f32 v35, v54, v55
    v_mfma_f32_16x16x32_bf16 v[84:87], a[208:211], a[152:155], v[84:87]
    ds_read_b64_tr_b16 a[240:241], v244 offset:1024
    v_mfma_f32_16x16x32_bf16 v[84:87], a[212:215], a[168:171], v[84:87]
    ds_read_b64_tr_b16 a[242:243], v244 offset:2048
    v_mfma_f32_16x16x32_bf16 v[84:87], a[216:219], a[184:187], v[84:87]
    buffer_store_dwordx4 v[32:35], v208, s[36:39], s67 offen offset:0 sc1
    v_mfma_f32_16x16x32_bf16 v[84:87], a[220:223], a[200:203], v[84:87]
    v_cvt_pk_bf16_f32 v36, v36, v37
    v_cvt_pk_bf16_f32 v37, v38, v39
    v_mfma_f32_16x16x32_bf16 v[88:91], a[220:223], a[204:207], v[88:91]
    ds_read_b64_tr_b16 a[244:245], v236 offset:3072
    v_cvt_pk_bf16_f32 v38, v60, v61
    v_mfma_f32_16x16x32_bf16 v[88:91], a[216:219], a[188:191], v[88:91]
    ds_read_b64_tr_b16 a[246:247], v236 offset:4096
    v_cvt_pk_bf16_f32 v39, v62, v63
    v_mfma_f32_16x16x32_bf16 v[88:91], a[212:215], a[172:175], v[88:91]
    buffer_store_dwordx4 v[36:39], v208, s[36:39], s67 offen offset:1024 sc1
    v_mfma_f32_16x16x32_bf16 v[88:91], a[208:211], a[156:159], v[88:91]
    s_waitcnt lgkmcnt(4)
    v_cvt_pk_bf16_f32 v44, v44, v45
    v_cvt_pk_bf16_f32 v45, v46, v47
    v_mfma_f32_16x16x32_bf16 v[120:123], a[224:227], a[156:159], v[120:123]
    ds_read_b64_tr_b16 a[208:209], v236 offset:31744
    v_cvt_pk_bf16_f32 v46, v64, v65
    v_mfma_f32_16x16x32_bf16 v[120:123], a[228:231], a[172:175], v[120:123]
    ds_read_b64_tr_b16 a[210:211], v236 offset:32768
    v_cvt_pk_bf16_f32 v47, v66, v67
    v_mfma_f32_16x16x32_bf16 v[120:123], a[232:235], a[188:191], v[120:123]
    buffer_store_dwordx4 v[44:47], v208, s[36:39], s67 offen offset:2048 sc1
    v_mfma_f32_16x16x32_bf16 v[120:123], a[236:239], a[204:207], v[120:123]
    v_cvt_pk_bf16_f32 v48, v48, v49
    v_cvt_pk_bf16_f32 v49, v50, v51
    v_mfma_f32_16x16x32_bf16 v[116:119], a[236:239], a[200:203], v[116:119]
    ds_read_b64_tr_b16 a[212:213], v244 offset:3072
    v_cvt_pk_bf16_f32 v50, v68, v69
    v_mfma_f32_16x16x32_bf16 v[116:119], a[232:235], a[184:187], v[116:119]
    ds_read_b64_tr_b16 a[214:215], v244 offset:4096
    v_cvt_pk_bf16_f32 v51, v70, v71
    v_mfma_f32_16x16x32_bf16 v[116:119], a[228:231], a[168:171], v[116:119]
    buffer_store_dwordx4 v[48:51], v208, s[36:39], s67 offen offset:3072 sc1
    v_mfma_f32_16x16x32_bf16 v[116:119], a[224:227], a[152:155], v[116:119]
    v_mfma_f32_16x16x32_bf16 v[112:115], a[224:227], a[148:151], v[112:115]
    ds_read_b64_tr_b16 a[216:217], v245 offset:1024
    v_mfma_f32_16x16x32_bf16 v[112:115], a[228:231], a[164:167], v[112:115]
    ds_read_b64_tr_b16 a[218:219], v245 offset:2048
    v_mfma_f32_16x16x32_bf16 v[112:115], a[232:235], a[180:183], v[112:115]
    v_mfma_f32_16x16x32_bf16 v[112:115], a[236:239], a[196:199], v[112:115]
    v_mfma_f32_16x16x32_bf16 v[92:95], a[236:239], a[192:195], v[92:95]
    ds_read_b64_tr_b16 a[220:221], v237 offset:3072
    v_mfma_f32_16x16x32_bf16 v[92:95], a[232:235], a[176:179], v[92:95]
    ds_read_b64_tr_b16 a[222:223], v237 offset:4096
    v_mfma_f32_16x16x32_bf16 v[92:95], a[228:231], a[160:163], v[92:95]
    v_mfma_f32_16x16x32_bf16 v[92:95], a[224:227], a[144:147], v[92:95]
    s_waitcnt lgkmcnt(4)
    v_mfma_f32_16x16x32_bf16 v[76:79], a[240:243], a[0:3], v[76:79]
    s_waitcnt vmcnt(8)
    ds_read_b64_tr_b16 a[224:225], v237 offset:31744
    ds_read_b64 v[188:189], v206 offset:0
    v_mfma_f32_16x16x32_bf16 v[76:79], a[244:247], a[16:19], v[76:79]
    ds_read_b64_tr_b16 a[226:227], v237 offset:32768
    ds_read_b64 v[190:191], v206 offset:32
    v_mfma_f32_16x16x32_bf16 v[76:79], a[208:211], a[32:35], v[76:79]
    ds_read_b64 v[192:193], v206 offset:1024
    ds_read_b64 v[194:195], v206 offset:1056
    v_mfma_f32_16x16x32_bf16 v[76:79], a[212:215], a[48:51], v[76:79]
    ds_read_b64 v[196:197], v206 offset:2048
    ds_read_b64 v[198:199], v206 offset:2080
    v_mfma_f32_16x16x32_bf16 v[80:83], a[212:215], a[52:55], v[80:83]
    ds_read_b64_tr_b16 a[228:229], v245 offset:3072
    ds_read_b64 v[200:201], v206 offset:3072
    v_mfma_f32_16x16x32_bf16 v[80:83], a[208:211], a[36:39], v[80:83]
    ds_read_b64_tr_b16 a[230:231], v245 offset:4096
    ds_read_b64 v[202:203], v206 offset:3104
    v_mfma_f32_16x16x32_bf16 v[80:83], a[244:247], a[20:23], v[80:83]
    v_mfma_f32_16x16x32_bf16 v[80:83], a[240:243], a[4:7], v[80:83]
    s_waitcnt vmcnt(4)
    buffer_store_dword v226, v225, s[36:39], s69 offen sc1
    v_mfma_f32_16x16x32_bf16 v[84:87], a[240:243], a[8:11], v[84:87]
    ds_read_b64_tr_b16 a[232:233], v246 offset:31744
    v_mfma_f32_16x16x32_bf16 v[84:87], a[244:247], a[24:27], v[84:87]
    ds_read_b64_tr_b16 a[234:235], v246 offset:32768
    v_mfma_f32_16x16x32_bf16 v[84:87], a[208:211], a[40:43], v[84:87]
    s_waitcnt lgkmcnt(2)
    v_lshlrev_b32 v0, 16, v188
    v_and_b32 v1, 0xffff0000, v188
    v_mfma_f32_16x16x32_bf16 v[84:87], a[212:215], a[56:59], v[84:87]
    v_lshlrev_b32 v2, 16, v189
    v_and_b32 v3, 0xffff0000, v189
    v_mfma_f32_16x16x32_bf16 v[88:91], a[212:215], a[60:63], v[88:91]
    ds_read_b64_tr_b16 a[236:237], v246 offset:33792
    v_lshlrev_b32 v16, 16, v190
    v_mfma_f32_16x16x32_bf16 v[88:91], a[208:211], a[44:47], v[88:91]
    ds_read_b64_tr_b16 a[238:239], v246 offset:34816
    v_and_b32 v17, 0xffff0000, v190
    v_mfma_f32_16x16x32_bf16 v[88:91], a[244:247], a[28:31], v[88:91]
    v_lshlrev_b32 v18, 16, v191
    v_and_b32 v19, 0xffff0000, v191
    v_mfma_f32_16x16x32_bf16 v[88:91], a[240:243], a[12:15], v[88:91]
    v_lshlrev_b32 v4, 16, v192
    v_and_b32 v5, 0xffff0000, v192
    v_mfma_f32_16x16x32_bf16 v[120:123], a[216:219], a[12:15], v[120:123]
    ds_read_b64_tr_b16 a[240:241], v254 offset:1024
    v_lshlrev_b32 v6, 16, v193
    v_mfma_f32_16x16x32_bf16 v[120:123], a[220:223], a[28:31], v[120:123]
    ds_read_b64_tr_b16 a[242:243], v254 offset:2048
    v_and_b32 v7, 0xffff0000, v193
    v_mfma_f32_16x16x32_bf16 v[120:123], a[224:227], a[44:47], v[120:123]
    v_lshlrev_b32 v20, 16, v194
    v_and_b32 v21, 0xffff0000, v194
    v_mfma_f32_16x16x32_bf16 v[120:123], a[228:231], a[60:63], v[120:123]
    v_lshlrev_b32 v22, 16, v195
    v_and_b32 v23, 0xffff0000, v195
    v_mfma_f32_16x16x32_bf16 v[116:119], a[228:231], a[56:59], v[116:119]
    ds_read_b64_tr_b16 a[244:245], v254 offset:3072
    v_lshlrev_b32 v8, 16, v196
    v_mfma_f32_16x16x32_bf16 v[116:119], a[224:227], a[40:43], v[116:119]
    ds_read_b64_tr_b16 a[246:247], v254 offset:4096
    v_and_b32 v9, 0xffff0000, v196
    v_mfma_f32_16x16x32_bf16 v[116:119], a[220:223], a[24:27], v[116:119]
    v_lshlrev_b32 v10, 16, v197
    v_and_b32 v11, 0xffff0000, v197
    v_mfma_f32_16x16x32_bf16 v[116:119], a[216:219], a[8:11], v[116:119]
    v_lshlrev_b32 v24, 16, v198
    v_and_b32 v25, 0xffff0000, v198
    v_mfma_f32_16x16x32_bf16 v[112:115], a[216:219], a[4:7], v[112:115]
    ds_read_b64_tr_b16 a[208:209], v247 offset:31744
    v_lshlrev_b32 v26, 16, v199
    v_mfma_f32_16x16x32_bf16 v[112:115], a[220:223], a[20:23], v[112:115]
    ds_read_b64_tr_b16 a[210:211], v247 offset:32768
    v_and_b32 v27, 0xffff0000, v199
    v_mfma_f32_16x16x32_bf16 v[112:115], a[224:227], a[36:39], v[112:115]
    v_lshlrev_b32 v12, 16, v200
    v_and_b32 v13, 0xffff0000, v200
    v_mfma_f32_16x16x32_bf16 v[112:115], a[228:231], a[52:55], v[112:115]
    v_lshlrev_b32 v14, 16, v201
    v_and_b32 v15, 0xffff0000, v201
    v_mfma_f32_16x16x32_bf16 v[92:95], a[228:231], a[48:51], v[92:95]
    ds_read_b64_tr_b16 a[212:213], v247 offset:33792
    v_lshlrev_b32 v28, 16, v202
    v_mfma_f32_16x16x32_bf16 v[92:95], a[224:227], a[32:35], v[92:95]
    ds_read_b64_tr_b16 a[214:215], v247 offset:34816
    v_and_b32 v29, 0xffff0000, v202
    v_mfma_f32_16x16x32_bf16 v[92:95], a[220:223], a[16:19], v[92:95]
    v_lshlrev_b32 v30, 16, v203
    v_and_b32 v31, 0xffff0000, v203
    v_mfma_f32_16x16x32_bf16 v[92:95], a[216:219], a[0:3], v[92:95]
    s_waitcnt lgkmcnt(4)
    v_mfma_f32_16x16x32_bf16 v[124:127], a[232:235], a[96:99], v[124:127]
    ds_read_b64_tr_b16 a[216:217], v255 offset:1024
    v_mfma_f32_16x16x32_bf16 v[124:127], a[236:239], a[112:115], v[124:127]
    ds_read_b64_tr_b16 a[218:219], v255 offset:2048
    v_mfma_f32_16x16x32_bf16 v[124:127], a[240:243], a[128:131], v[124:127]
    v_mfma_f32_16x16x32_bf16 v[124:127], a[244:247], a[144:147], v[124:127]
    v_mfma_f32_16x16x32_bf16 v[144:147], a[244:247], a[148:151], v[144:147]
    ds_read_b64_tr_b16 a[220:221], v255 offset:3072
    v_mfma_f32_16x16x32_bf16 v[144:147], a[240:243], a[132:135], v[144:147]
    ds_read_b64_tr_b16 a[222:223], v255 offset:4096
    v_cvt_pk_bf16_f32 v76, v76, v77
    v_mfma_f32_16x16x32_bf16 v[144:147], a[236:239], a[116:119], v[144:147]
    v_cvt_pk_bf16_f32 v77, v78, v79
    v_cvt_pk_bf16_f32 v78, v92, v93
    v_mfma_f32_16x16x32_bf16 v[144:147], a[232:235], a[100:103], v[144:147]
    v_cvt_pk_bf16_f32 v79, v94, v95
    v_mfma_f32_16x16x32_bf16 v[148:151], a[232:235], a[104:107], v[148:151]
    ds_read_b64_tr_b16 a[224:225], v254 offset:5120
    v_mfma_f32_16x16x32_bf16 v[148:151], a[236:239], a[120:123], v[148:151]
    ds_read_b64_tr_b16 a[226:227], v254 offset:6144
    v_mfma_f32_16x16x32_bf16 v[148:151], a[240:243], a[136:139], v[148:151]
    buffer_store_dwordx4 v[76:79], v208, s[36:39], s68 offen offset:0 sc1
    v_mfma_f32_16x16x32_bf16 v[148:151], a[244:247], a[152:155], v[148:151]
    v_cvt_pk_bf16_f32 v80, v80, v81
    v_cvt_pk_bf16_f32 v81, v82, v83
    v_mfma_f32_16x16x32_bf16 v[152:155], a[244:247], a[156:159], v[152:155]
    ds_read_b64_tr_b16 a[228:229], v238 offset:1024
    v_cvt_pk_bf16_f32 v82, v112, v113
    v_mfma_f32_16x16x32_bf16 v[152:155], a[240:243], a[140:143], v[152:155]
    ds_read_b64_tr_b16 a[230:231], v238 offset:2048
    v_cvt_pk_bf16_f32 v83, v114, v115
    v_mfma_f32_16x16x32_bf16 v[152:155], a[236:239], a[124:127], v[152:155]
    buffer_store_dwordx4 v[80:83], v208, s[36:39], s68 offen offset:1024 sc1
    v_mfma_f32_16x16x32_bf16 v[152:155], a[232:235], a[108:111], v[152:155]
    s_waitcnt lgkmcnt(4)
    v_cvt_pk_bf16_f32 v84, v84, v85
    v_cvt_pk_bf16_f32 v85, v86, v87
    v_mfma_f32_16x16x32_bf16 v[184:187], a[208:211], a[108:111], v[184:187]
    ds_read_b64_tr_b16 a[232:233], v238 offset:29696
    v_cvt_pk_bf16_f32 v86, v116, v117
    v_mfma_f32_16x16x32_bf16 v[184:187], a[212:215], a[124:127], v[184:187]
    ds_read_b64_tr_b16 a[234:235], v238 offset:30720
    v_cvt_pk_bf16_f32 v87, v118, v119
    v_mfma_f32_16x16x32_bf16 v[184:187], a[216:219], a[140:143], v[184:187]
    buffer_store_dwordx4 v[84:87], v208, s[36:39], s68 offen offset:2048 sc1
    v_mfma_f32_16x16x32_bf16 v[184:187], a[220:223], a[156:159], v[184:187]
    v_cvt_pk_bf16_f32 v88, v88, v89
    v_cvt_pk_bf16_f32 v89, v90, v91
    v_mfma_f32_16x16x32_bf16 v[180:183], a[220:223], a[152:155], v[180:183]
    ds_read_b64_tr_b16 a[236:237], v246 offset:1024
    v_cvt_pk_bf16_f32 v90, v120, v121
    v_mfma_f32_16x16x32_bf16 v[180:183], a[216:219], a[136:139], v[180:183]
    ds_read_b64_tr_b16 a[238:239], v246 offset:2048
    v_cvt_pk_bf16_f32 v91, v122, v123
    v_mfma_f32_16x16x32_bf16 v[180:183], a[212:215], a[120:123], v[180:183]
    buffer_store_dwordx4 v[88:91], v208, s[36:39], s68 offen offset:3072 sc1
    v_mfma_f32_16x16x32_bf16 v[180:183], a[208:211], a[104:107], v[180:183]
    v_mfma_f32_16x16x32_bf16 v[176:179], a[208:211], a[100:103], v[176:179]
    ds_read_b64_tr_b16 a[240:241], v255 offset:5120
    v_mfma_f32_16x16x32_bf16 v[176:179], a[212:215], a[116:119], v[176:179]
    ds_read_b64_tr_b16 a[242:243], v255 offset:6144
    v_mfma_f32_16x16x32_bf16 v[176:179], a[216:219], a[132:135], v[176:179]
    v_mfma_f32_16x16x32_bf16 v[176:179], a[220:223], a[148:151], v[176:179]
    v_mfma_f32_16x16x32_bf16 v[156:159], a[220:223], a[144:147], v[156:159]
    ds_read_b64_tr_b16 a[244:245], v239 offset:1024
    v_mfma_f32_16x16x32_bf16 v[156:159], a[216:219], a[128:131], v[156:159]
    ds_read_b64_tr_b16 a[246:247], v239 offset:2048
    v_mfma_f32_16x16x32_bf16 v[156:159], a[212:215], a[112:115], v[156:159]
    v_mfma_f32_16x16x32_bf16 v[156:159], a[208:211], a[96:99], v[156:159]
    s_waitcnt lgkmcnt(4)
    v_mfma_f32_16x16x32_bf16 v[124:127], a[224:227], a[160:163], v[124:127]
    ds_read_b64_tr_b16 a[208:209], v239 offset:29696
    v_mfma_f32_16x16x32_bf16 v[124:127], a[228:231], a[176:179], v[124:127]
    ds_read_b64_tr_b16 a[210:211], v239 offset:30720
    v_mfma_f32_16x16x32_bf16 v[124:127], a[232:235], a[192:195], v[124:127]
    v_mfma_f32_16x16x32_bf16 v[124:127], a[236:239], a[0:3], v[124:127]
    v_mfma_f32_16x16x32_bf16 v[144:147], a[236:239], a[4:7], v[144:147]
    ds_read_b64_tr_b16 a[212:213], v247 offset:1024
    v_mfma_f32_16x16x32_bf16 v[144:147], a[232:235], a[196:199], v[144:147]
    ds_read_b64_tr_b16 a[214:215], v247 offset:2048
    v_mfma_f32_16x16x32_bf16 v[144:147], a[228:231], a[180:183], v[144:147]
    v_mfma_f32_16x16x32_bf16 v[144:147], a[224:227], a[164:167], v[144:147]
    s_waitcnt vmcnt(5)
    buffer_store_dword v226, v225, s[36:39], s70 offen sc1
    v_mfma_f32_16x16x32_bf16 v[148:151], a[224:227], a[168:171], v[148:151]
    ds_read_b64_tr_b16 a[216:217], v238 offset:3072
    v_mfma_f32_16x16x32_bf16 v[148:151], a[228:231], a[184:187], v[148:151]
    ds_read_b64_tr_b16 a[218:219], v238 offset:4096
    v_mfma_f32_16x16x32_bf16 v[148:151], a[232:235], a[200:203], v[148:151]
    v_mfma_f32_16x16x32_bf16 v[148:151], a[236:239], a[8:11], v[148:151]
    v_mfma_f32_16x16x32_bf16 v[152:155], a[236:239], a[12:15], v[152:155]
    ds_read_b64_tr_b16 a[220:221], v238 offset:31744
    v_mfma_f32_16x16x32_bf16 v[152:155], a[232:235], a[204:207], v[152:155]
    ds_read_b64_tr_b16 a[222:223], v238 offset:32768
    v_mfma_f32_16x16x32_bf16 v[152:155], a[228:231], a[188:191], v[152:155]
    v_mfma_f32_16x16x32_bf16 v[152:155], a[224:227], a[172:175], v[152:155]
    s_waitcnt lgkmcnt(4)
    v_mfma_f32_16x16x32_bf16 v[184:187], a[240:243], a[172:175], v[184:187]
    ds_read_b64_tr_b16 a[224:225], v246 offset:3072
    v_mfma_f32_16x16x32_bf16 v[184:187], a[244:247], a[188:191], v[184:187]
    ds_read_b64_tr_b16 a[226:227], v246 offset:4096
    v_mfma_f32_16x16x32_bf16 v[184:187], a[208:211], a[204:207], v[184:187]
    v_mfma_f32_16x16x32_bf16 v[184:187], a[212:215], a[12:15], v[184:187]
    v_mfma_f32_16x16x32_bf16 v[180:183], a[212:215], a[8:11], v[180:183]
    ds_read_b64_tr_b16 a[228:229], v239 offset:3072
    v_mfma_f32_16x16x32_bf16 v[180:183], a[208:211], a[200:203], v[180:183]
    ds_read_b64_tr_b16 a[230:231], v239 offset:4096
    v_mfma_f32_16x16x32_bf16 v[180:183], a[244:247], a[184:187], v[180:183]
    v_mfma_f32_16x16x32_bf16 v[180:183], a[240:243], a[168:171], v[180:183]
    v_mfma_f32_16x16x32_bf16 v[176:179], a[240:243], a[164:167], v[176:179]
    ds_read_b64_tr_b16 a[232:233], v239 offset:31744
    v_mfma_f32_16x16x32_bf16 v[176:179], a[244:247], a[180:183], v[176:179]
    ds_read_b64_tr_b16 a[234:235], v239 offset:32768
    v_mfma_f32_16x16x32_bf16 v[176:179], a[208:211], a[196:199], v[176:179]
    v_mfma_f32_16x16x32_bf16 v[176:179], a[212:215], a[4:7], v[176:179]
    v_mfma_f32_16x16x32_bf16 v[156:159], a[212:215], a[0:3], v[156:159]
    ds_read_b64_tr_b16 a[236:237], v247 offset:3072
    v_mfma_f32_16x16x32_bf16 v[156:159], a[208:211], a[192:195], v[156:159]
    ds_read_b64_tr_b16 a[238:239], v247 offset:4096
    v_mfma_f32_16x16x32_bf16 v[156:159], a[244:247], a[176:179], v[156:159]
    v_mfma_f32_16x16x32_bf16 v[156:159], a[240:243], a[160:163], v[156:159]
    s_waitcnt lgkmcnt(6)
    v_mfma_f32_16x16x32_bf16 v[124:127], a[216:219], a[16:19], v[124:127]
    v_mfma_f32_16x16x32_bf16 v[124:127], a[220:223], a[32:35], v[124:127]
    v_mfma_f32_16x16x32_bf16 v[124:127], a[224:227], a[48:51], v[124:127]
    v_mfma_f32_16x16x32_bf16 v[144:147], a[224:227], a[52:55], v[144:147]
    v_mfma_f32_16x16x32_bf16 v[144:147], a[220:223], a[36:39], v[144:147]
    v_mfma_f32_16x16x32_bf16 v[144:147], a[216:219], a[20:23], v[144:147]
    v_mfma_f32_16x16x32_bf16 v[148:151], a[216:219], a[24:27], v[148:151]
    v_mfma_f32_16x16x32_bf16 v[148:151], a[220:223], a[40:43], v[148:151]
    buffer_load_dword v227, v230, s[36:39], s71 offen sc1
    v_mfma_f32_16x16x32_bf16 v[148:151], a[224:227], a[56:59], v[148:151]
    v_mfma_f32_16x16x32_bf16 v[152:155], a[224:227], a[60:63], v[152:155]
    v_mfma_f32_16x16x32_bf16 v[152:155], a[220:223], a[44:47], v[152:155]
    v_mfma_f32_16x16x32_bf16 v[152:155], a[216:219], a[28:31], v[152:155]
    s_waitcnt lgkmcnt(0)
    v_mfma_f32_16x16x32_bf16 v[184:187], a[228:231], a[28:31], v[184:187]
    v_mfma_f32_16x16x32_bf16 v[184:187], a[232:235], a[44:47], v[184:187]
    v_mfma_f32_16x16x32_bf16 v[184:187], a[236:239], a[60:63], v[184:187]
    v_mfma_f32_16x16x32_bf16 v[180:183], a[236:239], a[56:59], v[180:183]
    v_mfma_f32_16x16x32_bf16 v[180:183], a[232:235], a[40:43], v[180:183]
    v_mfma_f32_16x16x32_bf16 v[180:183], a[228:231], a[24:27], v[180:183]
    v_mfma_f32_16x16x32_bf16 v[176:179], a[228:231], a[20:23], v[176:179]
    v_mfma_f32_16x16x32_bf16 v[176:179], a[232:235], a[36:39], v[176:179]
    v_mfma_f32_16x16x32_bf16 v[176:179], a[236:239], a[52:55], v[176:179]
    v_mfma_f32_16x16x32_bf16 v[156:159], a[236:239], a[48:51], v[156:159]
    v_mfma_f32_16x16x32_bf16 v[156:159], a[232:235], a[32:35], v[156:159]
    v_mfma_f32_16x16x32_bf16 v[156:159], a[228:231], a[16:19], v[156:159]
    s_waitcnt vmcnt(2)
    buffer_store_dword v226, v225, s[36:39], s72 offen sc1
    s_waitcnt vmcnt(1)
    s_mov_b32 s83, 0x40000
F_sp_32:
    v_cmp_ne_u32 vcc, 0, v227
    s_and_b32 s53, vcc_lo, 0x1
    s_cmp_eq_u32 s53, 0x1
    s_cbranch_scc1 F_ok_33
    buffer_load_dword v227, v230, s[36:39], s71 offen sc1
    s_sub_u32 s83, s83, 1
    s_waitcnt vmcnt(0)
    s_cbranch_scc0 F_sp_32
F_ok_33:
    buffer_load_dwordx4 v[96:99], v208, s[36:39], s73 offen offset:0 sc1
    buffer_load_dwordx4 v[100:103], v208, s[36:39], s73 offen offset:1024 sc1
    buffer_load_dwordx4 v[104:107], v208, s[36:39], s73 offen offset:2048 sc1
    buffer_load_dwordx4 v[108:111], v208, s[36:39], s73 offen offset:3072 sc1
    s_add_u32 s73, s73, 4096
    s_mov_b32 s83, 0x40000
F_sp_34:
    v_cmp_ne_u32 vcc, 0, v227
    s_and_b32 s53, vcc_lo, 0x2
    s_cmp_eq_u32 s53, 0x2
    s_cbranch_scc1 F_ok_35
    buffer_load_dword v227, v230, s[36:39], s71 offen sc1
    s_sub_u32 s83, s83, 1
    s_waitcnt vmcnt(0)
    s_cbranch_scc0 F_sp_34
F_ok_35:
    buffer_load_dwordx4 v[128:131], v208, s[36:39], s73 offen offset:0 sc1
    buffer_load_dwordx4 v[132:135], v208, s[36:39], s73 offen offset:1024 sc1
    buffer_load_dwordx4 v[136:139], v208, s[36:39], s73 offen offset:2048 sc1
    buffer_load_dwordx4 v[140:143], v208, s[36:39], s73 offen offset:3072 sc1
    s_add_u32 s73, s73, 4096
    buffer_load_dword v227, v230, s[36:39], s71 offen sc1
    v_pk_add_f32 v[0:1], v[0:1], v[124:125]
    v_pk_add_f32 v[2:3], v[2:3], v[126:127]
    v_pk_add_f32 v[16:17], v[16:17], v[156:157]
    v_pk_add_f32 v[18:19], v[18:19], v[158:159]
    v_pk_add_f32 v[4:5], v[4:5], v[144:145]
    v_pk_add_f32 v[6:7], v[6:7], v[146:147]
    v_pk_add_f32 v[20:21], v[20:21], v[176:177]
    v_pk_add_f32 v[22:23], v[22:23], v[178:179]
    v_pk_add_f32 v[8:9], v[8:9], v[148:149]
    v_pk_add_f32 v[10:11], v[10:11], v[150:151]
    v_pk_add_f32 v[24:25], v[24:25], v[180:181]
    v_pk_add_f32 v[26:27], v[26:27], v[182:183]
    v_pk_add_f32 v[12:13], v[12:13], v[152:153]
    v_pk_add_f32 v[14:15], v[14:15], v[154:155]
    v_pk_add_f32 v[28:29], v[28:29], v[184:185]
    v_pk_add_f32 v[30:31], v[30:31], v[186:187]
    s_waitcnt vmcnt(8)
    v_lshlrev_b32 v204, 16, v96
    v_and_b32 v205, 0xffff0000, v96
    v_pk_add_f32 v[0:1], v[0:1], v[204:205]
    v_lshlrev_b32 v204, 16, v97
    v_and_b32 v205, 0xffff0000, v97
    v_pk_add_f32 v[2:3], v[2:3], v[204:205]
    v_lshlrev_b32 v204, 16, v98
    v_and_b32 v205, 0xffff0000, v98
    v_pk_add_f32 v[16:17], v[16:17], v[204:205]
    v_lshlrev_b32 v204, 16, v99
    v_and_b32 v205, 0xffff0000, v99
    v_pk_add_f32 v[18:19], v[18:19], v[204:205]
    s_waitcnt vmcnt(7)
    v_lshlrev_b32 v204, 16, v100
    v_and_b32 v205, 0xffff0000, v100
    v_pk_add_f32 v[4:5], v[4:5], v[204:205]
    v_lshlrev_b32 v204, 16, v101
    v_and_b32 v205, 0xffff0000, v101
    v_pk_add_f32 v[6:7], v[6:7], v[204:205]
    v_lshlrev_b32 v204, 16, v102
    v_and_b32 v205, 0xffff0000, v102
    v_pk_add_f32 v[20:21], v[20:21], v[204:205]
    v_lshlrev_b32 v204, 16, v103
    v_and_b32 v205, 0xffff0000, v103
    v_pk_add_f32 v[22:23], v[22:23], v[204:205]
    s_waitcnt vmcnt(6)
    v_lshlrev_b32 v204, 16, v104
    v_and_b32 v205, 0xffff0000, v104
    v_pk_add_f32 v[8:9], v[8:9], v[204:205]
    v_lshlrev_b32 v204, 16, v105
    v_and_b32 v205, 0xffff0000, v105
    v_pk_add_f32 v[10:11], v[10:11], v[204:205]
    v_lshlrev_b32 v204, 16, v106
    v_and_b32 v205, 0xffff0000, v106
    v_pk_add_f32 v[24:25], v[24:25], v[204:205]
    v_lshlrev_b32 v204, 16, v107
    v_and_b32 v205, 0xffff0000, v107
    v_pk_add_f32 v[26:27], v[26:27], v[204:205]
    s_waitcnt vmcnt(5)
    v_lshlrev_b32 v204, 16, v108
    v_and_b32 v205, 0xffff0000, v108
    v_pk_add_f32 v[12:13], v[12:13], v[204:205]
    v_lshlrev_b32 v204, 16, v109
    v_and_b32 v205, 0xffff0000, v109
    v_pk_add_f32 v[14:15], v[14:15], v[204:205]
    v_lshlrev_b32 v204, 16, v110
    v_and_b32 v205, 0xffff0000, v110
    v_pk_add_f32 v[28:29], v[28:29], v[204:205]
    v_lshlrev_b32 v204, 16, v111
    v_and_b32 v205, 0xffff0000, v111
    v_pk_add_f32 v[30:31], v[30:31], v[204:205]
    s_waitcnt vmcnt(0)
    s_mov_b32 s83, 0x40000
F_sp_36:
    v_cmp_ne_u32 vcc, 0, v227
    s_and_b32 s53, vcc_lo, 0x4
    s_cmp_eq_u32 s53, 0x4
    s_cbranch_scc1 F_ok_37
    buffer_load_dword v227, v230, s[36:39], s71 offen sc1
    s_sub_u32 s83, s83, 1
    s_waitcnt vmcnt(0)
    s_cbranch_scc0 F_sp_36
F_ok_37:
    buffer_load_dwordx4 v[160:163], v208, s[36:39], s73 offen offset:0 sc1
    buffer_load_dwordx4 v[164:167], v208, s[36:39], s73 offen offset:1024 sc1
    buffer_load_dwordx4 v[168:171], v208, s[36:39], s73 offen offset:2048 sc1
    buffer_load_dwordx4 v[172:175], v208, s[36:39], s73 offen offset:3072 sc1
    v_lshlrev_b32 v204, 16, v128
    v_and_b32 v205, 0xffff0000, v128
    v_pk_add_f32 v[0:1], v[0:1], v[204:205]
    v_lshlrev_b32 v204, 16, v129
    v_and_b32 v205, 0xffff0000, v129
    v_pk_add_f32 v[2:3], v[2:3], v[204:205]
    v_lshlrev_b32 v204, 16, v130
    v_and_b32 v205, 0xffff0000, v130
    v_pk_add_f32 v[16:17], v[16:17], v[204:205]
    v_lshlrev_b32 v204, 16, v131
    v_and_b32 v205, 0xffff0000, v131
    v_pk_add_f32 v[18:19], v[18:19], v[204:205]
    v_lshlrev_b32 v204, 16, v132
    v_and_b32 v205, 0xffff0000, v132
    v_pk_add_f32 v[4:5], v[4:5], v[204:205]
    v_lshlrev_b32 v204, 16, v133
    v_and_b32 v205, 0xffff0000, v133
    v_pk_add_f32 v[6:7], v[6:7], v[204:205]
    v_lshlrev_b32 v204, 16, v134
    v_and_b32 v205, 0xffff0000, v134
    v_pk_add_f32 v[20:21], v[20:21], v[204:205]
    v_lshlrev_b32 v204, 16, v135
    v_and_b32 v205, 0xffff0000, v135
    v_pk_add_f32 v[22:23], v[22:23], v[204:205]
    v_lshlrev_b32 v204, 16, v136
    v_and_b32 v205, 0xffff0000, v136
    v_pk_add_f32 v[8:9], v[8:9], v[204:205]
    v_lshlrev_b32 v204, 16, v137
    v_and_b32 v205, 0xffff0000, v137
    v_pk_add_f32 v[10:11], v[10:11], v[204:205]
    v_lshlrev_b32 v204, 16, v138
    v_and_b32 v205, 0xffff0000, v138
    v_pk_add_f32 v[24:25], v[24:25], v[204:205]
    v_lshlrev_b32 v204, 16, v139
    v_and_b32 v205, 0xffff0000, v139
    v_pk_add_f32 v[26:27], v[26:27], v[204:205]
    v_lshlrev_b32 v204, 16, v140
    v_and_b32 v205, 0xffff0000, v140
    v_pk_add_f32 v[12:13], v[12:13], v[204:205]
    v_lshlrev_b32 v204, 16, v141
    v_and_b32 v205, 0xffff0000, v141
    v_pk_add_f32 v[14:15], v[14:15], v[204:205]
    v_lshlrev_b32 v204, 16, v142
    v_and_b32 v205, 0xffff0000, v142
    v_pk_add_f32 v[28:29], v[28:29], v[204:205]
    v_lshlrev_b32 v204, 16, v143
    v_and_b32 v205, 0xffff0000, v143
    v_pk_add_f32 v[30:31], v[30:31], v[204:205]
    s_waitcnt vmcnt(3)
    v_lshlrev_b32 v204, 16, v160
    v_and_b32 v205, 0xffff0000, v160
    v_pk_add_f32 v[0:1], v[0:1], v[204:205]
    v_lshlrev_b32 v204, 16, v161
    v_and_b32 v205, 0xffff0000, v161
    v_pk_add_f32 v[2:3], v[2:3], v[204:205]
    v_lshlrev_b32 v204, 16, v162
    v_and_b32 v205, 0xffff0000, v162
    v_pk_add_f32 v[16:17], v[16:17], v[204:205]
    v_lshlrev_b32 v204, 16, v163
    v_and_b32 v205, 0xffff0000, v163
    v_pk_add_f32 v[18:19], v[18:19], v[204:205]
    v_cvt_pk_bf16_f32 v0, v0, v1
    v_cvt_pk_bf16_f32 v1, v2, v3
    v_cvt_pk_bf16_f32 v2, v16, v17
    v_cvt_pk_bf16_f32 v3, v18, v19
    ds_write_b64 v228, v[0:1] offset:0
    ds_write_b64 v228, v[2:3] offset:32
    ds_read_b128 v[16:19], v231 offset:0
    s_waitcnt vmcnt(2)
    v_lshlrev_b32 v204, 16, v164
    v_and_b32 v205, 0xffff0000, v164
    v_pk_add_f32 v[4:5], v[4:5], v[204:205]
    v_lshlrev_b32 v204, 16, v165
    v_and_b32 v205, 0xffff0000, v165
    v_pk_add_f32 v[6:7], v[6:7], v[204:205]
    v_lshlrev_b32 v204, 16, v166
    v_and_b32 v205, 0xffff0000, v166
    v_pk_add_f32 v[20:21], v[20:21], v[204:205]
    v_lshlrev_b32 v204, 16, v167
    v_and_b32 v205, 0xffff0000, v167
    v_pk_add_f32 v[22:23], v[22:23], v[204:205]
    v_cvt_pk_bf16_f32 v4, v4, v5
    v_cvt_pk_bf16_f32 v5, v6, v7
    v_cvt_pk_bf16_f32 v6, v20, v21
    v_cvt_pk_bf16_f32 v7, v22, v23
    ds_write_b64 v228, v[4:5] offset:1280
    ds_write_b64 v228, v[6:7] offset:1312
    ds_read_b128 v[20:23], v231 offset:1280
    s_waitcnt lgkmcnt(3)
    buffer_store_dwordx4 v[16:19], v211, s[24:27], s82 offen nt
    s_add_u32 s82, s82, 32768
    s_waitcnt vmcnt(2)
    v_lshlrev_b32 v204, 16, v168
    v_and_b32 v205, 0xffff0000, v168
    v_pk_add_f32 v[8:9], v[8:9], v[204:205]
    v_lshlrev_b32 v204, 16, v169
    v_and_b32 v205, 0xffff0000, v169
    v_pk_add_f32 v[10:11], v[10:11], v[204:205]
    v_lshlrev_b32 v204, 16, v170
    v_and_b32 v205, 0xffff0000, v170
    v_pk_add_f32 v[24:25], v[24:25], v[204:205]
    v_lshlrev_b32 v204, 16, v171
    v_and_b32 v205, 0xffff0000, v171
    v_pk_add_f32 v[26:27], v[26:27], v[204:205]
    v_cvt_pk_bf16_f32 v8, v8, v9
    v_cvt_pk_bf16_f32 v9, v10, v11
    v_cvt_pk_bf16_f32 v10, v24, v25
    v_cvt_pk_bf16_f32 v11, v26, v27
    ds_write_b64 v228, v[8:9] offset:2560
    ds_write_b64 v228, v[10:11] offset:2592
    ds_read_b128 v[24:27], v231 offset:2560
    s_waitcnt lgkmcnt(3)
    buffer_store_dwordx4 v[20:23], v211, s[24:27], s82 offen nt
    s_add_u32 s82, s82, 32768
    s_waitcnt vmcnt(2)
    v_lshlrev_b32 v204, 16, v172
    v_and_b32 v205, 0xffff0000, v172
    v_pk_add_f32 v[12:13], v[12:13], v[204:205]
    v_lshlrev_b32 v204, 16, v173
    v_and_b32 v205, 0xffff0000, v173
    v_pk_add_f32 v[14:15], v[14:15], v[204:205]
    v_lshlrev_b32 v204, 16, v174
    v_and_b32 v205, 0xffff0000, v174
    v_pk_add_f32 v[28:29], v[28:29], v[204:205]
    v_lshlrev_b32 v204, 16, v175
    v_and_b32 v205, 0xffff0000, v175
    v_pk_add_f32 v[30:31], v[30:31], v[204:205]
    v_cvt_pk_bf16_f32 v12, v12, v13
    v_cvt_pk_bf16_f32 v13, v14, v15
    v_cvt_pk_bf16_f32 v14, v28, v29
    v_cvt_pk_bf16_f32 v15, v30, v31
    ds_write_b64 v228, v[12:13] offset:3840
    ds_write_b64 v228, v[14:15] offset:3872
    ds_read_b128 v[28:31], v231 offset:3840
    s_waitcnt lgkmcnt(3)
    buffer_store_dwordx4 v[24:27], v211, s[24:27], s82 offen nt
    s_add_u32 s82, s82, 32768
    s_waitcnt lgkmcnt(0)
    buffer_store_dwordx4 v[28:31], v211, s[24:27], s82 offen nt
F_end:
    s_endpgm
.section .rodata,"a"
.p2align 6
.amdhsa_kernel parallel_sum__sliding_block__dense_activation_relu__prompt_kernel
  .amdhsa_next_free_vgpr 512
  .amdhsa_next_free_sgpr 102
  .amdhsa_accum_offset 256
  .amdhsa_group_segment_fixed_size 0
  .amdhsa_kernarg_size 72
  .amdhsa_user_sgpr_count 2
  .amdhsa_user_sgpr_kernarg_segment_ptr 1
  .amdhsa_system_sgpr_workgroup_id_x 1
  .amdhsa_float_denorm_mode_32 3
.end_amdhsa_kernel
.text
CODE_END:
```
